```python
import torch

def _softmax(x, axis=-1):
    return torch.softmax(x, dim=axis)
def _gelu(x):
    return torch.nn.functional.gelu(x, approximate="tanh")
def _silu(x):
    return torch.nn.functional.silu(x)
def _sigmoid(x):
    return torch.sigmoid(x)
def _layernorm(x, axis=-1, eps=1e-5):
    m = x.mean(dim=axis, keepdim=True)
    v = x.var(dim=axis, keepdim=True, unbiased=False)
    return (x - m) / torch.sqrt(v + eps)
def _scatter_add(tgt, idx, src, axis=0):
    return tgt.clone().index_add_(axis, idx, src)
def _segment_sum(src, seg, n):
    out = torch.zeros((n,) + src.shape[1:], dtype=src.dtype)
    return out.index_add_(0, seg, src)
def _pad(x, pw):
    flat = tuple(v for pair in reversed(pw) for v in pair)
    return torch.nn.functional.pad(x, flat)

kernel_name = 'parallel_sum__linear_kernel_hedgehog__glu_gated_reglu__prompt'

def setup_inputs():

    _w = (lambda a: (lambda t: t.to(torch.bfloat16) if t.is_floating_point() else t)(torch.as_tensor(a)))
    def _A_setup():
        B, S, D, H = 1, 2048, 640, 32
        Dh = D // H
        return {
            "x": _w((lambda *s: torch.randn(*s, dtype=torch.bfloat16) * 0.05)(B, S, D)),
            "wqkv": _w((lambda *s: torch.randn(*s, dtype=torch.bfloat16) * 0.2)(D, 3 * D)),
            "w_phi": _w((lambda *s: torch.randn(*s, dtype=torch.bfloat16) * 0.2)(H, Dh, Dh) * (Dh ** -0.5)),
            "wo": _w((lambda *s: torch.randn(*s, dtype=torch.bfloat16) * 0.05)(D, D)),
        }
    _A_in = _A_setup()

    def _B_setup():
        B, S, D, F = 1, 2048, 640, 1728
        return {
            "x": _w((lambda *s: torch.randn(*s, dtype=torch.bfloat16) * 0.05)(B, S, D)),
            "W_gate": _w((lambda *s: torch.randn(*s, dtype=torch.bfloat16) * 0.4)(D, F) * (2.0 / D) ** 0.5),
            "W_up": _w((lambda *s: torch.randn(*s, dtype=torch.bfloat16) * 0.4)(D, F) * (2.0 / D) ** 0.5),
            "W_down": _w((lambda *s: torch.randn(*s, dtype=torch.bfloat16) * 0.4)(F, D) * (1.0 / F) ** 0.5),
        }
    _B_in = _B_setup()

    return {
        "A_x": _A_in["x"],
        "A_wqkv": _A_in["wqkv"],
        "A_w_phi": _A_in["w_phi"],
        "A_wo": _A_in["wo"],
        "B_x": _B_in["x"],
        "B_W_gate": _B_in["W_gate"],
        "B_W_up": _B_in["W_up"],
        "B_W_down": _B_in["W_down"],
    }

def reference(A_x, A_wqkv, A_w_phi, A_wo, B_x, B_W_gate, B_W_up, B_W_down):
    def _A_ref(x, wqkv, w_phi, wo):
        B, S, D = x.shape
        H = 32; Dh = D // H
        qkv = (lambda x, *d: x.permute(*d))((x @ wqkv).reshape(B, S, 3, H, Dh), 2, 0, 3, 1, 4)
        q, k, v = qkv[0], qkv[1], qkv[2]
        pq = torch.einsum("bhsd,hdf->bhsf", q, w_phi)
        pk = torch.einsum("bhsd,hdf->bhsf", k, w_phi)
        phi_q = torch.concatenate([_softmax(pq, axis=-1), _softmax(-pq, axis=-1)], axis=-1)
        phi_k = torch.concatenate([_softmax(pk, axis=-1), _softmax(-pk, axis=-1)], axis=-1)
        kv = torch.einsum("bhsf,bhsd->bhfd", phi_k, v)
        z  = torch.einsum("bhsf->bhf", phi_k)
        num = torch.einsum("bhqf,bhfd->bhqd", phi_q, kv)
        den = torch.einsum("bhqf,bhf->bhq", phi_q, z)[..., None] + 1e-6
        o = num / den
        return (lambda x, *d: x.permute(*d))(o, 0, 2, 1, 3).reshape(B, S, D) @ wo

    def _B_ref(x, W_gate, W_up, W_down):
        gate = torch.einsum("bsd,df->bsf", x, W_gate)
        up = torch.einsum("bsd,df->bsf", x, W_up)
        gate = gate * (lambda x, dt: x.to(dt))(gate > 0, gate.dtype)
        h = gate * up
        return torch.einsum("bsf,fd->bsd", h, W_down)

    x = A_x
    xn = _layernorm(x, axis=-1)
    return x + _A_ref(xn, A_wqkv, A_w_phi, A_wo) + _B_ref(xn, B_W_gate, B_W_up, B_W_down)
```

```asm
; @launch grid=(256,1,1) block=(256,1,1) lds=163840
.amdgcn_target "amdgcn-amd-amdhsa--gfx950"
.text
.globl parallel_sum__linear_kernel_hedgehog__glu_gated_reglu__prompt_kernel
.p2align 8
.type parallel_sum__linear_kernel_hedgehog__glu_gated_reglu__prompt_kernel,@function
parallel_sum__linear_kernel_hedgehog__glu_gated_reglu__prompt_kernel:
    s_cmp_ge_u32 s2, 256
    s_cbranch_scc1 L_end
    s_load_dwordx16 s[16:31], s[0:1], 0
    s_load_dwordx4 s[32:35], s[0:1], 64
    s_load_dwordx2 s[36:37], s[0:1], 80
    s_getpc_b64 s[4:5]
L_pc:
    s_lshr_b32 s3, s2, 3
    s_lshl_b32 s3, s3, 9
    v_lshrrev_b32 v33, 6, v0
    v_lshl_add_u32 v33, v33, 7, s3
    v_and_b32 v34, 63, v0
    v_lshl_add_u32 v32, v34, 14, v33
    s_mov_b32 s3, L_att-L_pc-49152
    v_cmp_le_u32 vcc, 3, v34
    v_lshl_add_u32 v35, v34, 14, v33
    v_add_u32 v35, s3, v35
    v_cndmask_b32 v32, v32, v35, vcc
    s_mov_b32 s6, L_code_end-L_pc
    s_mov_b32 s7, 0x00020000
    v_cmp_le_u32 vcc, 6, v34
    v_mov_b32 v35, 0x40000000
    s_nop 0
    v_cndmask_b32 v32, v32, v35, vcc
    buffer_load_dword v5, v32, s[4:7], 0 offen
    v_and_b32 v1, 63, v0
    v_lshrrev_b32 v32, 6, v0
    v_lshrrev_b32 v33, 3, v1
    v_readfirstlane_b32 s38, v32
    v_and_b32 v34, 7, v1
    v_lshrrev_b32 v35, 1, v33
    v_xor_b32 v34, v34, v35
    v_mul_u32_u24 v33, 1280, v33
    v_xor_b32 v35, 0, v34
    v_lshl_add_u32 v35, v35, 4, v33
    v_add_u32 v8, 0, v35
    v_xor_b32 v35, 4, v34
    v_lshl_add_u32 v35, v35, 4, v33
    v_add_u32 v9, 9216, v35
    v_xor_b32 v35, 0, v34
    v_lshl_add_u32 v35, v35, 4, v33
    v_add_u32 v10, 18432, v35
    v_xor_b32 v35, 4, v34
    v_lshl_add_u32 v35, v35, 4, v33
    v_add_u32 v11, 27648, v35
    s_and_b32 s41, s2, 7
    s_lshr_b32 s42, s2, 3
    s_and_b32 s39, s41, 1
    s_lshl_b32 s39, s39, 3
    s_and_b32 s40, s42, 7
    s_add_u32 s39, s39, s40
    s_lshr_b32 s40, s41, 1
    s_lshl_b32 s40, s40, 2
    s_lshr_b32 s42, s42, 3
    s_add_u32 s40, s40, s42
    s_and_b32 s41, s40, 3
    s_mul_i32 s41, s41, 5
    s_lshr_b32 s41, s41, 1
    s_lshr_b32 s42, s40, 2
    s_add_u32 s41, s41, s42
    s_add_u32 s41, s41, s39
    s_sub_u32 s42, s41, 10
    s_cmp_ge_u32 s41, 10
    s_cselect_b32 s41, s42, s41
    s_sub_u32 s42, s41, 10
    s_cmp_ge_u32 s41, 10
    s_cselect_b32 s41, s42, s41
    s_lshl_b32 s76, s41, 7
    s_lshl_b32 s41, s39, 2
    s_add_u32 s41, s41, s38
    s_mul_i32 s42, s41, 40960
    s_lshl_b32 s43, s38, 12
    s_cmp_eq_u32 s38, 0
    s_cselect_b32 s73, 0, 0x40000000
    s_waitcnt lgkmcnt(0)
    s_add_u32 s44, s16, s42
    s_addc_u32 s45, s17, 0
    s_mov_b32 s46, 40960
    s_mov_b32 s47, 0x00020000
    s_cmp_eq_u32 s39, 0
    s_cbranch_scc1 L_zs
L_zs_ret:
    s_nop 0
    s_add_u32 m0, s43, 98304
    s_nop 0
    buffer_load_dwordx4 v8, s[44:47], s76 offen offset:0 lds
    buffer_load_dwordx4 v9, s[44:47], s76 offen offset:1024 lds
    buffer_load_dwordx4 v10, s[44:47], s76 offen offset:2048 lds
    buffer_load_dwordx4 v11, s[44:47], s76 offen offset:3072 lds
    v_and_b32 v2, 31, v1
    v_lshrrev_b32 v3, 5, v1
    s_lshr_b32 s10, s40, 2
    s_lshl_b32 s10, s10, 1
    s_and_b32 s41, s40, 1
    s_add_u32 s10, s10, s41
    s_add_u32 s77, s76, 128
    s_cmp_eq_u32 s77, 1280
    s_cselect_b32 s77, 0, s77
    s_and_b32 s41, s40, 2
    s_cmp_eq_u32 s41, 0
    s_cbranch_scc1 L_att
    s_cmp_lt_u32 s38, 2
    s_cselect_b32 s48, s26, s28
    s_cselect_b32 s49, s27, s29
    s_cselect_b32 s52, s26, s28
    s_cselect_b32 s53, s27, s29
    s_mov_b32 s50, 2211840
    s_mov_b32 s51, 0x00020000
    v_lshrrev_b32 v32, 3, v1
    v_and_b32 v33, 7, v1
    v_bfe_u32 v34, v32, 1, 1
    v_lshlrev_b32 v34, 2, v34
    v_xor_b32 v33, v33, v34
    s_and_b32 s41, s38, 1
    s_lshl_b32 s41, s41, 3
    v_add_u32 v32, s41, v32
    v_mul_u32_u24 v32, 3456, v32
    v_lshl_add_u32 v32, v33, 4, v32
    s_mul_i32 s41, s10, 384
    v_add_u32 v32, s41, v32
    v_add_u32 v16, 0, v32
    v_add_u32 v17, 54272, v32
    v_add_u32 v18, 108544, v32
    v_add_u32 v19, 162816, v32
    s_mul_i32 s9, s76, 1728
    s_add_u32 m0, s43, 0
    s_add_u32 s9, s9, 0
    buffer_load_dwordx4 v16, s[48:51], s9 offen offset:0 lds
    buffer_load_dwordx4 v17, s[48:51], s9 offen offset:1024 lds
    buffer_load_dwordx4 v18, s[48:51], s9 offen offset:2048 lds
    buffer_load_dwordx4 v19, s[48:51], s9 offen offset:3072 lds
    s_add_u32 s78, s77, 128
    s_cmp_eq_u32 s78, 1280
    s_cselect_b32 s78, 0, s78
    s_add_u32 s79, s78, 128
    s_cmp_eq_u32 s79, 1280
    s_cselect_b32 s79, 0, s79
    s_add_u32 s80, s79, 128
    s_cmp_eq_u32 s80, 1280
    s_cselect_b32 s80, 0, s80
    s_add_u32 s81, s80, 128
    s_cmp_eq_u32 s81, 1280
    s_cselect_b32 s81, 0, s81
    s_add_u32 s82, s81, 128
    s_cmp_eq_u32 s82, 1280
    s_cselect_b32 s82, 0, s82
    s_add_u32 s83, s82, 128
    s_cmp_eq_u32 s83, 1280
    s_cselect_b32 s83, 0, s83
    s_add_u32 s84, s83, 128
    s_cmp_eq_u32 s84, 1280
    s_cselect_b32 s84, 0, s84
    s_add_u32 s85, s84, 128
    s_cmp_eq_u32 s85, 1280
    s_cselect_b32 s85, 0, s85
    v_lshrrev_b32 v32, 1, v2
    v_and_b32 v32, 7, v32
    v_xor_b32 v32, v3, v32
    v_lshlrev_b32 v33, 7, v2
    v_add_u32 v33, s43, v33
    v_add_u32 v33, 0x10000, v33
    v_xor_b32 v34, 0, v32
    v_lshl_add_u32 v12, v34, 4, v33
    v_xor_b32 v34, 2, v32
    v_lshl_add_u32 v13, v34, 4, v33
    v_xor_b32 v34, 4, v32
    v_lshl_add_u32 v14, v34, 4, v33
    v_xor_b32 v34, 6, v32
    v_lshl_add_u32 v15, v34, 4, v33
    v_xor_b32 v56, 4096, v12
    v_xor_b32 v57, 4096, v13
    v_xor_b32 v58, 4096, v14
    v_xor_b32 v59, 4096, v15
    s_and_b32 s41, s38, 1
    s_lshl_b32 s74, s41, 14
    s_mul_i32 s75, s41, 151552
    s_lshl_b32 s42, s41, 11
    s_lshl_b32 s70, s10, 12
    s_add_u32 s70, s70, s42
    s_sub_u32 s71, s70, s75
    s_add_u32 s71, s71, 151552
    s_add_u32 s70, s70, s75
    s_mov_b32 s11, 0xffff0000
    s_mul_i32 s3, s38, 5120
    v_lshrrev_b32 v32, 5, v1
    v_lshlrev_b32 v32, 12, v32
    v_bfe_u32 v33, v1, 2, 2
    v_lshl_add_u32 v32, v33, 7, v32
    v_bfe_u32 v34, v1, 4, 1
    v_lshl_add_u32 v32, v34, 5, v32
    v_and_b32 v34, 3, v1
    v_lshl_add_u32 v32, v34, 3, v32
    v_lshrrev_b32 v33, 1, v33
    v_lshlrev_b32 v33, 6, v33
    v_xor_b32 v34, 0, v33
    v_add_u32 v21, v32, v34
    v_add_u32 v36, v32, v34
    v_add_u32 v21, s74, v21
    v_add_u32 v22, 0x10000, v21
    v_add_u32 v23, 0x20000, v21
    v_xor_b32 v34, 64, v33
    v_add_u32 v24, v32, v34
    v_add_u32 v37, v32, v34
    v_add_u32 v24, s74, v24
    v_add_u32 v25, 0x10000, v24
    v_add_u32 v26, 0x20000, v24
    s_mov_b32 s15, 0x00020000
    s_cmp_eq_u32 s39, 0
    s_cbranch_scc1 L_zf_1
L_zf_1_ret:
    s_mul_i32 s9, s76, 1728
    s_add_u32 m0, s43, 16384
    s_add_u32 s9, s9, 128
    buffer_load_dwordx4 v16, s[48:51], s9 offen offset:0 lds
    buffer_load_dwordx4 v17, s[48:51], s9 offen offset:1024 lds
    buffer_load_dwordx4 v18, s[48:51], s9 offen offset:2048 lds
    buffer_load_dwordx4 v19, s[48:51], s9 offen offset:3072 lds
    s_lshl_b32 s92, s38, 11
    s_cmp_lt_u32 s10, 6
    s_cselect_b32 s54, 2211840, 0
    s_mov_b32 s55, 0x00020000
    v_lshrrev_b32 v32, 2, v1
    s_and_b32 s41, s38, 1
    s_lshl_b32 s41, s41, 5
    v_add_u32 v32, s41, v32
    v_mul_u32_u24 v32, 3456, v32
    v_and_b32 v33, 3, v1
    v_lshl_add_u32 v32, v33, 4, v32
    s_lshl_b32 s41, s10, 6
    s_add_u32 s41, s41, 3072
    v_add_u32 v20, s41, v32
    v_bfe_u32 v32, v1, 2, 2
    v_lshl_add_u32 v32, v3, 3, v32
    v_lshlrev_b32 v32, 6, v32
    v_bfe_u32 v33, v1, 4, 1
    v_lshl_add_u32 v32, v33, 5, v32
    v_and_b32 v33, 3, v1
    v_lshl_add_u32 v27, v33, 3, v32
    v_add_u32 v28, 0x10000, v27
    v_add_u32 v29, 0x20000, v27
    s_lshr_b32 s41, s38, 1
    s_lshl_b32 s41, s41, 13
    v_add_u32 v203, s41, v21
    v_add_u32 v204, s41, v24
    s_lshl_b32 s41, s38, 13
    s_add_u32 s41, s41, 131072
    s_cmp_ge_u32 s38, 2
    s_cselect_b64 vcc, -1, 0
    v_add_u32 v32, s41, v36
    v_add_u32 v32, 0, v32
    v_add_u32 v33, 147456, v27
    v_cndmask_b32 v60, v32, v33, vcc
    v_add_u32 v32, s41, v36
    v_add_u32 v32, 512, v32
    v_add_u32 v33, 147712, v27
    v_cndmask_b32 v61, v32, v33, vcc
    v_add_u32 v32, s41, v37
    v_add_u32 v32, 0, v32
    v_add_u32 v33, 151552, v27
    v_cndmask_b32 v62, v32, v33, vcc
    v_add_u32 v32, s41, v37
    v_add_u32 v32, 512, v32
    v_add_u32 v33, 151808, v27
    v_cndmask_b32 v63, v32, v33, vcc
    v_bfe_u32 v32, v1, 4, 1
    v_lshlrev_b32 v32, 2, v32
    v_and_b32 v33, 15, v1
    v_mov_b32 v34, 0x3f803f80
    v_mov_b32 v35, 0
    v_cmp_eq_u32 vcc, v32, v33
    s_nop 1
    v_cndmask_b32 v36, v35, v34, vcc
    v_accvgpr_write_b32 a240, v36
    v_accvgpr_write_b32 a241, v36
    v_accvgpr_write_b32 a242, v36
    v_accvgpr_write_b32 a243, v36
    v_add_u32 v32, 8, v32
    v_cmp_eq_u32 vcc, v32, v33
    s_nop 1
    v_cndmask_b32 v36, v35, v34, vcc
    v_accvgpr_write_b32 a244, v36
    v_accvgpr_write_b32 a245, v36
    v_accvgpr_write_b32 a246, v36
    v_accvgpr_write_b32 a247, v36
    v_lshrrev_b32 v32, 4, v2
    v_mul_u32_u24 v32, 75776, v32
    v_and_b32 v33, 15, v2
    v_lshl_add_u32 v33, v3, 4, v33
    v_lshl_add_u32 v6, v33, 4, v32
    s_lshl_b32 s41, s39, 2
    s_and_b32 s42, s38, 2
    s_add_u32 s41, s41, s42
    s_mul_i32 s41, s41, 151552
    s_add_u32 s56, s36, s41
    s_addc_u32 s57, s37, 0
    s_mov_b32 s58, 303104
    s_mov_b32 s59, 0x00020000
    s_add_u32 s60, s36, 25165824
    s_addc_u32 s61, s37, 0
    s_mov_b32 s62, 282624
    s_mov_b32 s63, 0x00020000
    s_and_b32 s86, s39, 11
    s_and_b32 s41, s40, 4
    s_add_u32 s86, s86, s41
    s_lshr_b32 s87, s40, 3
    s_lshl_b32 s87, s87, 2
    s_and_b32 s41, s40, 1
    s_lshl_b32 s41, s41, 1
    s_add_u32 s87, s87, s41
    s_bfe_u32 s41, s39, 0x10002
    s_add_u32 s87, s87, s41
    s_sub_u32 s64, s39, 11
    s_lshl_b32 s64, s64, 3
    s_add_u32 s64, s64, s10
    s_lshl_b32 s64, s64, 2
    s_add_u32 s64, s64, s38
    s_lshr_b32 s89, s64, 3
    s_and_b32 s65, s64, 7
    s_min_u32 s68, s89, 19
    s_mul_i32 s66, s65, 160
    s_add_u32 s4, s22, s66
    s_addc_u32 s5, s23, 0
    s_mov_b32 s7, 0x00020000
    s_cmp_lt_u32 s89, 20
    s_cselect_b32 s6, 818080, 0
    s_lshl_b32 s67, s68, 2
    v_add_u32 v32, 0, v1
    v_mul_u32_u24 v33, 6554, v32
    v_lshrrev_b32 v33, 16, v33
    v_mul_u32_u24 v34, 10, v33
    v_sub_u32 v32, v32, v34
    v_lshrrev_b32 v34, 3, v33
    v_add_u32 v34, s67, v34
    v_and_b32 v33, 7, v33
    v_mul_u32_u24 v35, 6554, v34
    v_lshrrev_b32 v35, 16, v35
    v_mul_u32_u24 v36, 10, v35
    v_sub_u32 v34, v34, v36
    v_mul_u32_u24 v35, 80, v35
    v_lshrrev_b32 v36, 1, v34
    v_mul_u32_u24 v36, 20, v36
    v_and_b32 v37, 1, v34
    v_lshl_add_u32 v36, v37, 2, v36
    v_lshrrev_b32 v37, 2, v33
    v_lshl_add_u32 v36, v37, 3, v36
    v_mul_u32_u24 v37, 20, v37
    v_subrev_u32 v38, 8, v34
    v_mul_u32_u24 v38, 40, v38
    v_add_u32 v37, v37, v38
    v_add_u32 v37, 16, v37
    v_cmp_gt_u32 vcc, 8, v34
    v_and_b32 v33, 3, v33
    s_nop 0
    v_cndmask_b32 v36, v37, v36, vcc
    v_add_u32 v35, v35, v33
    v_add_u32 v35, v35, v36
    v_mul_u32_u24 v35, 1280, v35
    v_lshl_add_u32 v35, v32, 4, v35
    v_subrev_u32 v192, 0, v35
    v_add_u32 v32, 64, v1
    v_mul_u32_u24 v33, 6554, v32
    v_lshrrev_b32 v33, 16, v33
    v_mul_u32_u24 v34, 10, v33
    v_sub_u32 v32, v32, v34
    v_lshrrev_b32 v34, 3, v33
    v_add_u32 v34, s67, v34
    v_and_b32 v33, 7, v33
    v_mul_u32_u24 v35, 6554, v34
    v_lshrrev_b32 v35, 16, v35
    v_mul_u32_u24 v36, 10, v35
    v_sub_u32 v34, v34, v36
    v_mul_u32_u24 v35, 80, v35
    v_lshrrev_b32 v36, 1, v34
    v_mul_u32_u24 v36, 20, v36
    v_and_b32 v37, 1, v34
    v_lshl_add_u32 v36, v37, 2, v36
    v_lshrrev_b32 v37, 2, v33
    v_lshl_add_u32 v36, v37, 3, v36
    v_mul_u32_u24 v37, 20, v37
    v_subrev_u32 v38, 8, v34
    v_mul_u32_u24 v38, 40, v38
    v_add_u32 v37, v37, v38
    v_add_u32 v37, 16, v37
    v_cmp_gt_u32 vcc, 8, v34
    v_and_b32 v33, 3, v33
    s_nop 0
    v_cndmask_b32 v36, v37, v36, vcc
    v_add_u32 v35, v35, v33
    v_add_u32 v35, v35, v36
    v_mul_u32_u24 v35, 1280, v35
    v_lshl_add_u32 v35, v32, 4, v35
    v_subrev_u32 v193, 1024, v35
    v_add_u32 v32, 128, v1
    v_mul_u32_u24 v33, 6554, v32
    v_lshrrev_b32 v33, 16, v33
    v_mul_u32_u24 v34, 10, v33
    v_sub_u32 v32, v32, v34
    v_lshrrev_b32 v34, 3, v33
    v_add_u32 v34, s67, v34
    v_and_b32 v33, 7, v33
    v_mul_u32_u24 v35, 6554, v34
    v_lshrrev_b32 v35, 16, v35
    v_mul_u32_u24 v36, 10, v35
    v_sub_u32 v34, v34, v36
    v_mul_u32_u24 v35, 80, v35
    v_lshrrev_b32 v36, 1, v34
    v_mul_u32_u24 v36, 20, v36
    v_and_b32 v37, 1, v34
    v_lshl_add_u32 v36, v37, 2, v36
    v_lshrrev_b32 v37, 2, v33
    v_lshl_add_u32 v36, v37, 3, v36
    v_mul_u32_u24 v37, 20, v37
    v_subrev_u32 v38, 8, v34
    v_mul_u32_u24 v38, 40, v38
    v_add_u32 v37, v37, v38
    v_add_u32 v37, 16, v37
    v_cmp_gt_u32 vcc, 8, v34
    v_and_b32 v33, 3, v33
    s_nop 0
    v_cndmask_b32 v36, v37, v36, vcc
    v_add_u32 v35, v35, v33
    v_add_u32 v35, v35, v36
    v_mul_u32_u24 v35, 1280, v35
    v_lshl_add_u32 v35, v32, 4, v35
    v_subrev_u32 v194, 2048, v35
    v_add_u32 v32, 192, v1
    v_mul_u32_u24 v33, 6554, v32
    v_lshrrev_b32 v33, 16, v33
    v_mul_u32_u24 v34, 10, v33
    v_sub_u32 v32, v32, v34
    v_lshrrev_b32 v34, 3, v33
    v_add_u32 v34, s67, v34
    v_and_b32 v33, 7, v33
    v_mul_u32_u24 v35, 6554, v34
    v_lshrrev_b32 v35, 16, v35
    v_mul_u32_u24 v36, 10, v35
    v_sub_u32 v34, v34, v36
    v_mul_u32_u24 v35, 80, v35
    v_lshrrev_b32 v36, 1, v34
    v_mul_u32_u24 v36, 20, v36
    v_and_b32 v37, 1, v34
    v_lshl_add_u32 v36, v37, 2, v36
    v_lshrrev_b32 v37, 2, v33
    v_lshl_add_u32 v36, v37, 3, v36
    v_mul_u32_u24 v37, 20, v37
    v_subrev_u32 v38, 8, v34
    v_mul_u32_u24 v38, 40, v38
    v_add_u32 v37, v37, v38
    v_add_u32 v37, 16, v37
    v_cmp_gt_u32 vcc, 8, v34
    v_and_b32 v33, 3, v33
    s_nop 0
    v_cndmask_b32 v36, v37, v36, vcc
    v_add_u32 v35, v35, v33
    v_add_u32 v35, v35, v36
    v_mul_u32_u24 v35, 1280, v35
    v_lshl_add_u32 v35, v32, 4, v35
    v_subrev_u32 v195, 3072, v35
    v_add_u32 v32, 256, v1
    v_mul_u32_u24 v33, 6554, v32
    v_lshrrev_b32 v33, 16, v33
    v_mul_u32_u24 v34, 10, v33
    v_sub_u32 v32, v32, v34
    v_lshrrev_b32 v34, 3, v33
    v_add_u32 v34, s67, v34
    v_and_b32 v33, 7, v33
    v_mul_u32_u24 v35, 6554, v34
    v_lshrrev_b32 v35, 16, v35
    v_mul_u32_u24 v36, 10, v35
    v_sub_u32 v34, v34, v36
    v_mul_u32_u24 v35, 80, v35
    v_lshrrev_b32 v36, 1, v34
    v_mul_u32_u24 v36, 20, v36
    v_and_b32 v37, 1, v34
    v_lshl_add_u32 v36, v37, 2, v36
    v_lshrrev_b32 v37, 2, v33
    v_lshl_add_u32 v36, v37, 3, v36
    v_mul_u32_u24 v37, 20, v37
    v_subrev_u32 v38, 8, v34
    v_mul_u32_u24 v38, 40, v38
    v_add_u32 v37, v37, v38
    v_add_u32 v37, 16, v37
    v_cmp_gt_u32 vcc, 8, v34
    v_and_b32 v33, 3, v33
    s_nop 0
    v_cndmask_b32 v36, v37, v36, vcc
    v_add_u32 v35, v35, v33
    v_add_u32 v35, v35, v36
    v_mul_u32_u24 v35, 1280, v35
    v_lshl_add_u32 v35, v32, 4, v35
    v_subrev_u32 v196, 0, v35
    s_mul_i32 s65, s65, 74
    s_add_u32 s65, s65, s68
    s_add_u32 s65, s65, 54
    s_mul_i32 s65, s65, 5120
    s_add_u32 s65, s65, 10485760
    s_add_u32 s90, s36, s65
    s_addc_u32 s91, s37, 0
    s_and_b32 s65, s87, 1
    s_mul_i32 s24, s65, 10
    s_add_u32 s24, s24, 12
    s_mul_i32 s25, s65, 10
    s_add_u32 s25, s25, 32
    s_lshr_b32 s26, s38, 1
    s_mul_i32 s26, s26, 5120
    s_and_b32 s65, s38, 1
    s_mul_i32 s65, s65, 378880
    s_add_u32 s26, s26, s65
    s_and_b32 s64, s87, 6
    s_mul_i32 s64, s64, 378880
    s_add_u32 s64, s64, 10485760
    s_add_u32 s16, s36, s64
    s_addc_u32 s17, s37, 0
    s_mov_b32 s18, 757760
    s_mov_b32 s19, 0x00020000
    s_lshl_b32 s64, s86, 2
    s_add_u32 s64, s64, s38
    s_mul_i32 s64, s64, 151552
    s_add_u32 s20, s36, s64
    s_addc_u32 s21, s37, 0
    s_mov_b32 s22, 151552
    s_mov_b32 s23, 0x00020000
    s_add_u32 s88, s87, s86
    s_mul_i32 s69, s88, 52
    s_lshr_b32 s69, s69, 8
    s_mul_i32 s69, s69, 5
    s_sub_u32 s88, s88, s69
    s_add_u32 s72, s87, s86
    s_mul_i32 s69, s72, 52
    s_lshr_b32 s69, s69, 8
    s_mul_i32 s69, s69, 5
    s_sub_u32 s72, s72, s69
    s_lshl_b32 s64, s39, 2
    s_add_u32 s64, s64, s38
    s_lshl_b32 s64, s64, 8
    s_add_u32 s64, s64, 69632
    s_lshr_b32 s65, 0x0aff, s40
    s_and_b32 s65, s65, 1
    s_cmp_eq_u32 s65, 1
    s_cselect_b32 s64, s64, 0x40000000
    v_lshlrev_b32 v199, 3, v2
    v_lshl_add_u32 v199, v3, 2, v199
    v_add_u32 v199, s64, v199
    s_lshl_b32 s64, s40, 11
    s_add_u32 s64, s64, 86016
    s_lshr_b32 s65, s74, 5
    s_add_u32 s64, s64, s65
    s_lshr_b32 s65, s38, 1
    s_lshl_b32 s65, s65, 8
    s_add_u32 s64, s64, s65
    s_cmp_lt_u32 s39, 10
    s_cselect_b32 s64, s64, 0x40000000
    v_lshlrev_b32 v200, 2, v1
    v_add_u32 v200, s64, v200
    s_lshl_b32 s64, s39, 12
    s_lshr_b32 s65, 0x0aff, s40
    s_and_b32 s65, s65, 1
    s_cmp_eq_u32 s65, 1
    s_cselect_b32 s64, s64, 0x40000000
    s_lshl_b32 s65, s40, 8
    s_add_u32 s65, s65, 65536
    s_cmp_lt_u32 s39, 10
    s_cselect_b32 s65, s65, 0x40000000
    s_cmp_eq_u32 s38, 0
    s_cselect_b32 s64, s64, 0x40000000
    s_cselect_b32 s65, s65, 0x40000000
    v_mov_b32 v201, 0x40000000
    v_writelane_b32 v201, s64, 0
    v_writelane_b32 v201, s65, 1
    s_cmp_lt_u32 s89, 20
    s_cselect_b32 s64, 0, 0x40000000
    s_or_b32 s64, s64, s73
    s_and_b32 s65, s10, 3
    s_lshl_b32 s65, s65, 7
    s_add_u32 s64, s64, s65
    v_lshlrev_b32 v205, 12, v1
    v_add_u32 v205, 3328, v205
    v_cmp_gt_u32 vcc, 16, v1
    v_mov_b32 v206, 0x40000000
    s_nop 0
    v_cndmask_b32 v205, v206, v205, vcc
    v_add_u32 v205, s64, v205
    v_lshrrev_b32 v220, 4, v1
    v_lshlrev_b32 v220, 3, v220
    v_bfe_u32 v221, v1, 2, 2
    v_add_u32 v220, v220, v221
    v_mul_u32_u24 v220, 160, v220
    v_and_b32 v221, 3, v1
    v_lshl_add_u32 v220, v221, 3, v220
    v_add_u32 v220, s3, v220
    v_add_u32 v220, 131072, v220
    v_lshlrev_b32 v221, 4, v1
    v_mov_b32 v202, 1
    v_and_b32 v30, 15, v1
    v_lshlrev_b32 v30, 2, v30
    v_mov_b32 v31, 1
    s_add_u32 s96, s34, 0
    s_addc_u32 s97, s35, 0
    s_mov_b32 s98, 64
    s_mov_b32 s99, 0x00020000
    s_add_u32 m0, s43, 114688
    s_nop 0
    buffer_load_dwordx4 v8, s[44:47], s77 offen offset:0 lds
    buffer_load_dwordx4 v9, s[44:47], s77 offen offset:1024 lds
    buffer_load_dwordx4 v10, s[44:47], s77 offen offset:2048 lds
    buffer_load_dwordx4 v11, s[44:47], s77 offen offset:3072 lds
    s_mul_i32 s9, s77, 1728
    s_add_u32 m0, s43, 32768
    s_add_u32 s9, s9, 0
    buffer_load_dwordx4 v16, s[48:51], s9 offen offset:0 lds
    buffer_load_dwordx4 v17, s[48:51], s9 offen offset:1024 lds
    buffer_load_dwordx4 v18, s[48:51], s9 offen offset:2048 lds
    buffer_load_dwordx4 v19, s[48:51], s9 offen offset:3072 lds
    s_waitcnt vmcnt(8)
    s_barrier
    ds_read_b128 a[0:3], v12 offset:32768
    ds_read_b128 a[176:179], v56 offset:32768
    ds_read_b64_tr_b16 a[160:161], v21 offset:0
    ds_read_b64_tr_b16 a[162:163], v21 offset:512
    ds_read_b64_tr_b16 a[164:165], v24 offset:0
    ds_read_b64_tr_b16 a[166:167], v24 offset:512
    ds_read_b64_tr_b16 a[168:169], v21 offset:8192
    ds_read_b64_tr_b16 a[170:171], v21 offset:8704
    ds_read_b64_tr_b16 a[172:173], v24 offset:8192
    ds_read_b64_tr_b16 a[174:175], v24 offset:8704
    s_waitcnt lgkmcnt(4)
    v_mfma_f32_32x32x16_bf16 v[64:79], a[160:163], a[0:3], 0
    ds_read_b128 v[40:43], v12 offset:32768
    ds_read_b128 a[4:7], v13 offset:32768
    ds_read_b128 a[180:183], v57 offset:32768
    v_mfma_f32_32x32x16_bf16 v[128:143], a[160:163], a[176:179], 0
    ds_read_b128 v[44:47], v13 offset:32768
    ds_read_b64_tr_b16 a[184:185], v21 offset:1024
    ds_read_b64_tr_b16 a[186:187], v21 offset:1536
    s_mul_i32 s9, s77, 1728
    s_add_u32 m0, s43, 49152
    s_add_u32 s9, s9, 128
    buffer_load_dwordx4 v16, s[48:51], s9 offen offset:0 lds
    v_mfma_f32_32x32x16_bf16 v[80:95], a[164:167], a[0:3], 0
    ds_read_b128 v[48:51], v14 offset:32768
    ds_read_b128 a[8:11], v14 offset:32768
    ds_read_b128 a[200:203], v58 offset:32768
    v_mfma_f32_32x32x16_bf16 v[144:159], a[164:167], a[176:179], 0
    ds_read_b128 v[52:55], v15 offset:32768
    ds_read_b64_tr_b16 a[188:189], v24 offset:1024
    s_waitcnt lgkmcnt(14)
    ds_read_b64_tr_b16 a[190:191], v24 offset:1536
    buffer_load_dwordx4 v17, s[48:51], s9 offen offset:1024 lds
    s_waitcnt lgkmcnt(12)
    v_mfma_f32_32x32x16_bf16 v[96:111], a[168:171], a[0:3], 0
    ds_read_b128 a[12:15], v15 offset:32768
    ds_read_b128 a[204:207], v59 offset:32768
    ds_read_b64_tr_b16 v[208:209], v203 offset:0
    s_waitcnt lgkmcnt(14)
    ds_read_b64_tr_b16 v[210:211], v203 offset:512
    s_waitcnt lgkmcnt(14)
    ds_read_b64_tr_b16 v[212:213], v204 offset:0
    s_waitcnt lgkmcnt(14)
    ds_read_b64_tr_b16 v[214:215], v204 offset:512
    v_mfma_f32_32x32x16_bf16 v[160:175], a[168:171], a[176:179], 0
    s_waitcnt lgkmcnt(14)
    ds_read_b64_tr_b16 a[192:193], v21 offset:9216
    s_waitcnt lgkmcnt(14)
    ds_read_b64_tr_b16 a[194:195], v21 offset:9728
    buffer_load_dwordx4 v18, s[48:51], s9 offen offset:2048 lds
    v_mfma_f32_32x32x16_bf16 v[112:127], a[172:175], a[0:3], 0
    s_waitcnt lgkmcnt(14)
    ds_read_b64_tr_b16 a[196:197], v24 offset:9216
    s_waitcnt lgkmcnt(14)
    ds_read_b64_tr_b16 a[198:199], v24 offset:9728
    s_waitcnt lgkmcnt(6)
    v_mfma_f32_16x16x32_bf16 v[216:219], a[240:243], v[208:211], 0
    buffer_load_dwordx4 v19, s[48:51], s9 offen offset:3072 lds
    v_mfma_f32_32x32x16_bf16 v[176:191], a[172:175], a[176:179], 0
    s_waitcnt lgkmcnt(4)
    v_mfma_f32_16x16x32_bf16 v[216:219], a[244:247], v[212:215], v[216:219]
    s_mul_i32 s9, s78, 1728
    s_add_u32 m0, s43, 65536
    s_add_u32 s9, s9, 0
    buffer_load_dwordx4 v16, s[48:51], s9 offen offset:0 lds
    v_mfma_f32_32x32x16_bf16 v[64:79], a[184:187], a[4:7], v[64:79]
    ds_read_b64_tr_b16 a[160:161], v21 offset:2048
    ds_read_b64_tr_b16 a[162:163], v21 offset:2560
    v_mov_b32 v36, 0
    v_mov_b32 v37, 0
    v_mov_b32 v38, 0
    v_mfma_f32_32x32x16_bf16 v[128:143], a[184:187], a[180:183], v[128:143]
    s_barrier
    v_mov_b32 v39, 0
    s_add_u32 m0, s43, 98304
    v_lshlrev_b32 v32, 16, v40
    buffer_load_dwordx4 v8, s[44:47], s78 offen offset:0 lds
    v_mfma_f32_32x32x16_bf16 v[80:95], a[188:191], a[4:7], v[80:95]
    ds_read_b64_tr_b16 a[164:165], v24 offset:2048
    ds_read_b64_tr_b16 a[166:167], v24 offset:2560
    ds_read_b64_tr_b16 v[208:209], v203 offset:1024
    ds_read_b64_tr_b16 v[210:211], v203 offset:1536
    ds_read_b64_tr_b16 v[212:213], v204 offset:1024
    ds_read_b64_tr_b16 v[214:215], v204 offset:1536
    v_and_b32 v33, s11, v40
    v_mfma_f32_32x32x16_bf16 v[144:159], a[188:191], a[180:183], v[144:159]
    v_add_f32 v36, v36, v32
    v_add_f32 v37, v37, v33
    v_fmac_f32 v38, v32, v32
    v_fmac_f32 v39, v33, v33
    buffer_load_dwordx4 v9, s[44:47], s78 offen offset:1024 lds
    s_waitcnt lgkmcnt(8)
    v_mfma_f32_32x32x16_bf16 v[96:111], a[192:195], a[4:7], v[96:111]
    ds_read_b64_tr_b16 a[168:169], v21 offset:10240
    ds_read_b64_tr_b16 a[170:171], v21 offset:10752
    buffer_load_dwordx4 v10, s[44:47], s78 offen offset:2048 lds
    v_mfma_f32_32x32x16_bf16 v[160:175], a[192:195], a[180:183], v[160:175]
    s_waitcnt lgkmcnt(4)
    v_mfma_f32_16x16x32_bf16 v[216:219], a[240:243], v[208:211], v[216:219]
    s_waitcnt lgkmcnt(2)
    v_mfma_f32_16x16x32_bf16 v[216:219], a[244:247], v[212:215], v[216:219]
    buffer_load_dwordx4 v11, s[44:47], s78 offen offset:3072 lds
    v_mfma_f32_32x32x16_bf16 v[112:127], a[196:199], a[4:7], v[112:127]
    ds_read_b64_tr_b16 a[172:173], v24 offset:10240
    ds_read_b64_tr_b16 a[174:175], v24 offset:10752
    v_lshlrev_b32 v34, 16, v41
    s_add_u32 m0, s43, 65536
    v_and_b32 v35, s11, v41
    buffer_load_dwordx4 v17, s[48:51], s9 offen offset:1024 lds
    v_mfma_f32_32x32x16_bf16 v[176:191], a[196:199], a[180:183], v[176:191]
    v_add_f32 v36, v36, v34
    v_add_f32 v37, v37, v35
    v_fmac_f32 v38, v34, v34
    v_fmac_f32 v39, v35, v35
    buffer_load_dwordx4 v18, s[48:51], s9 offen offset:2048 lds
    v_mfma_f32_32x32x16_bf16 v[64:79], a[160:163], a[8:11], v[64:79]
    ds_read_b64_tr_b16 a[184:185], v21 offset:3072
    ds_read_b64_tr_b16 a[186:187], v21 offset:3584
    v_lshlrev_b32 v32, 16, v42
    buffer_load_dwordx4 v19, s[48:51], s9 offen offset:3072 lds
    v_mfma_f32_32x32x16_bf16 v[128:143], a[160:163], a[200:203], v[128:143]
    v_and_b32 v33, s11, v42
    v_add_f32 v36, v36, v32
    s_mul_i32 s9, s78, 1728
    s_add_u32 m0, s43, 81920
    s_add_u32 s9, s9, 128
    buffer_load_dwordx4 v16, s[48:51], s9 offen offset:0 lds
    v_mfma_f32_32x32x16_bf16 v[80:95], a[164:167], a[8:11], v[80:95]
    ds_read_b64_tr_b16 a[188:189], v24 offset:3072
    ds_read_b64_tr_b16 a[190:191], v24 offset:3584
    v_add_f32 v37, v37, v33
    buffer_load_dwordx4 v17, s[48:51], s9 offen offset:1024 lds
    v_mfma_f32_32x32x16_bf16 v[144:159], a[164:167], a[200:203], v[144:159]
    ds_read_b64_tr_b16 v[208:209], v203 offset:2048
    ds_read_b64_tr_b16 v[210:211], v203 offset:2560
    ds_read_b64_tr_b16 v[212:213], v204 offset:2048
    ds_read_b64_tr_b16 v[214:215], v204 offset:2560
    buffer_load_dwordx4 v18, s[48:51], s9 offen offset:2048 lds
    s_waitcnt lgkmcnt(8)
    v_mfma_f32_32x32x16_bf16 v[96:111], a[168:171], a[8:11], v[96:111]
    ds_read_b64_tr_b16 a[192:193], v21 offset:11264
    ds_read_b64_tr_b16 a[194:195], v21 offset:11776
    v_fmac_f32 v38, v32, v32
    v_fmac_f32 v39, v33, v33
    v_lshlrev_b32 v34, 16, v43
    v_and_b32 v35, s11, v43
    v_mfma_f32_32x32x16_bf16 v[160:175], a[168:171], a[200:203], v[160:175]
    v_add_f32 v36, v36, v34
    s_waitcnt lgkmcnt(4)
    v_mfma_f32_16x16x32_bf16 v[216:219], a[240:243], v[208:211], v[216:219]
    buffer_load_dwordx4 v19, s[48:51], s9 offen offset:3072 lds
    v_mfma_f32_32x32x16_bf16 v[112:127], a[172:175], a[8:11], v[112:127]
    ds_read_b64_tr_b16 a[196:197], v24 offset:11264
    ds_read_b64_tr_b16 a[198:199], v24 offset:11776
    s_waitcnt lgkmcnt(4)
    v_mfma_f32_16x16x32_bf16 v[216:219], a[244:247], v[212:215], v[216:219]
    v_add_f32 v37, v37, v35
    v_fmac_f32 v38, v34, v34
    v_fmac_f32 v39, v35, v35
    v_mfma_f32_32x32x16_bf16 v[176:191], a[172:175], a[200:203], v[176:191]
    v_lshlrev_b32 v32, 16, v44
    v_and_b32 v33, s11, v44
    v_add_f32 v36, v36, v32
    v_add_f32 v37, v37, v33
    v_fmac_f32 v38, v32, v32
    v_fmac_f32 v39, v33, v33
    v_lshlrev_b32 v34, 16, v45
    v_mfma_f32_32x32x16_bf16 v[64:79], a[184:187], a[12:15], v[64:79]
    ds_read_b64_tr_b16 v[208:209], v203 offset:3072
    ds_read_b64_tr_b16 v[210:211], v203 offset:3584
    ds_read_b64_tr_b16 v[212:213], v204 offset:3072
    ds_read_b64_tr_b16 v[214:215], v204 offset:3584
    v_and_b32 v35, s11, v45
    v_add_f32 v36, v36, v34
    v_mfma_f32_32x32x16_bf16 v[128:143], a[184:187], a[204:207], v[128:143]
    v_add_f32 v37, v37, v35
    v_fmac_f32 v38, v34, v34
    v_fmac_f32 v39, v35, v35
    s_waitcnt lgkmcnt(2)
    v_mfma_f32_16x16x32_bf16 v[216:219], a[240:243], v[208:211], v[216:219]
    s_waitcnt lgkmcnt(0)
    v_mfma_f32_16x16x32_bf16 v[216:219], a[244:247], v[212:215], v[216:219]
    s_waitcnt vmcnt(12)
    v_mfma_f32_32x32x16_bf16 v[80:95], a[188:191], a[12:15], v[80:95]
    s_barrier
    ds_read_b128 a[16:19], v12 offset:49152
    ds_read_b128 a[176:179], v56 offset:49152
    v_lshlrev_b32 v32, 16, v46
    v_mfma_f32_32x32x16_bf16 v[144:159], a[188:191], a[204:207], v[144:159]
    ds_read_b64_tr_b16 a[160:161], v21 offset:32768
    ds_read_b64_tr_b16 a[162:163], v21 offset:33280
    v_and_b32 v33, s11, v46
    v_add_f32 v36, v36, v32
    v_add_f32 v37, v37, v33
    v_mfma_f32_32x32x16_bf16 v[96:111], a[192:195], a[12:15], v[96:111]
    ds_read_b64_tr_b16 a[164:165], v24 offset:32768
    ds_read_b64_tr_b16 a[166:167], v24 offset:33280
    v_fmac_f32 v38, v32, v32
    v_fmac_f32 v39, v33, v33
    v_mfma_f32_32x32x16_bf16 v[160:175], a[192:195], a[204:207], v[160:175]
    ds_read_b64_tr_b16 a[168:169], v21 offset:40960
    ds_read_b64_tr_b16 a[170:171], v21 offset:41472
    v_lshlrev_b32 v34, 16, v47
    v_and_b32 v35, s11, v47
    v_add_f32 v36, v36, v34
    v_mfma_f32_32x32x16_bf16 v[112:127], a[196:199], a[12:15], v[112:127]
    ds_read_b64_tr_b16 a[172:173], v24 offset:40960
    ds_read_b64_tr_b16 a[174:175], v24 offset:41472
    v_add_f32 v37, v37, v35
    buffer_load_dword v197, v30, s[96:99], s73 offen sc1
    v_mfma_f32_32x32x16_bf16 v[176:191], a[196:199], a[204:207], v[176:191]
    s_mul_i32 s9, s79, 1728
    s_add_u32 m0, s43, 0
    s_add_u32 s9, s9, 0
    buffer_load_dwordx4 v16, s[48:51], s9 offen offset:0 lds
    s_waitcnt lgkmcnt(4)
    v_mfma_f32_32x32x16_bf16 v[64:79], a[160:163], a[16:19], v[64:79]
    ds_read_b128 a[20:23], v13 offset:49152
    ds_read_b128 a[180:183], v57 offset:49152
    v_fmac_f32 v38, v34, v34
    v_fmac_f32 v39, v35, v35
    v_mfma_f32_32x32x16_bf16 v[128:143], a[160:163], a[176:179], v[128:143]
    ds_read_b64_tr_b16 a[184:185], v21 offset:33792
    ds_read_b64_tr_b16 a[186:187], v21 offset:34304
    buffer_load_dwordx4 v17, s[48:51], s9 offen offset:1024 lds
    v_mfma_f32_32x32x16_bf16 v[80:95], a[164:167], a[16:19], v[80:95]
    ds_read_b128 a[24:27], v14 offset:49152
    ds_read_b128 a[200:203], v58 offset:49152
    v_lshlrev_b32 v32, 16, v48
    v_and_b32 v33, s11, v48
    v_add_f32 v36, v36, v32
    v_mfma_f32_32x32x16_bf16 v[144:159], a[164:167], a[176:179], v[144:159]
    ds_read_b64_tr_b16 a[188:189], v24 offset:33792
    ds_read_b64_tr_b16 a[190:191], v24 offset:34304
    buffer_load_dwordx4 v18, s[48:51], s9 offen offset:2048 lds
    s_waitcnt lgkmcnt(8)
    v_mfma_f32_32x32x16_bf16 v[96:111], a[168:171], a[16:19], v[96:111]
    ds_read_b128 a[28:31], v15 offset:49152
    ds_read_b128 a[204:207], v59 offset:49152
    v_add_f32 v37, v37, v33
    v_fmac_f32 v38, v32, v32
    v_mfma_f32_32x32x16_bf16 v[160:175], a[168:171], a[176:179], v[160:175]
    ds_read_b64_tr_b16 a[192:193], v21 offset:41984
    ds_read_b64_tr_b16 a[194:195], v21 offset:42496
    buffer_load_dwordx4 v19, s[48:51], s9 offen offset:3072 lds
    v_mfma_f32_32x32x16_bf16 v[112:127], a[172:175], a[16:19], v[112:127]
    ds_read_b64_tr_b16 a[196:197], v24 offset:41984
    ds_read_b64_tr_b16 a[198:199], v24 offset:42496
    s_mul_i32 s9, s79, 1728
    s_add_u32 m0, s43, 16384
    s_add_u32 s9, s9, 128
    buffer_load_dwordx4 v16, s[48:51], s9 offen offset:0 lds
    v_mfma_f32_32x32x16_bf16 v[176:191], a[172:175], a[176:179], v[176:191]
    v_fmac_f32 v39, v33, v33
    v_lshlrev_b32 v34, 16, v49
    buffer_load_dwordx4 v17, s[48:51], s9 offen offset:1024 lds
    s_waitcnt lgkmcnt(6)
    v_mfma_f32_32x32x16_bf16 v[64:79], a[184:187], a[20:23], v[64:79]
    ds_read_b64_tr_b16 a[160:161], v21 offset:34816
    ds_read_b64_tr_b16 a[162:163], v21 offset:35328
    v_and_b32 v35, s11, v49
    v_add_f32 v36, v36, v34
    s_waitcnt lgkmcnt(6)
    v_mfma_f32_32x32x16_bf16 v[128:143], a[184:187], a[180:183], v[128:143]
    s_barrier
    s_add_u32 m0, s43, 114688
    s_nop 0
    buffer_load_dwordx4 v8, s[44:47], s79 offen offset:0 lds
    v_mfma_f32_32x32x16_bf16 v[80:95], a[188:191], a[20:23], v[80:95]
    ds_read_b64_tr_b16 a[164:165], v24 offset:34816
    ds_read_b64_tr_b16 a[166:167], v24 offset:35328
    v_add_f32 v37, v37, v35
    v_fmac_f32 v38, v34, v34
    v_fmac_f32 v39, v35, v35
    v_mfma_f32_32x32x16_bf16 v[144:159], a[188:191], a[180:183], v[144:159]
    v_lshlrev_b32 v32, 16, v50
    v_and_b32 v33, s11, v50
    buffer_load_dwordx4 v9, s[44:47], s79 offen offset:1024 lds
    s_waitcnt lgkmcnt(4)
    v_mfma_f32_32x32x16_bf16 v[96:111], a[192:195], a[20:23], v[96:111]
    ds_read_b64_tr_b16 a[168:169], v21 offset:43008
    ds_read_b64_tr_b16 a[170:171], v21 offset:43520
    buffer_load_dwordx4 v10, s[44:47], s79 offen offset:2048 lds
    v_mfma_f32_32x32x16_bf16 v[160:175], a[192:195], a[180:183], v[160:175]
    v_add_f32 v36, v36, v32
    v_add_f32 v37, v37, v33
    buffer_load_dwordx4 v11, s[44:47], s79 offen offset:3072 lds
    v_mfma_f32_32x32x16_bf16 v[112:127], a[196:199], a[20:23], v[112:127]
    ds_read_b64_tr_b16 a[172:173], v24 offset:43008
    s_add_u32 m0, s43, 16384
    ds_read_b64_tr_b16 a[174:175], v24 offset:43520
    buffer_load_dwordx4 v18, s[48:51], s9 offen offset:2048 lds
    v_mfma_f32_32x32x16_bf16 v[176:191], a[196:199], a[180:183], v[176:191]
    v_fmac_f32 v38, v32, v32
    v_fmac_f32 v39, v33, v33
    buffer_load_dwordx4 v19, s[48:51], s9 offen offset:3072 lds
    s_waitcnt lgkmcnt(4)
    v_mfma_f32_32x32x16_bf16 v[64:79], a[160:163], a[24:27], v[64:79]
    ds_read_b64_tr_b16 a[184:185], v21 offset:35840
    ds_read_b64_tr_b16 a[186:187], v21 offset:36352
    v_lshlrev_b32 v34, 16, v51
    v_and_b32 v35, s11, v51
    v_mfma_f32_32x32x16_bf16 v[128:143], a[160:163], a[200:203], v[128:143]
    v_add_f32 v36, v36, v34
    v_add_f32 v37, v37, v35
    v_fmac_f32 v38, v34, v34
    v_fmac_f32 v39, v35, v35
    v_lshlrev_b32 v32, 16, v52
    v_mfma_f32_32x32x16_bf16 v[80:95], a[164:167], a[24:27], v[80:95]
    ds_read_b64_tr_b16 a[188:189], v24 offset:35840
    ds_read_b64_tr_b16 a[190:191], v24 offset:36352
    v_and_b32 v33, s11, v52
    v_add_f32 v36, v36, v32
    v_add_f32 v37, v37, v33
    v_mfma_f32_32x32x16_bf16 v[144:159], a[164:167], a[200:203], v[144:159]
    v_fmac_f32 v38, v32, v32
    v_fmac_f32 v39, v33, v33
    v_lshlrev_b32 v34, 16, v53
    v_and_b32 v35, s11, v53
    v_add_f32 v36, v36, v34
    s_waitcnt lgkmcnt(4)
    v_mfma_f32_32x32x16_bf16 v[96:111], a[168:171], a[24:27], v[96:111]
    ds_read_b64_tr_b16 a[192:193], v21 offset:44032
    ds_read_b64_tr_b16 a[194:195], v21 offset:44544
    v_add_f32 v37, v37, v35
    v_fmac_f32 v38, v34, v34
    v_mfma_f32_32x32x16_bf16 v[160:175], a[168:171], a[200:203], v[160:175]
    v_fmac_f32 v39, v35, v35
    v_lshlrev_b32 v32, 16, v54
    v_and_b32 v33, s11, v54
    v_add_f32 v36, v36, v32
    v_add_f32 v37, v37, v33
    v_mfma_f32_32x32x16_bf16 v[112:127], a[172:175], a[24:27], v[112:127]
    ds_read_b64_tr_b16 a[196:197], v24 offset:44032
    ds_read_b64_tr_b16 a[198:199], v24 offset:44544
    v_fmac_f32 v38, v32, v32
    v_fmac_f32 v39, v33, v33
    v_lshlrev_b32 v34, 16, v55
    v_mfma_f32_32x32x16_bf16 v[176:191], a[172:175], a[200:203], v[176:191]
    v_and_b32 v35, s11, v55
    v_add_f32 v36, v36, v34
    v_add_f32 v37, v37, v35
    v_fmac_f32 v38, v34, v34
    v_fmac_f32 v39, v35, v35
    s_waitcnt lgkmcnt(4)
    v_mfma_f32_32x32x16_bf16 v[64:79], a[184:187], a[28:31], v[64:79]
    v_add_f32 v198, v36, v37
    v_add_f32 v38, v38, v39
    s_nop 1
    v_permlane32_swap_b32 v198, v38
    v_add_f32 v198, v198, v38
    v_mfma_f32_32x32x16_bf16 v[128:143], a[184:187], a[204:207], v[128:143]
    s_waitcnt vmcnt(12)
    v_cmp_le_u32 vcc, v31, v197
    s_nop 1
    s_cmp_eq_u64 vcc, -1
    s_cbranch_scc1 L_zd_2_ok
    s_cmp_lg_u32 s38, 0
    s_cbranch_scc1 L_zd_2_ok
    s_mov_b32 s69, 0
L_zd_2_spin:
    buffer_load_dword v197, v30, s[96:99], 0 offen sc1
    s_waitcnt vmcnt(0)
    v_cmp_le_u32 vcc, v31, v197
    s_nop 1
    s_cmp_eq_u64 vcc, -1
    s_cbranch_scc1 L_zd_2_ok
    s_sleep 2
    s_add_u32 s69, s69, 1
    s_cmp_lt_u32 s69, 0x4000
    s_cbranch_scc1 L_zd_2_spin
L_zd_2_ok:
    s_waitcnt lgkmcnt(0)
    v_mfma_f32_32x32x16_bf16 v[80:95], a[188:191], a[28:31], v[80:95]
    s_barrier
    ds_read_b128 a[32:35], v12 offset:32768
    ds_read_b128 a[176:179], v56 offset:32768
    v_mfma_f32_32x32x16_bf16 v[144:159], a[188:191], a[204:207], v[144:159]
    ds_read_b64_tr_b16 a[160:161], v22 offset:0
    ds_read_b64_tr_b16 a[162:163], v22 offset:512
    buffer_atomic_add_f32 v198, v199, s[60:63], 0 offen
    v_mfma_f32_32x32x16_bf16 v[96:111], a[192:195], a[28:31], v[96:111]
    ds_read_b64_tr_b16 a[164:165], v25 offset:0
    ds_read_b64_tr_b16 a[166:167], v25 offset:512
    v_mfma_f32_32x32x16_bf16 v[160:175], a[192:195], a[204:207], v[160:175]
    ds_read_b64_tr_b16 a[168:169], v22 offset:8192
    ds_read_b64_tr_b16 a[170:171], v22 offset:8704
    buffer_atomic_add_f32 v216, v200, s[60:63], 0 offen
    v_mfma_f32_32x32x16_bf16 v[112:127], a[196:199], a[28:31], v[112:127]
    ds_read_b64_tr_b16 a[172:173], v25 offset:8192
    ds_read_b64_tr_b16 a[174:175], v25 offset:8704
    v_mfma_f32_32x32x16_bf16 v[176:191], a[196:199], a[204:207], v[176:191]
    s_mul_i32 s9, s80, 1728
    s_add_u32 m0, s43, 32768
    s_add_u32 s9, s9, 0
    buffer_load_dwordx4 v16, s[48:51], s9 offen offset:0 lds
    s_waitcnt lgkmcnt(4)
    v_mfma_f32_32x32x16_bf16 v[64:79], a[160:163], a[32:35], v[64:79]
    ds_read_b128 a[36:39], v13 offset:32768
    ds_read_b128 a[180:183], v57 offset:32768
    v_mfma_f32_32x32x16_bf16 v[128:143], a[160:163], a[176:179], v[128:143]
    ds_read_b64_tr_b16 a[184:185], v22 offset:1024
    ds_read_b64_tr_b16 a[186:187], v22 offset:1536
    buffer_load_dwordx4 v17, s[48:51], s9 offen offset:1024 lds
    v_mfma_f32_32x32x16_bf16 v[80:95], a[164:167], a[32:35], v[80:95]
    ds_read_b128 a[40:43], v14 offset:32768
    ds_read_b128 a[200:203], v58 offset:32768
    v_mfma_f32_32x32x16_bf16 v[144:159], a[164:167], a[176:179], v[144:159]
    ds_read_b64_tr_b16 a[188:189], v25 offset:1024
    ds_read_b64_tr_b16 a[190:191], v25 offset:1536
    buffer_load_dwordx4 v18, s[48:51], s9 offen offset:2048 lds
    s_waitcnt lgkmcnt(8)
    v_mfma_f32_32x32x16_bf16 v[96:111], a[168:171], a[32:35], v[96:111]
    ds_read_b128 a[44:47], v15 offset:32768
    ds_read_b128 a[204:207], v59 offset:32768
    v_mfma_f32_32x32x16_bf16 v[160:175], a[168:171], a[176:179], v[160:175]
    ds_read_b64_tr_b16 a[192:193], v22 offset:9216
    ds_read_b64_tr_b16 a[194:195], v22 offset:9728
    buffer_load_dwordx4 v19, s[48:51], s9 offen offset:3072 lds
    v_mfma_f32_32x32x16_bf16 v[112:127], a[172:175], a[32:35], v[112:127]
    ds_read_b64_tr_b16 a[196:197], v25 offset:9216
    ds_read_b64_tr_b16 a[198:199], v25 offset:9728
    v_mfma_f32_32x32x16_bf16 v[176:191], a[172:175], a[176:179], v[176:191]
    s_mul_i32 s9, s80, 1728
    s_add_u32 m0, s43, 49152
    s_add_u32 s9, s9, 128
    buffer_load_dwordx4 v16, s[48:51], s9 offen offset:0 lds
    s_waitcnt lgkmcnt(6)
    v_mfma_f32_32x32x16_bf16 v[64:79], a[184:187], a[36:39], v[64:79]
    ds_read_b64_tr_b16 a[160:161], v22 offset:2048
    ds_read_b64_tr_b16 a[162:163], v22 offset:2560
    s_waitcnt lgkmcnt(6)
    v_mfma_f32_32x32x16_bf16 v[128:143], a[184:187], a[180:183], v[128:143]
    s_barrier
    s_add_u32 m0, s43, 98304
    s_nop 0
    buffer_load_dwordx4 v8, s[44:47], s80 offen offset:0 lds
    v_mfma_f32_32x32x16_bf16 v[80:95], a[188:191], a[36:39], v[80:95]
    ds_read_b64_tr_b16 a[164:165], v25 offset:2048
    ds_read_b64_tr_b16 a[166:167], v25 offset:2560
    v_mfma_f32_32x32x16_bf16 v[144:159], a[188:191], a[180:183], v[144:159]
    buffer_load_dwordx4 v9, s[44:47], s80 offen offset:1024 lds
    s_waitcnt lgkmcnt(4)
    v_mfma_f32_32x32x16_bf16 v[96:111], a[192:195], a[36:39], v[96:111]
    ds_read_b64_tr_b16 a[168:169], v22 offset:10240
    ds_read_b64_tr_b16 a[170:171], v22 offset:10752
    v_mfma_f32_32x32x16_bf16 v[160:175], a[192:195], a[180:183], v[160:175]
    buffer_load_dwordx4 v10, s[44:47], s80 offen offset:2048 lds
    v_mfma_f32_32x32x16_bf16 v[112:127], a[196:199], a[36:39], v[112:127]
    ds_read_b64_tr_b16 a[172:173], v25 offset:10240
    ds_read_b64_tr_b16 a[174:175], v25 offset:10752
    v_mfma_f32_32x32x16_bf16 v[176:191], a[196:199], a[180:183], v[176:191]
    buffer_load_dwordx4 v11, s[44:47], s80 offen offset:3072 lds
    s_waitcnt lgkmcnt(4)
    v_mfma_f32_32x32x16_bf16 v[64:79], a[160:163], a[40:43], v[64:79]
    ds_read_b64_tr_b16 a[184:185], v22 offset:3072
    ds_read_b64_tr_b16 a[186:187], v22 offset:3584
    s_add_u32 m0, s43, 49152
    v_mfma_f32_32x32x16_bf16 v[128:143], a[160:163], a[200:203], v[128:143]
    buffer_load_dwordx4 v17, s[48:51], s9 offen offset:1024 lds
    v_mfma_f32_32x32x16_bf16 v[80:95], a[164:167], a[40:43], v[80:95]
    ds_read_b64_tr_b16 a[188:189], v25 offset:3072
    ds_read_b64_tr_b16 a[190:191], v25 offset:3584
    v_mfma_f32_32x32x16_bf16 v[144:159], a[164:167], a[200:203], v[144:159]
    buffer_load_dwordx4 v18, s[48:51], s9 offen offset:2048 lds
    s_waitcnt lgkmcnt(4)
    v_mfma_f32_32x32x16_bf16 v[96:111], a[168:171], a[40:43], v[96:111]
    ds_read_b64_tr_b16 a[192:193], v22 offset:11264
    ds_read_b64_tr_b16 a[194:195], v22 offset:11776
    v_mfma_f32_32x32x16_bf16 v[160:175], a[168:171], a[200:203], v[160:175]
    buffer_load_dwordx4 v19, s[48:51], s9 offen offset:3072 lds
    v_mfma_f32_32x32x16_bf16 v[112:127], a[172:175], a[40:43], v[112:127]
    ds_read_b64_tr_b16 a[196:197], v25 offset:11264
    ds_read_b64_tr_b16 a[198:199], v25 offset:11776
    v_mfma_f32_32x32x16_bf16 v[176:191], a[172:175], a[200:203], v[176:191]
    s_waitcnt lgkmcnt(4)
    v_mfma_f32_32x32x16_bf16 v[64:79], a[184:187], a[44:47], v[64:79]
    v_mfma_f32_32x32x16_bf16 v[128:143], a[184:187], a[204:207], v[128:143]
    s_waitcnt vmcnt(14) lgkmcnt(0)
    v_mfma_f32_32x32x16_bf16 v[80:95], a[188:191], a[44:47], v[80:95]
    s_barrier
    ds_read_b128 a[48:51], v12 offset:49152
    ds_read_b128 a[176:179], v56 offset:49152
    v_mfma_f32_32x32x16_bf16 v[144:159], a[188:191], a[204:207], v[144:159]
    ds_read_b64_tr_b16 a[160:161], v21 offset:0
    s_add_u32 m0, s3, 131072
    ds_read_b64_tr_b16 a[162:163], v21 offset:512
    buffer_load_dwordx4 v192, s[4:7], 0 offen offset:0 lds
    v_mfma_f32_32x32x16_bf16 v[96:111], a[192:195], a[44:47], v[96:111]
    ds_read_b64_tr_b16 a[164:165], v24 offset:0
    ds_read_b64_tr_b16 a[166:167], v24 offset:512
    buffer_load_dwordx4 v193, s[4:7], 0 offen offset:1024 lds
    v_mfma_f32_32x32x16_bf16 v[160:175], a[192:195], a[204:207], v[160:175]
    ds_read_b64_tr_b16 a[168:169], v21 offset:8192
    ds_read_b64_tr_b16 a[170:171], v21 offset:8704
    buffer_load_dwordx4 v194, s[4:7], 0 offen offset:2048 lds
    v_mfma_f32_32x32x16_bf16 v[112:127], a[196:199], a[44:47], v[112:127]
    ds_read_b64_tr_b16 a[172:173], v24 offset:8192
    ds_read_b64_tr_b16 a[174:175], v24 offset:8704
    buffer_load_dwordx4 v195, s[4:7], 0 offen offset:3072 lds
    s_add_u32 m0, s3, 135168
    s_nop 0
    buffer_load_dwordx4 v196, s[4:7], 0 offen offset:0 lds
    v_mfma_f32_32x32x16_bf16 v[176:191], a[196:199], a[204:207], v[176:191]
    s_mul_i32 s9, s81, 1728
    s_add_u32 m0, s43, 65536
    s_add_u32 s9, s9, 0
    buffer_load_dwordx4 v16, s[48:51], s9 offen offset:0 lds
    s_waitcnt lgkmcnt(4)
    v_mfma_f32_32x32x16_bf16 v[64:79], a[160:163], a[48:51], v[64:79]
    ds_read_b128 a[52:55], v13 offset:49152
    ds_read_b128 a[180:183], v57 offset:49152
    v_mfma_f32_32x32x16_bf16 v[128:143], a[160:163], a[176:179], v[128:143]
    ds_read_b64_tr_b16 a[184:185], v21 offset:1024
    ds_read_b64_tr_b16 a[186:187], v21 offset:1536
    buffer_load_dwordx4 v17, s[48:51], s9 offen offset:1024 lds
    v_mfma_f32_32x32x16_bf16 v[80:95], a[164:167], a[48:51], v[80:95]
    ds_read_b128 a[56:59], v14 offset:49152
    ds_read_b128 a[200:203], v58 offset:49152
    v_mfma_f32_32x32x16_bf16 v[144:159], a[164:167], a[176:179], v[144:159]
    ds_read_b64_tr_b16 a[188:189], v24 offset:1024
    ds_read_b64_tr_b16 a[190:191], v24 offset:1536
    buffer_load_dwordx4 v18, s[48:51], s9 offen offset:2048 lds
    s_waitcnt lgkmcnt(8)
    v_mfma_f32_32x32x16_bf16 v[96:111], a[168:171], a[48:51], v[96:111]
    ds_read_b128 a[60:63], v15 offset:49152
    ds_read_b128 a[204:207], v59 offset:49152
    v_mfma_f32_32x32x16_bf16 v[160:175], a[168:171], a[176:179], v[160:175]
    ds_read_b64_tr_b16 a[192:193], v21 offset:9216
    ds_read_b64_tr_b16 a[194:195], v21 offset:9728
    buffer_load_dwordx4 v19, s[48:51], s9 offen offset:3072 lds
    v_mfma_f32_32x32x16_bf16 v[112:127], a[172:175], a[48:51], v[112:127]
    ds_read_b64_tr_b16 a[196:197], v24 offset:9216
    ds_read_b64_tr_b16 a[198:199], v24 offset:9728
    v_mfma_f32_32x32x16_bf16 v[176:191], a[172:175], a[176:179], v[176:191]
    s_mul_i32 s9, s81, 1728
    s_add_u32 m0, s43, 81920
    s_add_u32 s9, s9, 128
    buffer_load_dwordx4 v16, s[48:51], s9 offen offset:0 lds
    s_waitcnt lgkmcnt(6)
    v_mfma_f32_32x32x16_bf16 v[64:79], a[184:187], a[52:55], v[64:79]
    ds_read_b64_tr_b16 a[160:161], v21 offset:2048
    ds_read_b64_tr_b16 a[162:163], v21 offset:2560
    s_waitcnt lgkmcnt(6)
    v_mfma_f32_32x32x16_bf16 v[128:143], a[184:187], a[180:183], v[128:143]
    s_barrier
    s_add_u32 m0, s43, 114688
    s_nop 0
    buffer_load_dwordx4 v8, s[44:47], s81 offen offset:0 lds
    v_mfma_f32_32x32x16_bf16 v[80:95], a[188:191], a[52:55], v[80:95]
    ds_read_b64_tr_b16 a[164:165], v24 offset:2048
    ds_read_b64_tr_b16 a[166:167], v24 offset:2560
    v_mfma_f32_32x32x16_bf16 v[144:159], a[188:191], a[180:183], v[144:159]
    buffer_load_dwordx4 v9, s[44:47], s81 offen offset:1024 lds
    s_waitcnt lgkmcnt(4)
    v_mfma_f32_32x32x16_bf16 v[96:111], a[192:195], a[52:55], v[96:111]
    ds_read_b64_tr_b16 a[168:169], v21 offset:10240
    ds_read_b64_tr_b16 a[170:171], v21 offset:10752
    v_mfma_f32_32x32x16_bf16 v[160:175], a[192:195], a[180:183], v[160:175]
    buffer_load_dwordx4 v10, s[44:47], s81 offen offset:2048 lds
    v_mfma_f32_32x32x16_bf16 v[112:127], a[196:199], a[52:55], v[112:127]
    ds_read_b64_tr_b16 a[172:173], v24 offset:10240
    ds_read_b64_tr_b16 a[174:175], v24 offset:10752
    v_mfma_f32_32x32x16_bf16 v[176:191], a[196:199], a[180:183], v[176:191]
    buffer_load_dwordx4 v11, s[44:47], s81 offen offset:3072 lds
    s_waitcnt lgkmcnt(4)
    v_mfma_f32_32x32x16_bf16 v[64:79], a[160:163], a[56:59], v[64:79]
    ds_read_b64_tr_b16 a[184:185], v21 offset:3072
    ds_read_b64_tr_b16 a[186:187], v21 offset:3584
    s_add_u32 m0, s43, 81920
    v_mfma_f32_32x32x16_bf16 v[128:143], a[160:163], a[200:203], v[128:143]
    buffer_load_dwordx4 v17, s[48:51], s9 offen offset:1024 lds
    v_mfma_f32_32x32x16_bf16 v[80:95], a[164:167], a[56:59], v[80:95]
    ds_read_b64_tr_b16 a[188:189], v24 offset:3072
    ds_read_b64_tr_b16 a[190:191], v24 offset:3584
    v_mfma_f32_32x32x16_bf16 v[144:159], a[164:167], a[200:203], v[144:159]
    buffer_load_dwordx4 v18, s[48:51], s9 offen offset:2048 lds
    s_waitcnt lgkmcnt(4)
    v_mfma_f32_32x32x16_bf16 v[96:111], a[168:171], a[56:59], v[96:111]
    ds_read_b64_tr_b16 a[192:193], v21 offset:11264
    ds_read_b64_tr_b16 a[194:195], v21 offset:11776
    v_mfma_f32_32x32x16_bf16 v[160:175], a[168:171], a[200:203], v[160:175]
    buffer_load_dwordx4 v19, s[48:51], s9 offen offset:3072 lds
    v_mfma_f32_32x32x16_bf16 v[112:127], a[172:175], a[56:59], v[112:127]
    ds_read_b64_tr_b16 a[196:197], v24 offset:11264
    ds_read_b64_tr_b16 a[198:199], v24 offset:11776
    v_mfma_f32_32x32x16_bf16 v[176:191], a[172:175], a[200:203], v[176:191]
    s_waitcnt lgkmcnt(4)
    v_mfma_f32_32x32x16_bf16 v[64:79], a[184:187], a[60:63], v[64:79]
    v_mfma_f32_32x32x16_bf16 v[128:143], a[184:187], a[204:207], v[128:143]
    s_waitcnt vmcnt(17) lgkmcnt(0)
    v_mfma_f32_32x32x16_bf16 v[80:95], a[188:191], a[60:63], v[80:95]
    s_barrier
    ds_read_b128 a[64:67], v12 offset:32768
    ds_read_b128 a[176:179], v56 offset:32768
    v_mfma_f32_32x32x16_bf16 v[144:159], a[188:191], a[204:207], v[144:159]
    ds_read_b64_tr_b16 a[160:161], v21 offset:32768
    ds_read_b64_tr_b16 a[162:163], v21 offset:33280
    buffer_atomic_add v202, v201, s[60:63], 0 offen
    v_mfma_f32_32x32x16_bf16 v[96:111], a[192:195], a[60:63], v[96:111]
    ds_read_b64_tr_b16 a[164:165], v24 offset:32768
    ds_read_b64_tr_b16 a[166:167], v24 offset:33280
    v_mfma_f32_32x32x16_bf16 v[160:175], a[192:195], a[204:207], v[160:175]
    ds_read_b64_tr_b16 a[168:169], v21 offset:40960
    ds_read_b64_tr_b16 a[170:171], v21 offset:41472
    v_mfma_f32_32x32x16_bf16 v[112:127], a[196:199], a[60:63], v[112:127]
    ds_read_b64_tr_b16 a[172:173], v24 offset:40960
    ds_read_b64_tr_b16 a[174:175], v24 offset:41472
    v_mfma_f32_32x32x16_bf16 v[176:191], a[196:199], a[204:207], v[176:191]
    s_mul_i32 s9, s82, 1728
    s_add_u32 m0, s43, 0
    s_add_u32 s9, s9, 0
    buffer_load_dwordx4 v16, s[48:51], s9 offen offset:0 lds
    s_waitcnt lgkmcnt(4)
    v_mfma_f32_32x32x16_bf16 v[64:79], a[160:163], a[64:67], v[64:79]
    ds_read_b128 a[68:71], v13 offset:32768
    ds_read_b128 a[180:183], v57 offset:32768
    v_mfma_f32_32x32x16_bf16 v[128:143], a[160:163], a[176:179], v[128:143]
    ds_read_b64_tr_b16 a[184:185], v21 offset:33792
    ds_read_b64_tr_b16 a[186:187], v21 offset:34304
    buffer_load_dwordx4 v17, s[48:51], s9 offen offset:1024 lds
    v_mfma_f32_32x32x16_bf16 v[80:95], a[164:167], a[64:67], v[80:95]
    ds_read_b128 a[72:75], v14 offset:32768
    ds_read_b128 a[200:203], v58 offset:32768
    v_mfma_f32_32x32x16_bf16 v[144:159], a[164:167], a[176:179], v[144:159]
    ds_read_b64_tr_b16 a[188:189], v24 offset:33792
    ds_read_b64_tr_b16 a[190:191], v24 offset:34304
    buffer_load_dwordx4 v18, s[48:51], s9 offen offset:2048 lds
    s_waitcnt lgkmcnt(8)
    v_mfma_f32_32x32x16_bf16 v[96:111], a[168:171], a[64:67], v[96:111]
    ds_read_b128 a[76:79], v15 offset:32768
    ds_read_b128 a[204:207], v59 offset:32768
    v_mfma_f32_32x32x16_bf16 v[160:175], a[168:171], a[176:179], v[160:175]
    ds_read_b64_tr_b16 a[192:193], v21 offset:41984
    ds_read_b64_tr_b16 a[194:195], v21 offset:42496
    buffer_load_dwordx4 v19, s[48:51], s9 offen offset:3072 lds
    v_mfma_f32_32x32x16_bf16 v[112:127], a[172:175], a[64:67], v[112:127]
    ds_read_b64_tr_b16 a[196:197], v24 offset:41984
    ds_read_b64_tr_b16 a[198:199], v24 offset:42496
    v_mfma_f32_32x32x16_bf16 v[176:191], a[172:175], a[176:179], v[176:191]
    s_mul_i32 s9, s82, 1728
    s_add_u32 m0, s43, 16384
    s_add_u32 s9, s9, 128
    buffer_load_dwordx4 v16, s[48:51], s9 offen offset:0 lds
    s_waitcnt lgkmcnt(6)
    v_mfma_f32_32x32x16_bf16 v[64:79], a[184:187], a[68:71], v[64:79]
    ds_read_b64_tr_b16 a[160:161], v21 offset:34816
    ds_read_b64_tr_b16 a[162:163], v21 offset:35328
    s_waitcnt lgkmcnt(6)
    v_mfma_f32_32x32x16_bf16 v[128:143], a[184:187], a[180:183], v[128:143]
    s_barrier
    s_add_u32 m0, s43, 98304
    s_nop 0
    buffer_load_dwordx4 v8, s[44:47], s82 offen offset:0 lds
    v_mfma_f32_32x32x16_bf16 v[80:95], a[188:191], a[68:71], v[80:95]
    ds_read_b64_tr_b16 a[164:165], v24 offset:34816
    ds_read_b64_tr_b16 a[166:167], v24 offset:35328
    v_mfma_f32_32x32x16_bf16 v[144:159], a[188:191], a[180:183], v[144:159]
    buffer_load_dwordx4 v9, s[44:47], s82 offen offset:1024 lds
    s_waitcnt lgkmcnt(4)
    v_mfma_f32_32x32x16_bf16 v[96:111], a[192:195], a[68:71], v[96:111]
    ds_read_b64_tr_b16 a[168:169], v21 offset:43008
    ds_read_b64_tr_b16 a[170:171], v21 offset:43520
    v_mfma_f32_32x32x16_bf16 v[160:175], a[192:195], a[180:183], v[160:175]
    buffer_load_dwordx4 v10, s[44:47], s82 offen offset:2048 lds
    v_mfma_f32_32x32x16_bf16 v[112:127], a[196:199], a[68:71], v[112:127]
    ds_read_b64_tr_b16 a[172:173], v24 offset:43008
    ds_read_b64_tr_b16 a[174:175], v24 offset:43520
    v_mfma_f32_32x32x16_bf16 v[176:191], a[196:199], a[180:183], v[176:191]
    buffer_load_dwordx4 v11, s[44:47], s82 offen offset:3072 lds
    s_waitcnt lgkmcnt(4)
    v_mfma_f32_32x32x16_bf16 v[64:79], a[160:163], a[72:75], v[64:79]
    ds_read_b64_tr_b16 a[184:185], v21 offset:35840
    ds_read_b64_tr_b16 a[186:187], v21 offset:36352
    s_add_u32 m0, s43, 16384
    v_mfma_f32_32x32x16_bf16 v[128:143], a[160:163], a[200:203], v[128:143]
    buffer_load_dwordx4 v17, s[48:51], s9 offen offset:1024 lds
    v_mfma_f32_32x32x16_bf16 v[80:95], a[164:167], a[72:75], v[80:95]
    ds_read_b64_tr_b16 a[188:189], v24 offset:35840
    ds_read_b64_tr_b16 a[190:191], v24 offset:36352
    v_mfma_f32_32x32x16_bf16 v[144:159], a[164:167], a[200:203], v[144:159]
    buffer_load_dwordx4 v18, s[48:51], s9 offen offset:2048 lds
    s_waitcnt lgkmcnt(4)
    v_mfma_f32_32x32x16_bf16 v[96:111], a[168:171], a[72:75], v[96:111]
    ds_read_b64_tr_b16 a[192:193], v21 offset:44032
    ds_read_b64_tr_b16 a[194:195], v21 offset:44544
    v_mfma_f32_32x32x16_bf16 v[160:175], a[168:171], a[200:203], v[160:175]
    buffer_load_dwordx4 v19, s[48:51], s9 offen offset:3072 lds
    v_mfma_f32_32x32x16_bf16 v[112:127], a[172:175], a[72:75], v[112:127]
    ds_read_b64_tr_b16 a[196:197], v24 offset:44032
    ds_read_b64_tr_b16 a[198:199], v24 offset:44544
    v_mfma_f32_32x32x16_bf16 v[176:191], a[172:175], a[200:203], v[176:191]
    s_waitcnt lgkmcnt(4)
    v_mfma_f32_32x32x16_bf16 v[64:79], a[184:187], a[76:79], v[64:79]
    v_mfma_f32_32x32x16_bf16 v[128:143], a[184:187], a[204:207], v[128:143]
    s_waitcnt vmcnt(13) lgkmcnt(0)
    v_mfma_f32_32x32x16_bf16 v[80:95], a[188:191], a[76:79], v[80:95]
    s_barrier
    ds_read_b128 a[80:83], v12 offset:49152
    ds_read_b128 a[176:179], v56 offset:49152
    v_mfma_f32_32x32x16_bf16 v[144:159], a[188:191], a[204:207], v[144:159]
    ds_read_b64_tr_b16 a[160:161], v22 offset:0
    ds_read_b64_tr_b16 a[162:163], v22 offset:512
    v_mfma_f32_32x32x16_bf16 v[96:111], a[192:195], a[76:79], v[96:111]
    ds_read_b64_tr_b16 a[164:165], v25 offset:0
    ds_read_b64_tr_b16 a[166:167], v25 offset:512
    v_mfma_f32_32x32x16_bf16 v[160:175], a[192:195], a[204:207], v[160:175]
    ds_read_b64_tr_b16 a[168:169], v22 offset:8192
    ds_read_b64_tr_b16 a[170:171], v22 offset:8704
    v_mfma_f32_32x32x16_bf16 v[112:127], a[196:199], a[76:79], v[112:127]
    ds_read_b64_tr_b16 a[172:173], v25 offset:8192
    ds_read_b64_tr_b16 a[174:175], v25 offset:8704
    s_mov_b32 s12, s90
    s_mov_b32 s13, s91
    v_mfma_f32_32x32x16_bf16 v[176:191], a[196:199], a[204:207], v[176:191]
    s_mul_i32 s9, s83, 1728
    s_add_u32 m0, s43, 32768
    s_add_u32 s9, s9, 0
    buffer_load_dwordx4 v16, s[48:51], s9 offen offset:0 lds
    s_waitcnt lgkmcnt(4)
    v_mfma_f32_32x32x16_bf16 v[64:79], a[160:163], a[80:83], v[64:79]
    ds_read_b128 a[84:87], v13 offset:49152
    ds_read_b128 a[180:183], v57 offset:49152
    s_cmp_lt_u32 s89, 20
    s_cselect_b32 s14, 5120, 0
    v_mfma_f32_32x32x16_bf16 v[128:143], a[160:163], a[176:179], v[128:143]
    ds_read_b64_tr_b16 a[184:185], v22 offset:1024
    ds_read_b64_tr_b16 a[186:187], v22 offset:1536
    buffer_load_dwordx4 v17, s[48:51], s9 offen offset:1024 lds
    v_mfma_f32_32x32x16_bf16 v[80:95], a[164:167], a[80:83], v[80:95]
    ds_read_b128 a[88:91], v14 offset:49152
    ds_read_b128 a[200:203], v58 offset:49152
    v_mfma_f32_32x32x16_bf16 v[144:159], a[164:167], a[176:179], v[144:159]
    ds_read_b64_tr_b16 a[188:189], v25 offset:1024
    ds_read_b64_tr_b16 a[190:191], v25 offset:1536
    buffer_load_dwordx4 v18, s[48:51], s9 offen offset:2048 lds
    s_waitcnt lgkmcnt(8)
    v_mfma_f32_32x32x16_bf16 v[96:111], a[168:171], a[80:83], v[96:111]
    ds_read_b128 a[92:95], v15 offset:49152
    ds_read_b128 a[204:207], v59 offset:49152
    v_mfma_f32_32x32x16_bf16 v[160:175], a[168:171], a[176:179], v[160:175]
    ds_read_b64_tr_b16 a[192:193], v22 offset:9216
    ds_read_b64_tr_b16 a[194:195], v22 offset:9728
    buffer_load_dwordx4 v19, s[48:51], s9 offen offset:3072 lds
    v_mfma_f32_32x32x16_bf16 v[112:127], a[172:175], a[80:83], v[112:127]
    ds_read_b64_tr_b16 a[196:197], v25 offset:9216
    ds_read_b64_tr_b16 a[198:199], v25 offset:9728
    v_mfma_f32_32x32x16_bf16 v[176:191], a[172:175], a[176:179], v[176:191]
    s_mul_i32 s9, s83, 1728
    s_add_u32 m0, s43, 49152
    s_add_u32 s9, s9, 128
    buffer_load_dwordx4 v16, s[48:51], s9 offen offset:0 lds
    s_waitcnt lgkmcnt(6)
    v_mfma_f32_32x32x16_bf16 v[64:79], a[184:187], a[84:87], v[64:79]
    ds_read_b64_tr_b16 a[160:161], v22 offset:2048
    ds_read_b64_tr_b16 a[162:163], v22 offset:2560
    s_waitcnt lgkmcnt(6)
    v_mfma_f32_32x32x16_bf16 v[128:143], a[184:187], a[180:183], v[128:143]
    s_barrier
    s_add_u32 m0, s43, 114688
    s_nop 0
    buffer_load_dwordx4 v8, s[44:47], s83 offen offset:0 lds
    v_mfma_f32_32x32x16_bf16 v[80:95], a[188:191], a[84:87], v[80:95]
    ds_read_b64_tr_b16 a[164:165], v25 offset:2048
    ds_read_b64_tr_b16 a[166:167], v25 offset:2560
    v_mfma_f32_32x32x16_bf16 v[144:159], a[188:191], a[180:183], v[144:159]
    buffer_load_dwordx4 v9, s[44:47], s83 offen offset:1024 lds
    s_waitcnt lgkmcnt(4)
    v_mfma_f32_32x32x16_bf16 v[96:111], a[192:195], a[84:87], v[96:111]
    ds_read_b64_tr_b16 a[168:169], v22 offset:10240
    ds_read_b64_tr_b16 a[170:171], v22 offset:10752
    v_mfma_f32_32x32x16_bf16 v[160:175], a[192:195], a[180:183], v[160:175]
    buffer_load_dwordx4 v10, s[44:47], s83 offen offset:2048 lds
    v_mfma_f32_32x32x16_bf16 v[112:127], a[196:199], a[84:87], v[112:127]
    ds_read_b64_tr_b16 a[172:173], v25 offset:10240
    ds_read_b64_tr_b16 a[174:175], v25 offset:10752
    v_mfma_f32_32x32x16_bf16 v[176:191], a[196:199], a[180:183], v[176:191]
    buffer_load_dwordx4 v11, s[44:47], s83 offen offset:3072 lds
    s_waitcnt lgkmcnt(4)
    v_mfma_f32_32x32x16_bf16 v[64:79], a[160:163], a[88:91], v[64:79]
    ds_read_b64_tr_b16 a[184:185], v22 offset:3072
    ds_read_b64_tr_b16 a[186:187], v22 offset:3584
    s_add_u32 m0, s43, 49152
    v_mfma_f32_32x32x16_bf16 v[128:143], a[160:163], a[200:203], v[128:143]
    buffer_load_dwordx4 v17, s[48:51], s9 offen offset:1024 lds
    v_mfma_f32_32x32x16_bf16 v[80:95], a[164:167], a[88:91], v[80:95]
    ds_read_b64_tr_b16 a[188:189], v25 offset:3072
    ds_read_b64_tr_b16 a[190:191], v25 offset:3584
    ds_read_b64_tr_b16 v[224:225], v220 offset:0
    ds_read_b64_tr_b16 v[226:227], v220 offset:640
    ds_read_b64_tr_b16 v[228:229], v220 offset:32
    ds_read_b64_tr_b16 v[230:231], v220 offset:672
    v_mfma_f32_32x32x16_bf16 v[144:159], a[164:167], a[200:203], v[144:159]
    buffer_load_dwordx4 v18, s[48:51], s9 offen offset:2048 lds
    s_waitcnt lgkmcnt(8)
    v_mfma_f32_32x32x16_bf16 v[96:111], a[168:171], a[88:91], v[96:111]
    ds_read_b64_tr_b16 a[192:193], v22 offset:11264
    ds_read_b64_tr_b16 a[194:195], v22 offset:11776
    v_mfma_f32_32x32x16_bf16 v[160:175], a[168:171], a[200:203], v[160:175]
    buffer_load_dwordx4 v19, s[48:51], s9 offen offset:3072 lds
    v_mfma_f32_32x32x16_bf16 v[112:127], a[172:175], a[88:91], v[112:127]
    ds_read_b64_tr_b16 a[196:197], v25 offset:11264
    ds_read_b64_tr_b16 a[198:199], v25 offset:11776
    v_mfma_f32_32x32x16_bf16 v[176:191], a[172:175], a[200:203], v[176:191]
    ds_read_b64_tr_b16 v[232:233], v220 offset:64
    ds_read_b64_tr_b16 v[234:235], v220 offset:704
    ds_read_b64_tr_b16 v[236:237], v220 offset:96
    s_waitcnt lgkmcnt(14)
    ds_read_b64_tr_b16 v[238:239], v220 offset:736
    s_waitcnt lgkmcnt(14)
    ds_read_b64_tr_b16 v[240:241], v220 offset:128
    s_waitcnt lgkmcnt(14)
    ds_read_b64_tr_b16 v[242:243], v220 offset:768
    s_waitcnt lgkmcnt(14)
    v_mfma_f32_32x32x16_bf16 v[64:79], a[184:187], a[92:95], v[64:79]
    v_mfma_f32_32x32x16_bf16 v[128:143], a[184:187], a[204:207], v[128:143]
    s_waitcnt vmcnt(12) lgkmcnt(0)
    v_mfma_f32_32x32x16_bf16 v[80:95], a[188:191], a[92:95], v[80:95]
    s_barrier
    ds_read_b128 a[96:99], v12 offset:32768
    ds_read_b128 a[176:179], v56 offset:32768
    v_mfma_f32_32x32x16_bf16 v[144:159], a[188:191], a[204:207], v[144:159]
    ds_read_b64_tr_b16 a[160:161], v21 offset:0
    ds_read_b64_tr_b16 a[162:163], v21 offset:512
    buffer_store_dwordx4 v[224:227], v221, s[12:15], 0 offen offset:0 sc1
    v_mfma_f32_32x32x16_bf16 v[96:111], a[192:195], a[92:95], v[96:111]
    ds_read_b64_tr_b16 a[164:165], v24 offset:0
    ds_read_b64_tr_b16 a[166:167], v24 offset:512
    v_mfma_f32_32x32x16_bf16 v[160:175], a[192:195], a[204:207], v[160:175]
    ds_read_b64_tr_b16 a[168:169], v21 offset:8192
    ds_read_b64_tr_b16 a[170:171], v21 offset:8704
    buffer_store_dwordx4 v[228:231], v221, s[12:15], 0 offen offset:1024 sc1
    v_mfma_f32_32x32x16_bf16 v[112:127], a[196:199], a[92:95], v[112:127]
    ds_read_b64_tr_b16 a[172:173], v24 offset:8192
    ds_read_b64_tr_b16 a[174:175], v24 offset:8704
    buffer_store_dwordx4 v[232:235], v221, s[12:15], 0 offen offset:2048 sc1
    buffer_store_dwordx4 v[236:239], v221, s[12:15], 0 offen offset:3072 sc1
    v_mfma_f32_32x32x16_bf16 v[176:191], a[196:199], a[204:207], v[176:191]
    s_mul_i32 s9, s84, 1728
    s_add_u32 m0, s43, 65536
    s_add_u32 s9, s9, 0
    buffer_load_dwordx4 v16, s[48:51], s9 offen offset:0 lds
    s_waitcnt lgkmcnt(4)
    v_mfma_f32_32x32x16_bf16 v[64:79], a[160:163], a[96:99], v[64:79]
    ds_read_b128 a[100:103], v13 offset:32768
    ds_read_b128 a[180:183], v57 offset:32768
    s_mov_b32 s69, 4096
    buffer_store_dwordx4 v[240:243], v221, s[12:15], s69 offen offset:0 sc1
    v_mfma_f32_32x32x16_bf16 v[128:143], a[160:163], a[176:179], v[128:143]
    ds_read_b64_tr_b16 a[184:185], v21 offset:1024
    ds_read_b64_tr_b16 a[186:187], v21 offset:1536
    buffer_load_dwordx4 v17, s[48:51], s9 offen offset:1024 lds
    v_mfma_f32_32x32x16_bf16 v[80:95], a[164:167], a[96:99], v[80:95]
    ds_read_b128 a[104:107], v14 offset:32768
    ds_read_b128 a[200:203], v58 offset:32768
    s_lshl_b32 s64, s39, 12
    s_lshl_b32 s65, s40, 8
    v_mfma_f32_32x32x16_bf16 v[144:159], a[164:167], a[176:179], v[144:159]
    ds_read_b64_tr_b16 a[188:189], v24 offset:1024
    ds_read_b64_tr_b16 a[190:191], v24 offset:1536
    buffer_load_dwordx4 v18, s[48:51], s9 offen offset:2048 lds
    s_waitcnt lgkmcnt(8)
    v_mfma_f32_32x32x16_bf16 v[96:111], a[168:171], a[96:99], v[96:111]
    ds_read_b128 a[108:111], v15 offset:32768
    ds_read_b128 a[204:207], v59 offset:32768
    s_add_u32 s65, s65, 65536
    v_mfma_f32_32x32x16_bf16 v[160:175], a[168:171], a[176:179], v[160:175]
    ds_read_b64_tr_b16 a[192:193], v21 offset:9216
    ds_read_b64_tr_b16 a[194:195], v21 offset:9728
    buffer_load_dwordx4 v19, s[48:51], s9 offen offset:3072 lds
    v_mfma_f32_32x32x16_bf16 v[112:127], a[172:175], a[96:99], v[112:127]
    ds_read_b64_tr_b16 a[196:197], v24 offset:9216
    ds_read_b64_tr_b16 a[198:199], v24 offset:9728
    v_mov_b32 v30, s64
    v_mfma_f32_32x32x16_bf16 v[176:191], a[172:175], a[176:179], v[176:191]
    s_mul_i32 s9, s84, 1728
    s_add_u32 m0, s43, 81920
    s_add_u32 s9, s9, 128
    buffer_load_dwordx4 v16, s[48:51], s9 offen offset:0 lds
    s_waitcnt lgkmcnt(6)
    v_mfma_f32_32x32x16_bf16 v[64:79], a[184:187], a[100:103], v[64:79]
    ds_read_b64_tr_b16 a[160:161], v21 offset:2048
    ds_read_b64_tr_b16 a[162:163], v21 offset:2560
    s_waitcnt lgkmcnt(6)
    v_mfma_f32_32x32x16_bf16 v[128:143], a[184:187], a[180:183], v[128:143]
    s_barrier
    s_add_u32 m0, s43, 98304
    s_nop 0
    buffer_load_dwordx4 v8, s[44:47], s84 offen offset:0 lds
    v_mfma_f32_32x32x16_bf16 v[80:95], a[188:191], a[100:103], v[80:95]
    ds_read_b64_tr_b16 a[164:165], v24 offset:2048
    ds_read_b64_tr_b16 a[166:167], v24 offset:2560
    v_writelane_b32 v30, s65, 1
    v_mfma_f32_32x32x16_bf16 v[144:159], a[188:191], a[180:183], v[144:159]
    buffer_load_dwordx4 v9, s[44:47], s84 offen offset:1024 lds
    s_waitcnt lgkmcnt(4)
    v_mfma_f32_32x32x16_bf16 v[96:111], a[192:195], a[100:103], v[96:111]
    ds_read_b64_tr_b16 a[168:169], v21 offset:10240
    ds_read_b64_tr_b16 a[170:171], v21 offset:10752
    v_mfma_f32_32x32x16_bf16 v[160:175], a[192:195], a[180:183], v[160:175]
    buffer_load_dwordx4 v10, s[44:47], s84 offen offset:2048 lds
    v_mfma_f32_32x32x16_bf16 v[112:127], a[196:199], a[100:103], v[112:127]
    ds_read_b64_tr_b16 a[172:173], v24 offset:10240
    ds_read_b64_tr_b16 a[174:175], v24 offset:10752
    v_mov_b32 v31, 10
    v_mfma_f32_32x32x16_bf16 v[176:191], a[196:199], a[180:183], v[176:191]
    buffer_load_dwordx4 v11, s[44:47], s84 offen offset:3072 lds
    s_waitcnt lgkmcnt(4)
    v_mfma_f32_32x32x16_bf16 v[64:79], a[160:163], a[104:107], v[64:79]
    ds_read_b64_tr_b16 a[184:185], v21 offset:3072
    ds_read_b64_tr_b16 a[186:187], v21 offset:3584
    s_add_u32 m0, s43, 81920
    v_mfma_f32_32x32x16_bf16 v[128:143], a[160:163], a[200:203], v[128:143]
    buffer_load_dwordx4 v17, s[48:51], s9 offen offset:1024 lds
    v_mfma_f32_32x32x16_bf16 v[80:95], a[164:167], a[104:107], v[80:95]
    ds_read_b64_tr_b16 a[188:189], v24 offset:3072
    ds_read_b64_tr_b16 a[190:191], v24 offset:3584
    v_mfma_f32_32x32x16_bf16 v[144:159], a[164:167], a[200:203], v[144:159]
    buffer_load_dwordx4 v18, s[48:51], s9 offen offset:2048 lds
    s_waitcnt lgkmcnt(4)
    v_mfma_f32_32x32x16_bf16 v[96:111], a[168:171], a[104:107], v[96:111]
    ds_read_b64_tr_b16 a[192:193], v21 offset:11264
    ds_read_b64_tr_b16 a[194:195], v21 offset:11776
    v_mfma_f32_32x32x16_bf16 v[160:175], a[168:171], a[200:203], v[160:175]
    buffer_load_dwordx4 v19, s[48:51], s9 offen offset:3072 lds
    v_mfma_f32_32x32x16_bf16 v[112:127], a[172:175], a[104:107], v[112:127]
    ds_read_b64_tr_b16 a[196:197], v24 offset:11264
    ds_read_b64_tr_b16 a[198:199], v24 offset:11776
    v_mfma_f32_32x32x16_bf16 v[176:191], a[172:175], a[200:203], v[176:191]
    s_waitcnt lgkmcnt(4)
    v_mfma_f32_32x32x16_bf16 v[64:79], a[184:187], a[108:111], v[64:79]
    v_mfma_f32_32x32x16_bf16 v[128:143], a[184:187], a[204:207], v[128:143]
    s_waitcnt vmcnt(17) lgkmcnt(0)
    v_mfma_f32_32x32x16_bf16 v[80:95], a[188:191], a[108:111], v[80:95]
    s_barrier
    ds_read_b128 a[112:115], v12 offset:49152
    ds_read_b128 a[176:179], v56 offset:49152
    v_mfma_f32_32x32x16_bf16 v[144:159], a[188:191], a[204:207], v[144:159]
    ds_read_b64_tr_b16 a[160:161], v21 offset:32768
    ds_read_b64_tr_b16 a[162:163], v21 offset:33280
    buffer_load_dword v197, v30, s[60:63], s73 offen sc1
    v_mfma_f32_32x32x16_bf16 v[96:111], a[192:195], a[108:111], v[96:111]
    ds_read_b64_tr_b16 a[164:165], v24 offset:32768
    ds_read_b64_tr_b16 a[166:167], v24 offset:33280
    v_mfma_f32_32x32x16_bf16 v[160:175], a[192:195], a[204:207], v[160:175]
    ds_read_b64_tr_b16 a[168:169], v21 offset:40960
    ds_read_b64_tr_b16 a[170:171], v21 offset:41472
    v_mfma_f32_32x32x16_bf16 v[112:127], a[196:199], a[108:111], v[112:127]
    ds_read_b64_tr_b16 a[172:173], v24 offset:40960
    ds_read_b64_tr_b16 a[174:175], v24 offset:41472
    v_mfma_f32_32x32x16_bf16 v[176:191], a[196:199], a[204:207], v[176:191]
    s_mul_i32 s9, s85, 1728
    s_add_u32 m0, s43, 0
    s_add_u32 s9, s9, 0
    buffer_load_dwordx4 v16, s[48:51], s9 offen offset:0 lds
    s_waitcnt lgkmcnt(4)
    v_mfma_f32_32x32x16_bf16 v[64:79], a[160:163], a[112:115], v[64:79]
    ds_read_b128 a[116:119], v13 offset:49152
    ds_read_b128 a[180:183], v57 offset:49152
    v_mfma_f32_32x32x16_bf16 v[128:143], a[160:163], a[176:179], v[128:143]
    ds_read_b64_tr_b16 a[184:185], v21 offset:33792
    ds_read_b64_tr_b16 a[186:187], v21 offset:34304
    buffer_load_dwordx4 v17, s[48:51], s9 offen offset:1024 lds
    v_mfma_f32_32x32x16_bf16 v[80:95], a[164:167], a[112:115], v[80:95]
    ds_read_b128 a[120:123], v14 offset:49152
    ds_read_b128 a[200:203], v58 offset:49152
    v_mfma_f32_32x32x16_bf16 v[144:159], a[164:167], a[176:179], v[144:159]
    ds_read_b64_tr_b16 a[188:189], v24 offset:33792
    ds_read_b64_tr_b16 a[190:191], v24 offset:34304
    buffer_load_dwordx4 v18, s[48:51], s9 offen offset:2048 lds
    s_waitcnt lgkmcnt(8)
    v_mfma_f32_32x32x16_bf16 v[96:111], a[168:171], a[112:115], v[96:111]
    ds_read_b128 a[124:127], v15 offset:49152
    ds_read_b128 a[204:207], v59 offset:49152
    v_mfma_f32_32x32x16_bf16 v[160:175], a[168:171], a[176:179], v[160:175]
    ds_read_b64_tr_b16 a[192:193], v21 offset:41984
    ds_read_b64_tr_b16 a[194:195], v21 offset:42496
    buffer_load_dwordx4 v19, s[48:51], s9 offen offset:3072 lds
    v_mfma_f32_32x32x16_bf16 v[112:127], a[172:175], a[112:115], v[112:127]
    ds_read_b64_tr_b16 a[196:197], v24 offset:41984
    ds_read_b64_tr_b16 a[198:199], v24 offset:42496
    v_mfma_f32_32x32x16_bf16 v[176:191], a[172:175], a[176:179], v[176:191]
    s_mul_i32 s9, s85, 1728
    s_add_u32 m0, s43, 16384
    s_add_u32 s9, s9, 128
    buffer_load_dwordx4 v16, s[48:51], s9 offen offset:0 lds
    s_waitcnt lgkmcnt(6)
    v_mfma_f32_32x32x16_bf16 v[64:79], a[184:187], a[116:119], v[64:79]
    ds_read_b64_tr_b16 a[160:161], v21 offset:34816
    ds_read_b64_tr_b16 a[162:163], v21 offset:35328
    s_waitcnt lgkmcnt(6)
    v_mfma_f32_32x32x16_bf16 v[128:143], a[184:187], a[180:183], v[128:143]
    s_barrier
    s_add_u32 m0, s43, 114688
    s_nop 0
    buffer_load_dwordx4 v8, s[44:47], s85 offen offset:0 lds
    v_mfma_f32_32x32x16_bf16 v[80:95], a[188:191], a[116:119], v[80:95]
    ds_read_b64_tr_b16 a[164:165], v24 offset:34816
    ds_read_b64_tr_b16 a[166:167], v24 offset:35328
    v_mfma_f32_32x32x16_bf16 v[144:159], a[188:191], a[180:183], v[144:159]
    buffer_load_dwordx4 v9, s[44:47], s85 offen offset:1024 lds
    s_waitcnt lgkmcnt(4)
    v_mfma_f32_32x32x16_bf16 v[96:111], a[192:195], a[116:119], v[96:111]
    ds_read_b64_tr_b16 a[168:169], v21 offset:43008
    ds_read_b64_tr_b16 a[170:171], v21 offset:43520
    v_mfma_f32_32x32x16_bf16 v[160:175], a[192:195], a[180:183], v[160:175]
    buffer_load_dwordx4 v10, s[44:47], s85 offen offset:2048 lds
    v_mfma_f32_32x32x16_bf16 v[112:127], a[196:199], a[116:119], v[112:127]
    ds_read_b64_tr_b16 a[172:173], v24 offset:43008
    ds_read_b64_tr_b16 a[174:175], v24 offset:43520
    v_mfma_f32_32x32x16_bf16 v[176:191], a[196:199], a[180:183], v[176:191]
    buffer_load_dwordx4 v11, s[44:47], s85 offen offset:3072 lds
    s_waitcnt lgkmcnt(4)
    v_mfma_f32_32x32x16_bf16 v[64:79], a[160:163], a[120:123], v[64:79]
    ds_read_b64_tr_b16 a[184:185], v21 offset:35840
    s_add_u32 m0, s43, 16384
    ds_read_b64_tr_b16 a[186:187], v21 offset:36352
    buffer_load_dwordx4 v17, s[48:51], s9 offen offset:1024 lds
    v_mfma_f32_32x32x16_bf16 v[128:143], a[160:163], a[200:203], v[128:143]
    buffer_load_dwordx4 v18, s[48:51], s9 offen offset:2048 lds
    v_mfma_f32_32x32x16_bf16 v[80:95], a[164:167], a[120:123], v[80:95]
    ds_read_b64_tr_b16 a[188:189], v24 offset:35840
    ds_read_b64_tr_b16 a[190:191], v24 offset:36352
    buffer_load_dwordx4 v19, s[48:51], s9 offen offset:3072 lds
    v_mfma_f32_32x32x16_bf16 v[144:159], a[164:167], a[200:203], v[144:159]
    s_mul_i32 s9, s76, 1728
    s_add_u32 m0, s43, 131072
    s_add_u32 s9, s9, 256
    buffer_load_dwordx4 v16, s[48:51], s9 offen offset:0 lds
    s_waitcnt lgkmcnt(4)
    v_mfma_f32_32x32x16_bf16 v[96:111], a[168:171], a[120:123], v[96:111]
    ds_read_b64_tr_b16 a[192:193], v21 offset:44032
    ds_read_b64_tr_b16 a[194:195], v21 offset:44544
    v_mfma_f32_32x32x16_bf16 v[160:175], a[168:171], a[200:203], v[160:175]
    buffer_load_dwordx4 v17, s[48:51], s9 offen offset:1024 lds
    v_mfma_f32_32x32x16_bf16 v[112:127], a[172:175], a[120:123], v[112:127]
    ds_read_b64_tr_b16 a[196:197], v24 offset:44032
    ds_read_b64_tr_b16 a[198:199], v24 offset:44544
    v_mfma_f32_32x32x16_bf16 v[176:191], a[172:175], a[200:203], v[176:191]
    buffer_load_dwordx4 v18, s[48:51], s9 offen offset:2048 lds
    s_waitcnt lgkmcnt(4)
    v_mfma_f32_32x32x16_bf16 v[64:79], a[184:187], a[124:127], v[64:79]
    buffer_load_dwordx4 v19, s[48:51], s9 offen offset:3072 lds
    v_mfma_f32_32x32x16_bf16 v[128:143], a[184:187], a[204:207], v[128:143]
    s_mul_i32 s8, s76, 1728
    s_add_u32 m0, s92, 147456
    s_nop 0
    buffer_load_dwordx4 v20, s[52:55], s8 offen offset:0 lds
    s_waitcnt vmcnt(17)
    v_cmp_le_u32 vcc, v31, v197
    s_nop 1
    s_cmp_eq_u64 vcc, -1
    s_cbranch_scc1 L_f0_3_ok
    s_cmp_lg_u32 s38, 0
    s_cbranch_scc1 L_f0_3_ok
    s_mov_b32 s69, 0
L_f0_3_spin:
    buffer_load_dword v197, v30, s[60:63], 0 offen sc1
    s_waitcnt vmcnt(0)
    v_cmp_le_u32 vcc, v31, v197
    s_nop 1
    s_cmp_eq_u64 vcc, -1
    s_cbranch_scc1 L_f0_3_ok
    s_sleep 2
    s_add_u32 s69, s69, 1
    s_cmp_lt_u32 s69, 0x4000
    s_cbranch_scc1 L_f0_3_spin
L_f0_3_ok:
    s_waitcnt lgkmcnt(0)
    v_mfma_f32_32x32x16_bf16 v[80:95], a[188:191], a[124:127], v[80:95]
    s_barrier
    ds_read_b128 a[128:131], v12 offset:32768
    ds_read_b128 a[176:179], v56 offset:32768
    v_mfma_f32_32x32x16_bf16 v[144:159], a[188:191], a[204:207], v[144:159]
    ds_read_b64_tr_b16 a[160:161], v22 offset:0
    ds_read_b64_tr_b16 a[162:163], v22 offset:512
    s_lshl_b32 s64, s39, 2
    s_add_u32 s64, s64, s38
    s_lshl_b32 s64, s64, 8
    s_add_u32 s64, s64, 69632
    v_mfma_f32_32x32x16_bf16 v[96:111], a[192:195], a[124:127], v[96:111]
    ds_read_b64_tr_b16 a[164:165], v25 offset:0
    ds_read_b64_tr_b16 a[166:167], v25 offset:512
    v_lshlrev_b32 v30, 3, v2
    buffer_load_dwordx2 v[198:199], v30, s[60:63], s64 offen sc1
    v_mfma_f32_32x32x16_bf16 v[160:175], a[192:195], a[204:207], v[160:175]
    ds_read_b64_tr_b16 a[168:169], v22 offset:8192
    ds_read_b64_tr_b16 a[170:171], v22 offset:8704
    s_add_u32 m0, s92, 147456
    s_add_u32 s8, s8, 54272
    buffer_load_dwordx4 v20, s[52:55], s8 offen offset:1024 lds
    v_mfma_f32_32x32x16_bf16 v[112:127], a[196:199], a[124:127], v[112:127]
    ds_read_b64_tr_b16 a[172:173], v25 offset:8192
    ds_read_b64_tr_b16 a[174:175], v25 offset:8704
    s_xor_b32 s64, s64, 256
    buffer_load_dwordx2 v[206:207], v30, s[60:63], s64 offen sc1
    s_lshl_b32 s64, s40, 11
    v_mfma_f32_32x32x16_bf16 v[176:191], a[196:199], a[204:207], v[176:191]
    s_mul_i32 s9, s77, 1728
    s_add_u32 m0, s43, 32768
    s_add_u32 s9, s9, 256
    buffer_load_dwordx4 v16, s[48:51], s9 offen offset:0 lds
    s_waitcnt lgkmcnt(4)
    v_mfma_f32_32x32x16_bf16 v[64:79], a[160:163], a[128:131], v[64:79]
    ds_read_b128 a[132:135], v13 offset:32768
    ds_read_b128 a[180:183], v57 offset:32768
    s_add_u32 s64, s64, 86016
    s_lshr_b32 s65, s74, 5
    v_mfma_f32_32x32x16_bf16 v[128:143], a[160:163], a[176:179], v[128:143]
    ds_read_b64_tr_b16 a[184:185], v22 offset:1024
    ds_read_b64_tr_b16 a[186:187], v22 offset:1536
    buffer_load_dwordx4 v17, s[48:51], s9 offen offset:1024 lds
    v_mfma_f32_32x32x16_bf16 v[80:95], a[164:167], a[128:131], v[80:95]
    ds_read_b128 a[136:139], v14 offset:32768
    ds_read_b128 a[200:203], v58 offset:32768
    s_add_u32 s64, s64, s65
    v_lshlrev_b32 v30, 2, v1
    buffer_load_dword v200, v30, s[60:63], s64 offen offset:0 sc1
    v_mfma_f32_32x32x16_bf16 v[144:159], a[164:167], a[176:179], v[144:159]
    ds_read_b64_tr_b16 a[188:189], v25 offset:1024
    ds_read_b64_tr_b16 a[190:191], v25 offset:1536
    buffer_load_dwordx4 v18, s[48:51], s9 offen offset:2048 lds
    s_waitcnt lgkmcnt(8)
    v_mfma_f32_32x32x16_bf16 v[96:111], a[168:171], a[128:131], v[96:111]
    ds_read_b128 a[140:143], v15 offset:32768
    ds_read_b128 a[204:207], v59 offset:32768
    buffer_load_dword v201, v30, s[60:63], s64 offen offset:256 sc1
    v_mfma_f32_32x32x16_bf16 v[160:175], a[168:171], a[176:179], v[160:175]
    ds_read_b64_tr_b16 a[192:193], v22 offset:9216
    ds_read_b64_tr_b16 a[194:195], v22 offset:9728
    buffer_load_dwordx4 v19, s[48:51], s9 offen offset:3072 lds
    v_mfma_f32_32x32x16_bf16 v[112:127], a[172:175], a[128:131], v[112:127]
    ds_read_b64_tr_b16 a[196:197], v25 offset:9216
    ds_read_b64_tr_b16 a[198:199], v25 offset:9728
    buffer_atomic_add v202, v205, s[60:63], 0 offen
    v_mfma_f32_32x32x16_bf16 v[176:191], a[172:175], a[176:179], v[176:191]
    s_mul_i32 s8, s77, 1728
    s_add_u32 m0, s92, 49152
    s_nop 0
    buffer_load_dwordx4 v20, s[52:55], s8 offen offset:0 lds
    s_waitcnt lgkmcnt(6)
    v_mfma_f32_32x32x16_bf16 v[64:79], a[184:187], a[132:135], v[64:79]
    ds_read_b64_tr_b16 a[160:161], v22 offset:2048
    ds_read_b64_tr_b16 a[162:163], v22 offset:2560
    v_mfma_f32_32x32x16_bf16 v[128:143], a[184:187], a[180:183], v[128:143]
    s_add_u32 s8, s8, 54272
    buffer_load_dwordx4 v20, s[52:55], s8 offen offset:1024 lds
    v_mfma_f32_32x32x16_bf16 v[80:95], a[188:191], a[132:135], v[80:95]
    ds_read_b64_tr_b16 a[164:165], v25 offset:2048
    ds_read_b64_tr_b16 a[166:167], v25 offset:2560
    v_mfma_f32_32x32x16_bf16 v[144:159], a[188:191], a[180:183], v[144:159]
    s_lshl_b32 s64, s40, 11
    s_add_u32 s64, s64, 87040
    s_waitcnt lgkmcnt(4)
    v_mfma_f32_32x32x16_bf16 v[96:111], a[192:195], a[132:135], v[96:111]
    ds_read_b64_tr_b16 a[168:169], v22 offset:10240
    ds_read_b64_tr_b16 a[170:171], v22 offset:10752
    v_mfma_f32_32x32x16_bf16 v[160:175], a[192:195], a[180:183], v[160:175]
    s_lshl_b32 s65, s38, 8
    s_add_u32 s64, s64, s65
    v_mfma_f32_32x32x16_bf16 v[112:127], a[196:199], a[132:135], v[112:127]
    ds_read_b64_tr_b16 a[172:173], v25 offset:10240
    ds_read_b64_tr_b16 a[174:175], v25 offset:10752
    v_mfma_f32_32x32x16_bf16 v[176:191], a[196:199], a[180:183], v[176:191]
    s_cmp_lt_u32 s39, 10
    s_cselect_b32 s64, s64, 0x40000000
    s_waitcnt lgkmcnt(4)
    v_mfma_f32_32x32x16_bf16 v[64:79], a[160:163], a[136:139], v[64:79]
    ds_read_b64_tr_b16 a[184:185], v22 offset:3072
    ds_read_b64_tr_b16 a[186:187], v22 offset:3584
    v_mfma_f32_32x32x16_bf16 v[128:143], a[160:163], a[200:203], v[128:143]
    s_cmp_lt_u32 s38, 3
    s_cselect_b32 s64, s64, 0x40000000
    v_mfma_f32_32x32x16_bf16 v[80:95], a[164:167], a[136:139], v[80:95]
    ds_read_b64_tr_b16 a[188:189], v25 offset:3072
    ds_read_b64_tr_b16 a[190:191], v25 offset:3584
    v_mfma_f32_32x32x16_bf16 v[144:159], a[164:167], a[200:203], v[144:159]
    v_lshlrev_b32 v30, 2, v1
    v_add_u32 v30, s64, v30
    s_waitcnt lgkmcnt(4)
    v_mfma_f32_32x32x16_bf16 v[96:111], a[168:171], a[136:139], v[96:111]
    ds_read_b64_tr_b16 a[192:193], v22 offset:11264
    ds_read_b64_tr_b16 a[194:195], v22 offset:11776
    v_mfma_f32_32x32x16_bf16 v[160:175], a[168:171], a[200:203], v[160:175]
    s_lshl_b32 s64, s40, 8
    s_add_u32 s64, s64, 65664
    v_mfma_f32_32x32x16_bf16 v[112:127], a[172:175], a[136:139], v[112:127]
    ds_read_b64_tr_b16 a[196:197], v25 offset:11264
    ds_read_b64_tr_b16 a[198:199], v25 offset:11776
    v_mfma_f32_32x32x16_bf16 v[176:191], a[172:175], a[200:203], v[176:191]
    s_cmp_lt_u32 s39, 10
    s_cselect_b32 s64, s64, 0x40000000
    s_waitcnt lgkmcnt(4)
    v_mfma_f32_32x32x16_bf16 v[64:79], a[184:187], a[140:143], v[64:79]
    s_cmp_eq_u32 s38, 0
    s_cselect_b32 s64, s64, 0x40000000
    v_mfma_f32_32x32x16_bf16 v[128:143], a[184:187], a[204:207], v[128:143]
    v_mov_b32 v31, 0x40000000
    v_writelane_b32 v31, s64, 0
    s_waitcnt vmcnt(17) lgkmcnt(0)
    v_mfma_f32_32x32x16_bf16 v[80:95], a[188:191], a[140:143], v[80:95]
    s_barrier
    ds_read_b128 a[144:147], v12 offset:49152
    ds_read_b128 a[176:179], v56 offset:49152
    v_mfma_f32_32x32x16_bf16 v[144:159], a[188:191], a[204:207], v[144:159]
    ds_read_b64_tr_b16 a[160:161], v21 offset:0
    ds_read_b64_tr_b16 a[162:163], v21 offset:512
    v_mfma_f32_32x32x16_bf16 v[96:111], a[192:195], a[140:143], v[96:111]
    ds_read_b64_tr_b16 a[164:165], v24 offset:0
    ds_read_b64_tr_b16 a[166:167], v24 offset:512
    v_mfma_f32_32x32x16_bf16 v[160:175], a[192:195], a[204:207], v[160:175]
    ds_read_b64_tr_b16 a[168:169], v21 offset:8192
    ds_read_b64_tr_b16 a[170:171], v21 offset:8704
    v_mfma_f32_32x32x16_bf16 v[112:127], a[196:199], a[140:143], v[112:127]
    ds_read_b64_tr_b16 a[172:173], v24 offset:8192
    ds_read_b64_tr_b16 a[174:175], v24 offset:8704
    v_mfma_f32_32x32x16_bf16 v[176:191], a[196:199], a[204:207], v[176:191]
    s_mul_i32 s9, s78, 1728
    s_add_u32 m0, s43, 65536
    s_add_u32 s9, s9, 256
    buffer_load_dwordx4 v16, s[48:51], s9 offen offset:0 lds
    s_waitcnt lgkmcnt(4)
    v_mfma_f32_32x32x16_bf16 v[64:79], a[160:163], a[144:147], v[64:79]
    ds_read_b128 a[148:151], v13 offset:49152
    ds_read_b128 a[180:183], v57 offset:49152
    v_mfma_f32_32x32x16_bf16 v[128:143], a[160:163], a[176:179], v[128:143]
    ds_read_b64_tr_b16 a[184:185], v21 offset:1024
    ds_read_b64_tr_b16 a[186:187], v21 offset:1536
    buffer_load_dwordx4 v17, s[48:51], s9 offen offset:1024 lds
    v_mfma_f32_32x32x16_bf16 v[80:95], a[164:167], a[144:147], v[80:95]
    ds_read_b128 a[152:155], v14 offset:49152
    ds_read_b128 a[200:203], v58 offset:49152
    v_mfma_f32_32x32x16_bf16 v[144:159], a[164:167], a[176:179], v[144:159]
    ds_read_b64_tr_b16 a[188:189], v24 offset:1024
    ds_read_b64_tr_b16 a[190:191], v24 offset:1536
    buffer_load_dwordx4 v18, s[48:51], s9 offen offset:2048 lds
    s_waitcnt lgkmcnt(8)
    v_mfma_f32_32x32x16_bf16 v[96:111], a[168:171], a[144:147], v[96:111]
    ds_read_b128 a[156:159], v15 offset:49152
    ds_read_b128 a[204:207], v59 offset:49152
    v_mfma_f32_32x32x16_bf16 v[160:175], a[168:171], a[176:179], v[160:175]
    ds_read_b64_tr_b16 a[192:193], v21 offset:9216
    ds_read_b64_tr_b16 a[194:195], v21 offset:9728
    buffer_load_dwordx4 v19, s[48:51], s9 offen offset:3072 lds
    v_mfma_f32_32x32x16_bf16 v[112:127], a[172:175], a[144:147], v[112:127]
    ds_read_b64_tr_b16 a[196:197], v24 offset:9216
    ds_read_b64_tr_b16 a[198:199], v24 offset:9728
    s_waitcnt vmcnt(15)
    v_mul_f32 v5, 0.0015625, v198
    v_mul_f32 v12, 0.0015625, v199
    v_fma_f32 v12, -v5, v5, v12
    v_mfma_f32_32x32x16_bf16 v[176:191], a[172:175], a[176:179], v[176:191]
    s_mul_i32 s8, s78, 1728
    s_add_u32 m0, s92, 81920
    s_nop 0
    buffer_load_dwordx4 v20, s[52:55], s8 offen offset:0 lds
    s_waitcnt lgkmcnt(6)
    v_mfma_f32_32x32x16_bf16 v[64:79], a[184:187], a[148:151], v[64:79]
    ds_read_b64_tr_b16 a[160:161], v21 offset:2048
    ds_read_b64_tr_b16 a[162:163], v21 offset:2560
    v_max_f32 v12, 0, v12
    v_add_f32 v12, 0x3727c5ac, v12
    v_mfma_f32_32x32x16_bf16 v[128:143], a[184:187], a[180:183], v[128:143]
    s_add_u32 s8, s8, 54272
    buffer_load_dwordx4 v20, s[52:55], s8 offen offset:1024 lds
    v_mfma_f32_32x32x16_bf16 v[80:95], a[188:191], a[148:151], v[80:95]
    ds_read_b64_tr_b16 a[164:165], v24 offset:2048
    ds_read_b64_tr_b16 a[166:167], v24 offset:2560
    v_rsq_f32 v4, v12
    v_sub_f32 v12, 0, v5
    v_mfma_f32_32x32x16_bf16 v[144:159], a[188:191], a[180:183], v[144:159]
    v_cvt_pk_bf16_f32 v32, v12, v12
    v_and_b32 v13, s11, v32
    v_sub_f32 v14, v12, v13
    v_cvt_pk_bf16_f32 v33, v14, v12
    v_lshlrev_b32 v13, 16, v33
    s_waitcnt lgkmcnt(4)
    v_mfma_f32_32x32x16_bf16 v[96:111], a[192:195], a[148:151], v[96:111]
    ds_read_b64_tr_b16 a[168:169], v21 offset:10240
    ds_read_b64_tr_b16 a[170:171], v21 offset:10752
    v_sub_f32 v12, v14, v13
    v_cvt_pk_bf16_f32 v34, v12, v14
    v_mfma_f32_32x32x16_bf16 v[160:175], a[192:195], a[180:183], v[160:175]
    v_cmp_eq_u32 vcc, 0, v3
    v_mov_b32 v35, 0
    v_mov_b32 v39, 0
    v_cndmask_b32 v36, v32, v35, vcc
    v_cndmask_b32 v37, v33, v35, vcc
    v_mfma_f32_32x32x16_bf16 v[112:127], a[196:199], a[148:151], v[112:127]
    ds_read_b64_tr_b16 a[172:173], v24 offset:10240
    ds_read_b64_tr_b16 a[174:175], v24 offset:10752
    v_cndmask_b32 v38, v34, v35, vcc
    v_cndmask_b32 v32, v35, v32, vcc
    v_cndmask_b32 v33, v35, v33, vcc
    v_mfma_f32_32x32x16_bf16 v[176:191], a[196:199], a[180:183], v[176:191]
    v_cndmask_b32 v34, v35, v34, vcc
    v_mul_f32 v4, v4, v4
    s_waitcnt vmcnt(15)
    v_mul_f32 v5, 0.0015625, v206
    v_mul_f32 v12, 0.0015625, v207
    v_fma_f32 v12, -v5, v5, v12
    s_waitcnt lgkmcnt(4)
    v_mfma_f32_32x32x16_bf16 v[64:79], a[160:163], a[152:155], v[64:79]
    ds_read_b64_tr_b16 a[184:185], v21 offset:3072
    ds_read_b64_tr_b16 a[186:187], v21 offset:3584
    v_max_f32 v12, 0, v12
    v_add_f32 v12, 0x3727c5ac, v12
    v_mfma_f32_32x32x16_bf16 v[128:143], a[160:163], a[200:203], v[128:143]
    v_rsq_f32 v0, v12
    v_sub_f32 v12, 0, v5
    v_cvt_pk_bf16_f32 v48, v12, v12
    v_and_b32 v13, s11, v48
    v_mfma_f32_32x32x16_bf16 v[80:95], a[164:167], a[152:155], v[80:95]
    ds_read_b64_tr_b16 a[188:189], v24 offset:3072
    ds_read_b64_tr_b16 a[190:191], v24 offset:3584
    v_sub_f32 v14, v12, v13
    v_cvt_pk_bf16_f32 v49, v14, v12
    v_lshlrev_b32 v13, 16, v49
    v_mfma_f32_32x32x16_bf16 v[144:159], a[164:167], a[200:203], v[144:159]
    v_sub_f32 v12, v14, v13
    v_cvt_pk_bf16_f32 v50, v12, v14
    v_cmp_eq_u32 vcc, 0, v3
    v_mov_b32 v51, 0
    v_mov_b32 v55, 0
    s_waitcnt lgkmcnt(4)
    v_mfma_f32_32x32x16_bf16 v[96:111], a[168:171], a[152:155], v[96:111]
    ds_read_b64_tr_b16 a[192:193], v21 offset:11264
    ds_read_b64_tr_b16 a[194:195], v21 offset:11776
    v_cndmask_b32 v52, v48, v51, vcc
    v_cndmask_b32 v53, v49, v51, vcc
    v_mfma_f32_32x32x16_bf16 v[160:175], a[168:171], a[200:203], v[160:175]
    v_cndmask_b32 v54, v50, v51, vcc
    v_cndmask_b32 v48, v51, v48, vcc
    v_cndmask_b32 v49, v51, v49, vcc
    v_cndmask_b32 v50, v51, v50, vcc
    v_mul_f32 v0, v0, v0
    v_mfma_f32_32x32x16_bf16 v[112:127], a[172:175], a[152:155], v[112:127]
    ds_read_b64_tr_b16 a[196:197], v24 offset:11264
    ds_read_b64_tr_b16 a[198:199], v24 offset:11776
    s_waitcnt vmcnt(12)
    v_cvt_pk_bf16_f32 v12, v200, v200
    v_and_b32 v12, s11, v12
    v_sub_f32 v12, v200, v12
    v_mfma_f32_32x32x16_bf16 v[176:191], a[172:175], a[200:203], v[176:191]
    v_cvt_pk_bf16_f32 v40, v200, v12
    v_and_b32 v13, s11, v40
    v_sub_f32 v12, v12, v13
    v_cvt_pk_bf16_f32 v41, v200, v12
    v_mov_b32 v42, v40
    s_waitcnt lgkmcnt(4)
    v_subrev_u32 v21, s74, v21
    v_subrev_u32 v22, s74, v22
    v_subrev_u32 v23, s74, v23
    v_subrev_u32 v24, s74, v24
    v_subrev_u32 v25, s74, v25
    v_subrev_u32 v26, s74, v26
    v_mfma_f32_32x32x16_bf16 v[64:79], a[184:187], a[156:159], v[64:79]
    v_mfma_f32_32x32x16_bf16 v[128:143], a[184:187], a[204:207], v[128:143]
    v_mov_b32 v43, 0
    s_waitcnt vmcnt(10)
    v_cvt_pk_bf16_f32 v12, v201, v201
    v_and_b32 v12, s11, v12
    v_sub_f32 v12, v201, v12
    s_waitcnt lgkmcnt(0)
    v_mfma_f32_32x32x16_bf16 v[80:95], a[188:191], a[156:159], v[80:95]
    s_barrier
    ds_read_b64_tr_b16 a[160:161], v23 offset:0
    ds_read_b64_tr_b16 a[162:163], v23 offset:512
    v_mfma_f32_32x32x16_bf16 v[144:159], a[188:191], a[204:207], v[144:159]
    ds_read_b64_tr_b16 a[164:165], v26 offset:0
    ds_read_b64_tr_b16 a[166:167], v26 offset:512
    v_cvt_pk_bf16_f32 v44, v201, v12
    v_and_b32 v13, s11, v44
    v_sub_f32 v12, v12, v13
    v_mfma_f32_32x32x16_bf16 v[96:111], a[192:195], a[156:159], v[96:111]
    ds_read_b64_tr_b16 a[168:169], v23 offset:8192
    ds_read_b64_tr_b16 a[170:171], v23 offset:8704
    v_cvt_pk_bf16_f32 v45, v201, v12
    v_mfma_f32_32x32x16_bf16 v[160:175], a[192:195], a[204:207], v[160:175]
    ds_read_b64_tr_b16 a[172:173], v26 offset:8192
    ds_read_b64_tr_b16 a[174:175], v26 offset:8704
    v_mov_b32 v46, v44
    v_mov_b32 v47, 0
    v_mfma_f32_32x32x16_bf16 v[112:127], a[196:199], a[156:159], v[112:127]
    ds_read_b64_tr_b16 a[176:177], v29 offset:16384
    ds_read_b64_tr_b16 a[178:179], v29 offset:16640
    v_mfma_f32_32x32x16_bf16 v[176:191], a[196:199], a[204:207], v[176:191]
    ds_read_b64_tr_b16 a[180:181], v29 offset:20480
    ds_read_b64_tr_b16 a[182:183], v29 offset:20736
    s_mul_i32 s9, s79, 1728
    s_add_u32 m0, s43, 98304
    s_add_u32 s9, s9, 256
    buffer_load_dwordx4 v16, s[48:51], s9 offen offset:0 lds
    s_waitcnt lgkmcnt(6)
    v_mfma_f32_32x32x16_bf16 v[192:207], a[160:163], a[0:3], 0
    ds_read_b64_tr_b16 a[184:185], v23 offset:1024
    ds_read_b64_tr_b16 a[186:187], v23 offset:1536
    ds_read_b64_tr_b16 v[8:9], v60 offset:0
    buffer_load_dwordx4 v17, s[48:51], s9 offen offset:1024 lds
    v_mfma_f32_32x32x16_bf16 v[208:223], a[164:167], a[0:3], 0
    ds_read_b64_tr_b16 a[188:189], v26 offset:1024
    ds_read_b64_tr_b16 a[190:191], v26 offset:1536
    ds_read_b64_tr_b16 v[10:11], v61 offset:0
    ds_read_b64_tr_b16 v[12:13], v62 offset:0
    ds_read_b64_tr_b16 v[14:15], v63 offset:0
    v_mfma_f32_32x32x16_bf16 v[64:79], v[40:43], v[32:35], v[64:79]
    v_mfma_f32_32x32x16_bf16 v[224:239], a[168:171], a[0:3], 0
    ds_read_b64_tr_b16 a[192:193], v23 offset:9216
    s_waitcnt lgkmcnt(14)
    ds_read_b64_tr_b16 a[194:195], v23 offset:9728
    v_mfma_f32_32x32x16_bf16 v[80:95], v[40:43], v[36:39], v[80:95]
    buffer_load_dwordx4 v18, s[48:51], s9 offen offset:2048 lds
    s_waitcnt lgkmcnt(10)
    v_mfma_f32_32x32x16_bf16 v[240:255], a[172:175], a[0:3], 0
    ds_read_b64_tr_b16 a[196:197], v26 offset:9216
    ds_read_b64_tr_b16 a[198:199], v26 offset:9728
    s_waitcnt lgkmcnt(6)
    v_mfma_f32_16x16x32_bf16 v[56:59], a[240:243], v[8:11], 0
    s_waitcnt lgkmcnt(4)
    v_mfma_f32_16x16x32_bf16 v[56:59], a[244:247], v[12:15], v[56:59]
    v_mfma_f32_32x32x16_bf16 a[208:223], a[176:179], a[0:3], 0
    ds_read_b64_tr_b16 a[200:201], v29 offset:17408
    ds_read_b64_tr_b16 a[202:203], v29 offset:17664
    v_mfma_f32_32x32x16_bf16 v[96:111], v[44:47], v[32:35], v[96:111]
    buffer_load_dwordx4 v19, s[48:51], s9 offen offset:3072 lds
    v_mfma_f32_32x32x16_bf16 a[224:239], a[180:183], a[0:3], 0
    ds_read_b64_tr_b16 a[204:205], v29 offset:21504
    ds_read_b64_tr_b16 a[206:207], v29 offset:21760
    v_mfma_f32_32x32x16_bf16 v[112:127], v[44:47], v[36:39], v[112:127]
    ds_read_b64_tr_b16 v[8:9], v60 offset:1024
    ds_read_b64_tr_b16 v[10:11], v61 offset:1024
    ds_read_b64_tr_b16 v[12:13], v62 offset:1024
    s_waitcnt lgkmcnt(9)
    v_mfma_f32_32x32x16_bf16 v[192:207], a[184:187], a[4:7], v[192:207]
    ds_read_b64_tr_b16 a[160:161], v23 offset:2048
    ds_read_b64_tr_b16 a[162:163], v23 offset:2560
    s_mul_i32 s8, s79, 1728
    s_add_u32 m0, s92, 114688
    s_nop 0
    buffer_load_dwordx4 v20, s[52:55], s8 offen offset:0 lds
    v_mfma_f32_32x32x16_bf16 v[208:223], a[188:191], a[4:7], v[208:223]
    ds_read_b64_tr_b16 a[164:165], v26 offset:2048
    ds_read_b64_tr_b16 a[166:167], v26 offset:2560
    ds_read_b64_tr_b16 v[14:15], v63 offset:1024
    v_mfma_f32_32x32x16_bf16 v[128:143], v[40:43], v[48:51], v[128:143]
    v_mfma_f32_32x32x16_bf16 v[144:159], v[40:43], v[52:55], v[144:159]
    v_mfma_f32_32x32x16_bf16 v[224:239], a[192:195], a[4:7], v[224:239]
    ds_read_b64_tr_b16 a[168:169], v23 offset:10240
    s_waitcnt lgkmcnt(14)
    ds_read_b64_tr_b16 a[170:171], v23 offset:10752
    s_add_u32 s8, s8, 54272
    buffer_load_dwordx4 v20, s[52:55], s8 offen offset:1024 lds
    s_waitcnt lgkmcnt(10)
    v_mfma_f32_32x32x16_bf16 v[240:255], a[196:199], a[4:7], v[240:255]
    ds_read_b64_tr_b16 a[172:173], v26 offset:10240
    ds_read_b64_tr_b16 a[174:175], v26 offset:10752
    s_waitcnt lgkmcnt(10)
    v_mfma_f32_16x16x32_bf16 v[56:59], a[240:243], v[8:11], v[56:59]
    s_waitcnt lgkmcnt(4)
    v_mfma_f32_16x16x32_bf16 v[56:59], a[244:247], v[12:15], v[56:59]
    v_mfma_f32_32x32x16_bf16 a[208:223], a[200:203], a[4:7], a[208:223]
    ds_read_b64_tr_b16 a[176:177], v29 offset:18432
    ds_read_b64_tr_b16 a[178:179], v29 offset:18688
    s_mul_i32 s9, s80, 1728
    s_add_u32 m0, s43, 0
    s_add_u32 s9, s9, 256
    buffer_load_dwordx4 v16, s[48:51], s9 offen offset:0 lds
    v_mfma_f32_32x32x16_bf16 a[224:239], a[204:207], a[4:7], a[224:239]
    ds_read_b64_tr_b16 a[180:181], v29 offset:22528
    ds_read_b64_tr_b16 a[182:183], v29 offset:22784
    v_mfma_f32_32x32x16_bf16 v[160:175], v[44:47], v[48:51], v[160:175]
    v_mfma_f32_32x32x16_bf16 v[176:191], v[44:47], v[52:55], v[176:191]
    ds_read_b64_tr_b16 v[8:9], v60 offset:2048
    s_waitcnt lgkmcnt(7)
    v_mfma_f32_32x32x16_bf16 v[192:207], a[160:163], a[8:11], v[192:207]
    ds_read_b64_tr_b16 a[184:185], v23 offset:3072
    ds_read_b64_tr_b16 a[186:187], v23 offset:3584
    ds_read_b64_tr_b16 v[10:11], v61 offset:2048
    buffer_load_dwordx4 v17, s[48:51], s9 offen offset:1024 lds
    v_mfma_f32_32x32x16_bf16 v[208:223], a[164:167], a[8:11], v[208:223]
    ds_read_b64_tr_b16 a[188:189], v26 offset:3072
    ds_read_b64_tr_b16 a[190:191], v26 offset:3584
    ds_read_b64_tr_b16 v[12:13], v62 offset:2048
    ds_read_b64_tr_b16 v[14:15], v63 offset:2048
    s_waitcnt lgkmcnt(4)
    v_mfma_f32_16x16x32_bf16 v[56:59], a[240:243], v[8:11], v[56:59]
    s_waitcnt lgkmcnt(0)
    v_mfma_f32_16x16x32_bf16 v[56:59], a[244:247], v[12:15], v[56:59]
    v_mfma_f32_32x32x16_bf16 v[224:239], a[168:171], a[8:11], v[224:239]
    ds_read_b64_tr_b16 a[192:193], v23 offset:11264
    ds_read_b64_tr_b16 a[194:195], v23 offset:11776
    v_max_f32 v64, 0, v64
    v_max_f32 v65, 0, v65
    buffer_load_dwordx4 v18, s[48:51], s9 offen offset:2048 lds
    v_mfma_f32_32x32x16_bf16 v[240:255], a[172:175], a[8:11], v[240:255]
    ds_read_b64_tr_b16 a[196:197], v26 offset:11264
    ds_read_b64_tr_b16 a[198:199], v26 offset:11776
    v_pk_mul_f32 v[96:97], v[96:97], v[4:5] op_sel_hi:[1,0]
    v_pk_mul_f32 v[64:65], v[64:65], v[96:97]
    v_cvt_pk_bf16_f32 v64, v64, v65
    ds_read_b64_tr_b16 v[8:9], v60 offset:3072
    v_mfma_f32_32x32x16_bf16 a[208:223], a[176:179], a[8:11], a[208:223]
    ds_read_b64_tr_b16 a[200:201], v29 offset:19456
    ds_read_b64_tr_b16 a[202:203], v29 offset:19712
    ds_read_b64_tr_b16 v[10:11], v61 offset:3072
    buffer_load_dwordx4 v19, s[48:51], s9 offen offset:3072 lds
    v_mfma_f32_32x32x16_bf16 a[224:239], a[180:183], a[8:11], a[224:239]
    ds_read_b64_tr_b16 a[204:205], v29 offset:23552
    ds_read_b64_tr_b16 a[206:207], v29 offset:23808
    ds_read_b64_tr_b16 v[12:13], v62 offset:3072
    ds_read_b64_tr_b16 v[14:15], v63 offset:3072
    v_max_f32 v66, 0, v66
    v_max_f32 v67, 0, v67
    v_pk_mul_f32 v[98:99], v[98:99], v[4:5] op_sel_hi:[1,0]
    s_waitcnt lgkmcnt(10)
    v_mfma_f32_32x32x16_bf16 v[192:207], a[184:187], a[12:15], v[192:207]
    v_pk_mul_f32 v[66:67], v[66:67], v[98:99]
    v_cvt_pk_bf16_f32 v65, v66, v67
    s_waitcnt lgkmcnt(4)
    v_mfma_f32_16x16x32_bf16 v[56:59], a[240:243], v[8:11], v[56:59]
    s_waitcnt lgkmcnt(0)
    v_mfma_f32_16x16x32_bf16 v[56:59], a[244:247], v[12:15], v[56:59]
    v_max_f32 v68, 0, v68
    v_max_f32 v69, 0, v69
    v_pk_mul_f32 v[100:101], v[100:101], v[4:5] op_sel_hi:[1,0]
    s_waitcnt vmcnt(16)
    v_mfma_f32_32x32x16_bf16 v[208:223], a[188:191], a[12:15], v[208:223]
    s_barrier
    ds_read_b64_tr_b16 a[160:161], v21 offset:32768
    ds_read_b64_tr_b16 a[162:163], v21 offset:33280
    ds_read_b64_tr_b16 a[164:165], v24 offset:32768
    v_pk_mul_f32 v[68:69], v[68:69], v[100:101]
    v_cvt_pk_bf16_f32 v66, v68, v69
    v_max_f32 v70, 0, v70
    v_max_f32 v71, 0, v71
    v_mfma_f32_32x32x16_bf16 v[224:239], a[192:195], a[12:15], v[224:239]
    ds_read_b64_tr_b16 a[166:167], v24 offset:33280
    ds_read_b64_tr_b16 a[168:169], v21 offset:40960
    v_pk_mul_f32 v[102:103], v[102:103], v[4:5] op_sel_hi:[1,0]
    v_pk_mul_f32 v[70:71], v[70:71], v[102:103]
    v_cvt_pk_bf16_f32 v67, v70, v71
    v_max_f32 v72, 0, v72
    v_max_f32 v73, 0, v73
    v_pk_mul_f32 v[104:105], v[104:105], v[4:5] op_sel_hi:[1,0]
    v_pk_mul_f32 v[72:73], v[72:73], v[104:105]
    v_cvt_pk_bf16_f32 v68, v72, v73
    v_mfma_f32_32x32x16_bf16 v[240:255], a[196:199], a[12:15], v[240:255]
    ds_read_b64_tr_b16 a[170:171], v21 offset:41472
    ds_read_b64_tr_b16 a[172:173], v24 offset:40960
    ds_read_b64_tr_b16 a[174:175], v24 offset:41472
    v_max_f32 v74, 0, v74
    v_max_f32 v75, 0, v75
    v_pk_mul_f32 v[106:107], v[106:107], v[4:5] op_sel_hi:[1,0]
    buffer_atomic_add_f32 v56, v30, s[60:63], 0 offen
    v_mfma_f32_32x32x16_bf16 a[208:223], a[200:203], a[12:15], a[208:223]
    ds_read_b64_tr_b16 a[176:177], v27 offset:49152
    ds_read_b64_tr_b16 a[178:179], v27 offset:49408
    v_pk_mul_f32 v[74:75], v[74:75], v[106:107]
    v_cvt_pk_bf16_f32 v69, v74, v75
    v_max_f32 v76, 0, v76
    v_max_f32 v77, 0, v77
    v_mfma_f32_32x32x16_bf16 a[224:239], a[204:207], a[12:15], a[224:239]
    ds_read_b64_tr_b16 a[180:181], v27 offset:53248
    ds_read_b64_tr_b16 a[182:183], v27 offset:53504
    v_pk_mul_f32 v[108:109], v[108:109], v[4:5] op_sel_hi:[1,0]
    v_pk_mul_f32 v[76:77], v[76:77], v[108:109]
    v_cvt_pk_bf16_f32 v70, v76, v77
    s_waitcnt lgkmcnt(6)
    v_mfma_f32_32x32x16_bf16 v[192:207], a[160:163], a[16:19], v[192:207]
    ds_read_b64_tr_b16 a[184:185], v21 offset:33792
    ds_read_b64_tr_b16 a[186:187], v21 offset:34304
    s_mul_i32 s8, s80, 1728
    s_add_u32 m0, s92, 16384
    s_nop 0
    buffer_load_dwordx4 v20, s[52:55], s8 offen offset:0 lds
    v_mfma_f32_32x32x16_bf16 v[208:223], a[164:167], a[16:19], v[208:223]
    ds_read_b64_tr_b16 a[188:189], v24 offset:33792
    ds_read_b64_tr_b16 a[190:191], v24 offset:34304
    v_max_f32 v78, 0, v78
    v_max_f32 v79, 0, v79
    v_pk_mul_f32 v[110:111], v[110:111], v[4:5] op_sel_hi:[1,0]
    v_pk_mul_f32 v[78:79], v[78:79], v[110:111]
    v_mfma_f32_32x32x16_bf16 v[224:239], a[168:171], a[16:19], v[224:239]
    ds_read_b64_tr_b16 a[192:193], v21 offset:41984
    ds_read_b64_tr_b16 a[194:195], v21 offset:42496
    s_add_u32 s8, s8, 54272
    buffer_load_dwordx4 v20, s[52:55], s8 offen offset:1024 lds
    s_waitcnt lgkmcnt(6)
    v_mfma_f32_32x32x16_bf16 v[240:255], a[172:175], a[16:19], v[240:255]
    ds_read_b64_tr_b16 a[196:197], v24 offset:41984
    ds_read_b64_tr_b16 a[198:199], v24 offset:42496
    v_cvt_pk_bf16_f32 v71, v78, v79
    s_add_u32 s41, s70, 0
    buffer_store_dwordx4 v[64:67], v6, s[56:59], s41 offen offset:0 sc1
    v_mfma_f32_32x32x16_bf16 a[208:223], a[176:179], a[16:19], a[208:223]
    ds_read_b64_tr_b16 a[200:201], v27 offset:50176
    ds_read_b64_tr_b16 a[202:203], v27 offset:50432
    s_mul_i32 s9, s81, 1728
    s_add_u32 m0, s43, 131072
    s_add_u32 s9, s9, 256
    buffer_load_dwordx4 v16, s[48:51], s9 offen offset:0 lds
    v_mfma_f32_32x32x16_bf16 a[224:239], a[180:183], a[16:19], a[224:239]
    ds_read_b64_tr_b16 a[204:205], v27 offset:54272
    ds_read_b64_tr_b16 a[206:207], v27 offset:54528
    buffer_store_dwordx4 v[68:71], v6, s[56:59], s41 offen offset:512 sc1
    v_max_f32 v80, 0, v80
    v_max_f32 v81, 0, v81
    s_waitcnt lgkmcnt(6)
    v_mfma_f32_32x32x16_bf16 v[192:207], a[184:187], a[20:23], v[192:207]
    ds_read_b64_tr_b16 a[160:161], v21 offset:34816
    ds_read_b64_tr_b16 a[162:163], v21 offset:35328
    buffer_load_dwordx4 v17, s[48:51], s9 offen offset:1024 lds
    v_mfma_f32_32x32x16_bf16 v[208:223], a[188:191], a[20:23], v[208:223]
    ds_read_b64_tr_b16 a[164:165], v24 offset:34816
    ds_read_b64_tr_b16 a[166:167], v24 offset:35328
    v_pk_mul_f32 v[112:113], v[112:113], v[4:5] op_sel_hi:[1,0]
    v_pk_mul_f32 v[80:81], v[80:81], v[112:113]
    v_cvt_pk_bf16_f32 v80, v80, v81
    v_max_f32 v82, 0, v82
    v_mfma_f32_32x32x16_bf16 v[224:239], a[192:195], a[20:23], v[224:239]
    ds_read_b64_tr_b16 a[168:169], v21 offset:43008
    ds_read_b64_tr_b16 a[170:171], v21 offset:43520
    v_max_f32 v83, 0, v83
    buffer_load_dwordx4 v18, s[48:51], s9 offen offset:2048 lds
    s_waitcnt lgkmcnt(6)
    v_mfma_f32_32x32x16_bf16 v[240:255], a[196:199], a[20:23], v[240:255]
    ds_read_b64_tr_b16 a[172:173], v24 offset:43008
    ds_read_b64_tr_b16 a[174:175], v24 offset:43520
    v_pk_mul_f32 v[114:115], v[114:115], v[4:5] op_sel_hi:[1,0]
    v_pk_mul_f32 v[82:83], v[82:83], v[114:115]
    v_cvt_pk_bf16_f32 v81, v82, v83
    v_mfma_f32_32x32x16_bf16 a[208:223], a[200:203], a[20:23], a[208:223]
    ds_read_b64_tr_b16 a[176:177], v27 offset:51200
    ds_read_b64_tr_b16 a[178:179], v27 offset:51456
    v_max_f32 v84, 0, v84
    buffer_load_dwordx4 v19, s[48:51], s9 offen offset:3072 lds
    v_mfma_f32_32x32x16_bf16 a[224:239], a[204:207], a[20:23], a[224:239]
    ds_read_b64_tr_b16 a[180:181], v27 offset:55296
    ds_read_b64_tr_b16 a[182:183], v27 offset:55552
    v_max_f32 v85, 0, v85
    v_pk_mul_f32 v[116:117], v[116:117], v[4:5] op_sel_hi:[1,0]
    v_pk_mul_f32 v[84:85], v[84:85], v[116:117]
    v_cvt_pk_bf16_f32 v82, v84, v85
    s_waitcnt lgkmcnt(6)
    v_mfma_f32_32x32x16_bf16 v[192:207], a[160:163], a[24:27], v[192:207]
    ds_read_b64_tr_b16 a[184:185], v21 offset:35840
    ds_read_b64_tr_b16 a[186:187], v21 offset:36352
    s_mul_i32 s8, s81, 1728
    s_add_u32 m0, s92, 147456
    s_nop 0
    buffer_load_dwordx4 v20, s[52:55], s8 offen offset:0 lds
    v_mfma_f32_32x32x16_bf16 v[208:223], a[164:167], a[24:27], v[208:223]
    ds_read_b64_tr_b16 a[188:189], v24 offset:35840
    ds_read_b64_tr_b16 a[190:191], v24 offset:36352
    v_max_f32 v86, 0, v86
    v_max_f32 v87, 0, v87
    v_pk_mul_f32 v[118:119], v[118:119], v[4:5] op_sel_hi:[1,0]
    v_pk_mul_f32 v[86:87], v[86:87], v[118:119]
    v_mfma_f32_32x32x16_bf16 v[224:239], a[168:171], a[24:27], v[224:239]
    ds_read_b64_tr_b16 a[192:193], v21 offset:44032
    ds_read_b64_tr_b16 a[194:195], v21 offset:44544
    s_add_u32 s8, s8, 54272
    buffer_load_dwordx4 v20, s[52:55], s8 offen offset:1024 lds
    s_waitcnt lgkmcnt(6)
    v_mfma_f32_32x32x16_bf16 v[240:255], a[172:175], a[24:27], v[240:255]
    ds_read_b64_tr_b16 a[196:197], v24 offset:44032
    ds_read_b64_tr_b16 a[198:199], v24 offset:44544
    v_cvt_pk_bf16_f32 v83, v86, v87
    v_max_f32 v88, 0, v88
    v_max_f32 v89, 0, v89
    v_mfma_f32_32x32x16_bf16 a[208:223], a[176:179], a[24:27], a[208:223]
    ds_read_b64_tr_b16 a[200:201], v27 offset:52224
    ds_read_b64_tr_b16 a[202:203], v27 offset:52480
    v_pk_mul_f32 v[120:121], v[120:121], v[4:5] op_sel_hi:[1,0]
    v_pk_mul_f32 v[88:89], v[88:89], v[120:121]
    v_cvt_pk_bf16_f32 v84, v88, v89
    v_max_f32 v90, 0, v90
    v_mfma_f32_32x32x16_bf16 a[224:239], a[180:183], a[24:27], a[224:239]
    ds_read_b64_tr_b16 a[204:205], v27 offset:56320
    ds_read_b64_tr_b16 a[206:207], v27 offset:56576
    v_max_f32 v91, 0, v91
    v_pk_mul_f32 v[122:123], v[122:123], v[4:5] op_sel_hi:[1,0]
    v_pk_mul_f32 v[90:91], v[90:91], v[122:123]
    v_cvt_pk_bf16_f32 v85, v90, v91
    s_waitcnt lgkmcnt(6)
    v_mfma_f32_32x32x16_bf16 v[192:207], a[184:187], a[28:31], v[192:207]
    v_max_f32 v92, 0, v92
    v_max_f32 v93, 0, v93
    v_pk_mul_f32 v[124:125], v[124:125], v[4:5] op_sel_hi:[1,0]
    v_pk_mul_f32 v[92:93], v[92:93], v[124:125]
    v_cvt_pk_bf16_f32 v86, v92, v93
    s_waitcnt vmcnt(21) lgkmcnt(0)
    v_mfma_f32_32x32x16_bf16 v[208:223], a[188:191], a[28:31], v[208:223]
    s_barrier
    ds_read_b64_tr_b16 a[160:161], v22 offset:0
    ds_read_b64_tr_b16 a[162:163], v22 offset:512
    ds_read_b64_tr_b16 a[164:165], v25 offset:0
    v_max_f32 v94, 0, v94
    v_mfma_f32_32x32x16_bf16 v[224:239], a[192:195], a[28:31], v[224:239]
    ds_read_b64_tr_b16 a[166:167], v25 offset:512
    ds_read_b64_tr_b16 a[168:169], v22 offset:8192
    v_max_f32 v95, 0, v95
    v_pk_mul_f32 v[126:127], v[126:127], v[4:5] op_sel_hi:[1,0]
    v_pk_mul_f32 v[94:95], v[94:95], v[126:127]
    v_cvt_pk_bf16_f32 v87, v94, v95
    v_mfma_f32_32x32x16_bf16 v[240:255], a[196:199], a[28:31], v[240:255]
    ds_read_b64_tr_b16 a[170:171], v22 offset:8704
    ds_read_b64_tr_b16 a[172:173], v25 offset:8192
    ds_read_b64_tr_b16 a[174:175], v25 offset:8704
    s_add_u32 s41, s70, 1024
    buffer_store_dwordx4 v[80:83], v6, s[56:59], s41 offen offset:0 sc1
    v_mfma_f32_32x32x16_bf16 a[208:223], a[200:203], a[28:31], a[208:223]
    ds_read_b64_tr_b16 a[176:177], v28 offset:16384
    ds_read_b64_tr_b16 a[178:179], v28 offset:16640
    buffer_store_dwordx4 v[84:87], v6, s[56:59], s41 offen offset:512 sc1
    v_max_f32 v128, 0, v128
    v_max_f32 v129, 0, v129
    v_mfma_f32_32x32x16_bf16 a[224:239], a[204:207], a[28:31], a[224:239]
    ds_read_b64_tr_b16 a[180:181], v28 offset:20480
    ds_read_b64_tr_b16 a[182:183], v28 offset:20736
    v_pk_mul_f32 v[160:161], v[160:161], v[0:1] op_sel_hi:[1,0]
    v_pk_mul_f32 v[128:129], v[128:129], v[160:161]
    v_cvt_pk_bf16_f32 v128, v128, v129
    v_max_f32 v130, 0, v130
    s_waitcnt lgkmcnt(6)
    v_mfma_f32_32x32x16_bf16 v[192:207], a[160:163], a[32:35], v[192:207]
    ds_read_b64_tr_b16 a[184:185], v22 offset:1024
    ds_read_b64_tr_b16 a[186:187], v22 offset:1536
    s_mul_i32 s9, s82, 1728
    s_add_u32 m0, s43, 32768
    s_add_u32 s9, s9, 256
    buffer_load_dwordx4 v16, s[48:51], s9 offen offset:0 lds
    v_mfma_f32_32x32x16_bf16 v[208:223], a[164:167], a[32:35], v[208:223]
    ds_read_b64_tr_b16 a[188:189], v25 offset:1024
    ds_read_b64_tr_b16 a[190:191], v25 offset:1536
    v_max_f32 v131, 0, v131
    v_pk_mul_f32 v[162:163], v[162:163], v[0:1] op_sel_hi:[1,0]
    v_pk_mul_f32 v[130:131], v[130:131], v[162:163]
    v_cvt_pk_bf16_f32 v129, v130, v131
    v_mfma_f32_32x32x16_bf16 v[224:239], a[168:171], a[32:35], v[224:239]
    ds_read_b64_tr_b16 a[192:193], v22 offset:9216
    ds_read_b64_tr_b16 a[194:195], v22 offset:9728
    v_max_f32 v132, 0, v132
    buffer_load_dwordx4 v17, s[48:51], s9 offen offset:1024 lds
    s_waitcnt lgkmcnt(6)
    v_mfma_f32_32x32x16_bf16 v[240:255], a[172:175], a[32:35], v[240:255]
    ds_read_b64_tr_b16 a[196:197], v25 offset:9216
    ds_read_b64_tr_b16 a[198:199], v25 offset:9728
    v_max_f32 v133, 0, v133
    v_pk_mul_f32 v[164:165], v[164:165], v[0:1] op_sel_hi:[1,0]
    v_pk_mul_f32 v[132:133], v[132:133], v[164:165]
    v_mfma_f32_32x32x16_bf16 a[208:223], a[176:179], a[32:35], a[208:223]
    ds_read_b64_tr_b16 a[200:201], v28 offset:17408
    ds_read_b64_tr_b16 a[202:203], v28 offset:17664
    v_cvt_pk_bf16_f32 v130, v132, v133
    buffer_load_dwordx4 v18, s[48:51], s9 offen offset:2048 lds
    v_mfma_f32_32x32x16_bf16 a[224:239], a[180:183], a[32:35], a[224:239]
    ds_read_b64_tr_b16 a[204:205], v28 offset:21504
    ds_read_b64_tr_b16 a[206:207], v28 offset:21760
    v_max_f32 v134, 0, v134
    v_max_f32 v135, 0, v135
    v_pk_mul_f32 v[166:167], v[166:167], v[0:1] op_sel_hi:[1,0]
    v_pk_mul_f32 v[134:135], v[134:135], v[166:167]
    s_waitcnt lgkmcnt(6)
    v_mfma_f32_32x32x16_bf16 v[192:207], a[184:187], a[36:39], v[192:207]
    ds_read_b64_tr_b16 a[160:161], v22 offset:2048
    ds_read_b64_tr_b16 a[162:163], v22 offset:2560
    buffer_load_dwordx4 v19, s[48:51], s9 offen offset:3072 lds
    v_mfma_f32_32x32x16_bf16 v[208:223], a[188:191], a[36:39], v[208:223]
    ds_read_b64_tr_b16 a[164:165], v25 offset:2048
    ds_read_b64_tr_b16 a[166:167], v25 offset:2560
    v_cvt_pk_bf16_f32 v131, v134, v135
    v_max_f32 v136, 0, v136
    v_max_f32 v137, 0, v137
    v_pk_mul_f32 v[168:169], v[168:169], v[0:1] op_sel_hi:[1,0]
    v_mfma_f32_32x32x16_bf16 v[224:239], a[192:195], a[36:39], v[224:239]
    ds_read_b64_tr_b16 a[168:169], v22 offset:10240
    ds_read_b64_tr_b16 a[170:171], v22 offset:10752
    s_mul_i32 s8, s82, 1728
    s_add_u32 m0, s92, 49152
    s_nop 0
    buffer_load_dwordx4 v20, s[52:55], s8 offen offset:0 lds
    s_waitcnt lgkmcnt(6)
    v_mfma_f32_32x32x16_bf16 v[240:255], a[196:199], a[36:39], v[240:255]
    ds_read_b64_tr_b16 a[172:173], v25 offset:10240
    ds_read_b64_tr_b16 a[174:175], v25 offset:10752
    v_pk_mul_f32 v[136:137], v[136:137], v[168:169]
    v_cvt_pk_bf16_f32 v132, v136, v137
    v_max_f32 v138, 0, v138
    v_mfma_f32_32x32x16_bf16 a[208:223], a[200:203], a[36:39], a[208:223]
    ds_read_b64_tr_b16 a[176:177], v28 offset:18432
    ds_read_b64_tr_b16 a[178:179], v28 offset:18688
    s_add_u32 s8, s8, 54272
    buffer_load_dwordx4 v20, s[52:55], s8 offen offset:1024 lds
    v_mfma_f32_32x32x16_bf16 a[224:239], a[204:207], a[36:39], a[224:239]
    ds_read_b64_tr_b16 a[180:181], v28 offset:22528
    ds_read_b64_tr_b16 a[182:183], v28 offset:22784
    v_max_f32 v139, 0, v139
    v_pk_mul_f32 v[170:171], v[170:171], v[0:1] op_sel_hi:[1,0]
    v_pk_mul_f32 v[138:139], v[138:139], v[170:171]
    v_cvt_pk_bf16_f32 v133, v138, v139
    s_waitcnt lgkmcnt(6)
    v_mfma_f32_32x32x16_bf16 v[192:207], a[160:163], a[40:43], v[192:207]
    ds_read_b64_tr_b16 a[184:185], v22 offset:3072
    ds_read_b64_tr_b16 a[186:187], v22 offset:3584
    v_max_f32 v140, 0, v140
    v_max_f32 v141, 0, v141
    v_pk_mul_f32 v[172:173], v[172:173], v[0:1] op_sel_hi:[1,0]
    v_mfma_f32_32x32x16_bf16 v[208:223], a[164:167], a[40:43], v[208:223]
    ds_read_b64_tr_b16 a[188:189], v25 offset:3072
    ds_read_b64_tr_b16 a[190:191], v25 offset:3584
    v_pk_mul_f32 v[140:141], v[140:141], v[172:173]
    v_cvt_pk_bf16_f32 v134, v140, v141
    v_max_f32 v142, 0, v142
    v_max_f32 v143, 0, v143
    v_mfma_f32_32x32x16_bf16 v[224:239], a[168:171], a[40:43], v[224:239]
    ds_read_b64_tr_b16 a[192:193], v22 offset:11264
    ds_read_b64_tr_b16 a[194:195], v22 offset:11776
    v_pk_mul_f32 v[174:175], v[174:175], v[0:1] op_sel_hi:[1,0]
    v_pk_mul_f32 v[142:143], v[142:143], v[174:175]
    v_cvt_pk_bf16_f32 v135, v142, v143
    s_add_u32 s41, s71, 0
    s_waitcnt lgkmcnt(6)
    v_mfma_f32_32x32x16_bf16 v[240:255], a[172:175], a[40:43], v[240:255]
    ds_read_b64_tr_b16 a[196:197], v25 offset:11264
    ds_read_b64_tr_b16 a[198:199], v25 offset:11776
    buffer_store_dwordx4 v[128:131], v6, s[56:59], s41 offen offset:0 sc1
    buffer_store_dwordx4 v[132:135], v6, s[56:59], s41 offen offset:512 sc1
    v_mfma_f32_32x32x16_bf16 a[208:223], a[176:179], a[40:43], a[208:223]
    ds_read_b64_tr_b16 a[200:201], v28 offset:19456
    ds_read_b64_tr_b16 a[202:203], v28 offset:19712
    v_max_f32 v144, 0, v144
    v_max_f32 v145, 0, v145
    v_pk_mul_f32 v[176:177], v[176:177], v[0:1] op_sel_hi:[1,0]
    v_pk_mul_f32 v[144:145], v[144:145], v[176:177]
    v_mfma_f32_32x32x16_bf16 a[224:239], a[180:183], a[40:43], a[224:239]
    ds_read_b64_tr_b16 a[204:205], v28 offset:23552
    ds_read_b64_tr_b16 a[206:207], v28 offset:23808
    v_cvt_pk_bf16_f32 v144, v144, v145
    v_max_f32 v146, 0, v146
    v_max_f32 v147, 0, v147
    v_pk_mul_f32 v[178:179], v[178:179], v[0:1] op_sel_hi:[1,0]
    s_waitcnt lgkmcnt(6)
    v_mfma_f32_32x32x16_bf16 v[192:207], a[184:187], a[44:47], v[192:207]
    v_pk_mul_f32 v[146:147], v[146:147], v[178:179]
    v_cvt_pk_bf16_f32 v145, v146, v147
    v_max_f32 v148, 0, v148
    v_max_f32 v149, 0, v149
    s_waitcnt vmcnt(20) lgkmcnt(0)
    v_mfma_f32_32x32x16_bf16 v[208:223], a[188:191], a[44:47], v[208:223]
    s_barrier
    ds_read_b64_tr_b16 a[160:161], v22 offset:32768
    ds_read_b64_tr_b16 a[162:163], v22 offset:33280
    ds_read_b64_tr_b16 a[164:165], v25 offset:32768
    v_pk_mul_f32 v[180:181], v[180:181], v[0:1] op_sel_hi:[1,0]
    v_mfma_f32_32x32x16_bf16 v[224:239], a[192:195], a[44:47], v[224:239]
    ds_read_b64_tr_b16 a[166:167], v25 offset:33280
    ds_read_b64_tr_b16 a[168:169], v22 offset:40960
    v_pk_mul_f32 v[148:149], v[148:149], v[180:181]
    v_cvt_pk_bf16_f32 v146, v148, v149
    v_max_f32 v150, 0, v150
    v_mfma_f32_32x32x16_bf16 v[240:255], a[196:199], a[44:47], v[240:255]
    ds_read_b64_tr_b16 a[170:171], v22 offset:41472
    ds_read_b64_tr_b16 a[172:173], v25 offset:40960
    ds_read_b64_tr_b16 a[174:175], v25 offset:41472
    v_mov_b32 v56, 1
    buffer_atomic_add v56, v31, s[60:63], 0 offen
    v_mfma_f32_32x32x16_bf16 a[208:223], a[200:203], a[44:47], a[208:223]
    ds_read_b64_tr_b16 a[176:177], v28 offset:49152
    ds_read_b64_tr_b16 a[178:179], v28 offset:49408
    v_max_f32 v151, 0, v151
    v_pk_mul_f32 v[182:183], v[182:183], v[0:1] op_sel_hi:[1,0]
    v_pk_mul_f32 v[150:151], v[150:151], v[182:183]
    v_cvt_pk_bf16_f32 v147, v150, v151
    v_max_f32 v152, 0, v152
    v_mfma_f32_32x32x16_bf16 a[224:239], a[204:207], a[44:47], a[224:239]
    ds_read_b64_tr_b16 a[180:181], v28 offset:53248
    ds_read_b64_tr_b16 a[182:183], v28 offset:53504
    v_max_f32 v153, 0, v153
    v_pk_mul_f32 v[184:185], v[184:185], v[0:1] op_sel_hi:[1,0]
    v_pk_mul_f32 v[152:153], v[152:153], v[184:185]
    v_lshlrev_b32 v8, 4, v1
    v_and_b32 v13, 15, v2
    s_waitcnt lgkmcnt(6)
    v_mfma_f32_32x32x16_bf16 v[192:207], a[160:163], a[48:51], v[192:207]
    ds_read_b64_tr_b16 a[184:185], v22 offset:33792
    ds_read_b64_tr_b16 a[186:187], v22 offset:34304
    s_mul_i32 s9, s83, 1728
    s_add_u32 m0, s43, 65536
    s_add_u32 s9, s9, 256
    buffer_load_dwordx4 v16, s[48:51], s9 offen offset:0 lds
    v_mfma_f32_32x32x16_bf16 v[208:223], a[164:167], a[48:51], v[208:223]
    ds_read_b64_tr_b16 a[188:189], v25 offset:33792
    ds_read_b64_tr_b16 a[190:191], v25 offset:34304
    v_lshlrev_b32 v13, 4, v13
    v_lshl_add_u32 v13, v3, 8, v13
    v_lshrrev_b32 v14, 4, v2
    v_mul_u32_u24 v11, 75776, v14
    v_mfma_f32_32x32x16_bf16 v[224:239], a[168:171], a[48:51], v[224:239]
    ds_read_b64_tr_b16 a[192:193], v22 offset:41984
    ds_read_b64_tr_b16 a[194:195], v22 offset:42496
    v_add_u32 v11, v11, v13
    buffer_load_dwordx4 v17, s[48:51], s9 offen offset:1024 lds
    s_waitcnt lgkmcnt(6)
    v_mfma_f32_32x32x16_bf16 v[240:255], a[172:175], a[48:51], v[240:255]
    ds_read_b64_tr_b16 a[196:197], v25 offset:41984
    ds_read_b64_tr_b16 a[198:199], v25 offset:42496
    v_lshl_add_u32 v12, v14, 10, v13
    v_add_u32 v13, 0x10000, v12
    v_add_u32 v14, 0x20000, v12
    v_mfma_f32_32x32x16_bf16 a[208:223], a[176:179], a[48:51], a[208:223]
    ds_read_b64_tr_b16 a[200:201], v28 offset:50176
    ds_read_b64_tr_b16 a[202:203], v28 offset:50432
    v_cvt_pk_bf16_f32 v148, v152, v153
    buffer_load_dwordx4 v18, s[48:51], s9 offen offset:2048 lds
    v_mfma_f32_32x32x16_bf16 a[224:239], a[180:183], a[48:51], a[224:239]
    ds_read_b64_tr_b16 a[204:205], v28 offset:54272
    ds_read_b64_tr_b16 a[206:207], v28 offset:54528
    v_max_f32 v154, 0, v154
    v_max_f32 v155, 0, v155
    v_pk_mul_f32 v[186:187], v[186:187], v[0:1] op_sel_hi:[1,0]
    v_pk_mul_f32 v[154:155], v[154:155], v[186:187]
    s_waitcnt lgkmcnt(6)
    v_mfma_f32_32x32x16_bf16 v[192:207], a[184:187], a[52:55], v[192:207]
    ds_read_b64_tr_b16 a[160:161], v22 offset:34816
    ds_read_b64_tr_b16 a[162:163], v22 offset:35328
    buffer_load_dwordx4 v19, s[48:51], s9 offen offset:3072 lds
    v_mfma_f32_32x32x16_bf16 v[208:223], a[188:191], a[52:55], v[208:223]
    ds_read_b64_tr_b16 a[164:165], v25 offset:34816
    ds_read_b64_tr_b16 a[166:167], v25 offset:35328
    v_cvt_pk_bf16_f32 v149, v154, v155
    v_max_f32 v156, 0, v156
    v_max_f32 v157, 0, v157
    v_pk_mul_f32 v[188:189], v[188:189], v[0:1] op_sel_hi:[1,0]
    v_pk_mul_f32 v[156:157], v[156:157], v[188:189]
    v_mfma_f32_32x32x16_bf16 v[224:239], a[192:195], a[52:55], v[224:239]
    ds_read_b64_tr_b16 a[168:169], v22 offset:43008
    ds_read_b64_tr_b16 a[170:171], v22 offset:43520
    s_mul_i32 s8, s83, 1728
    s_add_u32 m0, s92, 81920
    s_nop 0
    buffer_load_dwordx4 v20, s[52:55], s8 offen offset:0 lds
    s_waitcnt lgkmcnt(6)
    v_mfma_f32_32x32x16_bf16 v[240:255], a[196:199], a[52:55], v[240:255]
    ds_read_b64_tr_b16 a[172:173], v25 offset:43008
    ds_read_b64_tr_b16 a[174:175], v25 offset:43520
    v_cvt_pk_bf16_f32 v150, v156, v157
    v_max_f32 v158, 0, v158
    v_max_f32 v159, 0, v159
    v_mfma_f32_32x32x16_bf16 a[208:223], a[200:203], a[52:55], a[208:223]
    ds_read_b64_tr_b16 a[176:177], v28 offset:51200
    ds_read_b64_tr_b16 a[178:179], v28 offset:51456
    s_add_u32 s8, s8, 54272
    buffer_load_dwordx4 v20, s[52:55], s8 offen offset:1024 lds
    v_mfma_f32_32x32x16_bf16 a[224:239], a[204:207], a[52:55], a[224:239]
    ds_read_b64_tr_b16 a[180:181], v28 offset:55296
    ds_read_b64_tr_b16 a[182:183], v28 offset:55552
    v_pk_mul_f32 v[190:191], v[190:191], v[0:1] op_sel_hi:[1,0]
    v_pk_mul_f32 v[158:159], v[158:159], v[190:191]
    v_cvt_pk_bf16_f32 v151, v158, v159
    s_add_u32 s41, s71, 1024
    s_waitcnt lgkmcnt(6)
    v_mfma_f32_32x32x16_bf16 v[192:207], a[160:163], a[56:59], v[192:207]
    ds_read_b64_tr_b16 a[184:185], v22 offset:35840
    ds_read_b64_tr_b16 a[186:187], v22 offset:36352
    buffer_store_dwordx4 v[144:147], v6, s[56:59], s41 offen offset:0 sc1
    buffer_store_dwordx4 v[148:151], v6, s[56:59], s41 offen offset:512 sc1
    v_mfma_f32_32x32x16_bf16 v[208:223], a[164:167], a[56:59], v[208:223]
    ds_read_b64_tr_b16 a[188:189], v25 offset:35840
    ds_read_b64_tr_b16 a[190:191], v25 offset:36352
    v_mfma_f32_32x32x16_bf16 v[224:239], a[168:171], a[56:59], v[224:239]
    ds_read_b64_tr_b16 a[192:193], v22 offset:44032
    ds_read_b64_tr_b16 a[194:195], v22 offset:44544
    s_waitcnt lgkmcnt(6)
    v_mfma_f32_32x32x16_bf16 v[240:255], a[172:175], a[56:59], v[240:255]
    ds_read_b64_tr_b16 a[196:197], v25 offset:44032
    ds_read_b64_tr_b16 a[198:199], v25 offset:44544
    v_mfma_f32_32x32x16_bf16 a[208:223], a[176:179], a[56:59], a[208:223]
    ds_read_b64_tr_b16 a[200:201], v28 offset:52224
    ds_read_b64_tr_b16 a[202:203], v28 offset:52480
    v_mfma_f32_32x32x16_bf16 a[224:239], a[180:183], a[56:59], a[224:239]
    ds_read_b64_tr_b16 a[204:205], v28 offset:56320
    ds_read_b64_tr_b16 a[206:207], v28 offset:56576
    s_waitcnt lgkmcnt(6)
    v_mfma_f32_32x32x16_bf16 v[192:207], a[184:187], a[60:63], v[192:207]
    s_waitcnt vmcnt(27) lgkmcnt(0)
    v_mfma_f32_32x32x16_bf16 v[208:223], a[188:191], a[60:63], v[208:223]
    s_barrier
    ds_read_b64_tr_b16 a[160:161], v21 offset:0
    ds_read_b64_tr_b16 a[162:163], v21 offset:512
    ds_read_b64_tr_b16 a[164:165], v24 offset:0
    v_mfma_f32_32x32x16_bf16 v[224:239], a[192:195], a[60:63], v[224:239]
    ds_read_b64_tr_b16 a[166:167], v24 offset:512
    ds_read_b64_tr_b16 a[168:169], v21 offset:8192
    v_mfma_f32_32x32x16_bf16 v[240:255], a[196:199], a[60:63], v[240:255]
    ds_read_b64_tr_b16 a[170:171], v21 offset:8704
    ds_read_b64_tr_b16 a[172:173], v24 offset:8192
    ds_read_b64_tr_b16 a[174:175], v24 offset:8704
    v_mfma_f32_32x32x16_bf16 a[208:223], a[200:203], a[60:63], a[208:223]
    ds_read_b64_tr_b16 a[176:177], v27 offset:16384
    ds_read_b64_tr_b16 a[178:179], v27 offset:16640
    v_mfma_f32_32x32x16_bf16 a[224:239], a[204:207], a[60:63], a[224:239]
    ds_read_b64_tr_b16 a[180:181], v27 offset:20480
    ds_read_b64_tr_b16 a[182:183], v27 offset:20736
    s_waitcnt lgkmcnt(6)
    v_mfma_f32_32x32x16_bf16 v[192:207], a[160:163], a[64:67], v[192:207]
    ds_read_b64_tr_b16 a[184:185], v21 offset:1024
    ds_read_b64_tr_b16 a[186:187], v21 offset:1536
    s_mul_i32 s9, s84, 1728
    s_add_u32 m0, s43, 98304
    s_add_u32 s9, s9, 256
    buffer_load_dwordx4 v16, s[48:51], s9 offen offset:0 lds
    v_mfma_f32_32x32x16_bf16 v[208:223], a[164:167], a[64:67], v[208:223]
    ds_read_b64_tr_b16 a[188:189], v24 offset:1024
    ds_read_b64_tr_b16 a[190:191], v24 offset:1536
    v_mfma_f32_32x32x16_bf16 v[224:239], a[168:171], a[64:67], v[224:239]
    ds_read_b64_tr_b16 a[192:193], v21 offset:9216
    ds_read_b64_tr_b16 a[194:195], v21 offset:9728
    buffer_load_dwordx4 v17, s[48:51], s9 offen offset:1024 lds
    s_waitcnt lgkmcnt(6)
    v_mfma_f32_32x32x16_bf16 v[240:255], a[172:175], a[64:67], v[240:255]
    ds_read_b64_tr_b16 a[196:197], v24 offset:9216
    ds_read_b64_tr_b16 a[198:199], v24 offset:9728
    v_mfma_f32_32x32x16_bf16 a[208:223], a[176:179], a[64:67], a[208:223]
    ds_read_b64_tr_b16 a[200:201], v27 offset:17408
    ds_read_b64_tr_b16 a[202:203], v27 offset:17664
    buffer_load_dwordx4 v18, s[48:51], s9 offen offset:2048 lds
    v_mfma_f32_32x32x16_bf16 a[224:239], a[180:183], a[64:67], a[224:239]
    ds_read_b64_tr_b16 a[204:205], v27 offset:21504
    ds_read_b64_tr_b16 a[206:207], v27 offset:21760
    s_lshl_b32 s64, s39, 12
    s_add_u32 s64, s64, 128
    s_waitcnt lgkmcnt(6)
    v_mfma_f32_32x32x16_bf16 v[192:207], a[184:187], a[68:71], v[192:207]
    ds_read_b64_tr_b16 a[160:161], v21 offset:2048
    ds_read_b64_tr_b16 a[162:163], v21 offset:2560
    buffer_load_dwordx4 v19, s[48:51], s9 offen offset:3072 lds
    v_mfma_f32_32x32x16_bf16 v[208:223], a[188:191], a[68:71], v[208:223]
    ds_read_b64_tr_b16 a[164:165], v24 offset:2048
    ds_read_b64_tr_b16 a[166:167], v24 offset:2560
    s_cmp_eq_u32 s38, 0
    s_cselect_b32 s64, s64, 0x40000000
    v_mfma_f32_32x32x16_bf16 v[224:239], a[192:195], a[68:71], v[224:239]
    ds_read_b64_tr_b16 a[168:169], v21 offset:10240
    ds_read_b64_tr_b16 a[170:171], v21 offset:10752
    s_mul_i32 s8, s84, 1728
    s_add_u32 m0, s92, 114688
    s_nop 0
    buffer_load_dwordx4 v20, s[52:55], s8 offen offset:0 lds
    s_waitcnt lgkmcnt(6)
    v_mfma_f32_32x32x16_bf16 v[240:255], a[196:199], a[68:71], v[240:255]
    ds_read_b64_tr_b16 a[172:173], v24 offset:10240
    ds_read_b64_tr_b16 a[174:175], v24 offset:10752
    v_mfma_f32_32x32x16_bf16 a[208:223], a[200:203], a[68:71], a[208:223]
    ds_read_b64_tr_b16 a[176:177], v27 offset:18432
    ds_read_b64_tr_b16 a[178:179], v27 offset:18688
    s_add_u32 s8, s8, 54272
    buffer_load_dwordx4 v20, s[52:55], s8 offen offset:1024 lds
    v_mfma_f32_32x32x16_bf16 a[224:239], a[204:207], a[68:71], a[224:239]
    ds_read_b64_tr_b16 a[180:181], v27 offset:22528
    ds_read_b64_tr_b16 a[182:183], v27 offset:22784
    v_mov_b32 v41, 0x40000000
    s_waitcnt lgkmcnt(6)
    v_mfma_f32_32x32x16_bf16 v[192:207], a[160:163], a[72:75], v[192:207]
    ds_read_b64_tr_b16 a[184:185], v21 offset:3072
    ds_read_b64_tr_b16 a[186:187], v21 offset:3584
    v_mfma_f32_32x32x16_bf16 v[208:223], a[164:167], a[72:75], v[208:223]
    ds_read_b64_tr_b16 a[188:189], v24 offset:3072
    ds_read_b64_tr_b16 a[190:191], v24 offset:3584
    v_mfma_f32_32x32x16_bf16 v[224:239], a[168:171], a[72:75], v[224:239]
    ds_read_b64_tr_b16 a[192:193], v21 offset:11264
    ds_read_b64_tr_b16 a[194:195], v21 offset:11776
    v_writelane_b32 v41, s64, 0
    s_waitcnt lgkmcnt(6)
    v_mfma_f32_32x32x16_bf16 v[240:255], a[172:175], a[72:75], v[240:255]
    ds_read_b64_tr_b16 a[196:197], v24 offset:11264
    ds_read_b64_tr_b16 a[198:199], v24 offset:11776
    v_mfma_f32_32x32x16_bf16 a[208:223], a[176:179], a[72:75], a[208:223]
    ds_read_b64_tr_b16 a[200:201], v27 offset:19456
    ds_read_b64_tr_b16 a[202:203], v27 offset:19712
    v_mfma_f32_32x32x16_bf16 a[224:239], a[180:183], a[72:75], a[224:239]
    ds_read_b64_tr_b16 a[204:205], v27 offset:23552
    ds_read_b64_tr_b16 a[206:207], v27 offset:23808
    s_waitcnt lgkmcnt(6)
    v_mfma_f32_32x32x16_bf16 v[192:207], a[184:187], a[76:79], v[192:207]
    s_waitcnt vmcnt(6) lgkmcnt(0)
    v_mfma_f32_32x32x16_bf16 v[208:223], a[188:191], a[76:79], v[208:223]
    s_barrier
    ds_read_b64_tr_b16 a[160:161], v23 offset:0
    ds_read_b64_tr_b16 a[162:163], v23 offset:512
    ds_read_b64_tr_b16 a[164:165], v26 offset:0
    v_mfma_f32_32x32x16_bf16 v[224:239], a[192:195], a[76:79], v[224:239]
    ds_read_b64_tr_b16 a[166:167], v26 offset:512
    ds_read_b64_tr_b16 a[168:169], v23 offset:8192
    v_mov_b32 v42, 1
    buffer_atomic_add v42, v41, s[60:63], 0 offen
    v_mfma_f32_32x32x16_bf16 v[240:255], a[196:199], a[76:79], v[240:255]
    ds_read_b64_tr_b16 a[170:171], v23 offset:8704
    ds_read_b64_tr_b16 a[172:173], v26 offset:8192
    ds_read_b64_tr_b16 a[174:175], v26 offset:8704
    v_mfma_f32_32x32x16_bf16 a[208:223], a[200:203], a[76:79], a[208:223]
    ds_read_b64_tr_b16 a[176:177], v29 offset:16384
    ds_read_b64_tr_b16 a[178:179], v29 offset:16640
    v_mfma_f32_32x32x16_bf16 a[224:239], a[204:207], a[76:79], a[224:239]
    ds_read_b64_tr_b16 a[180:181], v29 offset:20480
    ds_read_b64_tr_b16 a[182:183], v29 offset:20736
    s_waitcnt lgkmcnt(6)
    v_mfma_f32_32x32x16_bf16 v[192:207], a[160:163], a[80:83], v[192:207]
    ds_read_b64_tr_b16 a[184:185], v23 offset:1024
    ds_read_b64_tr_b16 a[186:187], v23 offset:1536
    s_mul_i32 s9, s85, 1728
    s_add_u32 m0, s43, 0
    s_add_u32 s9, s9, 256
    buffer_load_dwordx4 v16, s[48:51], s9 offen offset:0 lds
    v_mfma_f32_32x32x16_bf16 v[208:223], a[164:167], a[80:83], v[208:223]
    ds_read_b64_tr_b16 a[188:189], v26 offset:1024
    ds_read_b64_tr_b16 a[190:191], v26 offset:1536
    s_lshl_b32 s64, s86, 12
    s_add_u32 s64, s64, 2304
    s_lshl_b32 s65, s40, 8
    v_mfma_f32_32x32x16_bf16 v[224:239], a[168:171], a[80:83], v[224:239]
    ds_read_b64_tr_b16 a[192:193], v23 offset:9216
    ds_read_b64_tr_b16 a[194:195], v23 offset:9728
    buffer_load_dwordx4 v17, s[48:51], s9 offen offset:1024 lds
    s_waitcnt lgkmcnt(6)
    v_mfma_f32_32x32x16_bf16 v[240:255], a[172:175], a[80:83], v[240:255]
    ds_read_b64_tr_b16 a[196:197], v26 offset:9216
    ds_read_b64_tr_b16 a[198:199], v26 offset:9728
    s_add_u32 s65, s65, 65664
    v_mfma_f32_32x32x16_bf16 a[208:223], a[176:179], a[80:83], a[208:223]
    ds_read_b64_tr_b16 a[200:201], v29 offset:17408
    ds_read_b64_tr_b16 a[202:203], v29 offset:17664
    buffer_load_dwordx4 v18, s[48:51], s9 offen offset:2048 lds
    v_mfma_f32_32x32x16_bf16 a[224:239], a[180:183], a[80:83], a[224:239]
    ds_read_b64_tr_b16 a[204:205], v29 offset:21504
    ds_read_b64_tr_b16 a[206:207], v29 offset:21760
    v_min_u32 v31, 7, v1
    v_lshl_add_u32 v30, v31, 7, s64
    s_waitcnt lgkmcnt(6)
    v_mfma_f32_32x32x16_bf16 v[192:207], a[184:187], a[84:87], v[192:207]
    ds_read_b64_tr_b16 a[160:161], v23 offset:2048
    ds_read_b64_tr_b16 a[162:163], v23 offset:2560
    buffer_load_dwordx4 v19, s[48:51], s9 offen offset:3072 lds
    v_mfma_f32_32x32x16_bf16 v[208:223], a[188:191], a[84:87], v[208:223]
    ds_read_b64_tr_b16 a[164:165], v26 offset:2048
    ds_read_b64_tr_b16 a[166:167], v26 offset:2560
    v_lshrrev_b32 v31, 2, v31
    v_mul_u32_u24 v31, v31, v31
    v_mfma_f32_32x32x16_bf16 v[224:239], a[192:195], a[84:87], v[224:239]
    ds_read_b64_tr_b16 a[168:169], v23 offset:10240
    ds_read_b64_tr_b16 a[170:171], v23 offset:10752
    s_mul_i32 s8, s85, 1728
    s_add_u32 m0, s92, 16384
    s_nop 0
    buffer_load_dwordx4 v20, s[52:55], s8 offen offset:0 lds
    s_waitcnt lgkmcnt(6)
    v_mfma_f32_32x32x16_bf16 v[240:255], a[196:199], a[84:87], v[240:255]
    ds_read_b64_tr_b16 a[172:173], v26 offset:10240
    ds_read_b64_tr_b16 a[174:175], v26 offset:10752
    v_sub_u32 v31, 14, v31
    v_mfma_f32_32x32x16_bf16 a[208:223], a[200:203], a[84:87], a[208:223]
    ds_read_b64_tr_b16 a[176:177], v29 offset:18432
    ds_read_b64_tr_b16 a[178:179], v29 offset:18688
    s_add_u32 s8, s8, 54272
    buffer_load_dwordx4 v20, s[52:55], s8 offen offset:1024 lds
    v_mfma_f32_32x32x16_bf16 a[224:239], a[204:207], a[84:87], a[224:239]
    ds_read_b64_tr_b16 a[180:181], v29 offset:22528
    ds_read_b64_tr_b16 a[182:183], v29 offset:22784
    v_writelane_b32 v30, s65, 8
    s_waitcnt lgkmcnt(6)
    v_mfma_f32_32x32x16_bf16 v[192:207], a[160:163], a[88:91], v[192:207]
    ds_read_b64_tr_b16 a[184:185], v23 offset:3072
    ds_read_b64_tr_b16 a[186:187], v23 offset:3584
    v_mfma_f32_32x32x16_bf16 v[208:223], a[164:167], a[88:91], v[208:223]
    ds_read_b64_tr_b16 a[188:189], v26 offset:3072
    ds_read_b64_tr_b16 a[190:191], v26 offset:3584
    v_writelane_b32 v31, 10, 8
    v_mfma_f32_32x32x16_bf16 v[224:239], a[168:171], a[88:91], v[224:239]
    ds_read_b64_tr_b16 a[192:193], v23 offset:11264
    ds_read_b64_tr_b16 a[194:195], v23 offset:11776
    buffer_load_dword v60, v30, s[60:63], s73 offen sc1
    s_waitcnt lgkmcnt(6)
    v_mfma_f32_32x32x16_bf16 v[240:255], a[172:175], a[88:91], v[240:255]
    ds_read_b64_tr_b16 a[196:197], v26 offset:11264
    ds_read_b64_tr_b16 a[198:199], v26 offset:11776
    v_mfma_f32_32x32x16_bf16 a[208:223], a[176:179], a[88:91], a[208:223]
    ds_read_b64_tr_b16 a[200:201], v29 offset:19456
    ds_read_b64_tr_b16 a[202:203], v29 offset:19712
    v_mfma_f32_32x32x16_bf16 a[224:239], a[180:183], a[88:91], a[224:239]
    ds_read_b64_tr_b16 a[204:205], v29 offset:23552
    ds_read_b64_tr_b16 a[206:207], v29 offset:23808
    s_waitcnt lgkmcnt(6)
    v_mfma_f32_32x32x16_bf16 v[192:207], a[184:187], a[92:95], v[192:207]
    s_waitcnt lgkmcnt(0)
    v_mfma_f32_32x32x16_bf16 v[208:223], a[188:191], a[92:95], v[208:223]
    s_barrier
    ds_read_b64_tr_b16 a[160:161], v21 offset:32768
    ds_read_b64_tr_b16 a[162:163], v21 offset:33280
    ds_read_b64_tr_b16 a[164:165], v24 offset:32768
    v_mfma_f32_32x32x16_bf16 v[224:239], a[192:195], a[92:95], v[224:239]
    ds_read_b64_tr_b16 a[166:167], v24 offset:33280
    ds_read_b64_tr_b16 a[168:169], v21 offset:40960
    v_mfma_f32_32x32x16_bf16 v[240:255], a[196:199], a[92:95], v[240:255]
    ds_read_b64_tr_b16 a[170:171], v21 offset:41472
    ds_read_b64_tr_b16 a[172:173], v24 offset:40960
    ds_read_b64_tr_b16 a[174:175], v24 offset:41472
    v_mfma_f32_32x32x16_bf16 a[208:223], a[200:203], a[92:95], a[208:223]
    ds_read_b64_tr_b16 a[176:177], v27 offset:49152
    ds_read_b64_tr_b16 a[178:179], v27 offset:49408
    v_mfma_f32_32x32x16_bf16 a[224:239], a[204:207], a[92:95], a[224:239]
    ds_read_b64_tr_b16 a[180:181], v27 offset:53248
    ds_read_b64_tr_b16 a[182:183], v27 offset:53504
    s_waitcnt lgkmcnt(6)
    v_mfma_f32_32x32x16_bf16 v[192:207], a[160:163], a[96:99], v[192:207]
    ds_read_b64_tr_b16 a[184:185], v21 offset:33792
    ds_read_b64_tr_b16 a[186:187], v21 offset:34304
    v_mfma_f32_32x32x16_bf16 v[208:223], a[164:167], a[96:99], v[208:223]
    ds_read_b64_tr_b16 a[188:189], v24 offset:33792
    ds_read_b64_tr_b16 a[190:191], v24 offset:34304
    v_mfma_f32_32x32x16_bf16 v[224:239], a[168:171], a[96:99], v[224:239]
    ds_read_b64_tr_b16 a[192:193], v21 offset:41984
    ds_read_b64_tr_b16 a[194:195], v21 offset:42496
    s_waitcnt lgkmcnt(6)
    v_mfma_f32_32x32x16_bf16 v[240:255], a[172:175], a[96:99], v[240:255]
    ds_read_b64_tr_b16 a[196:197], v24 offset:41984
    ds_read_b64_tr_b16 a[198:199], v24 offset:42496
    v_mfma_f32_32x32x16_bf16 a[208:223], a[176:179], a[96:99], a[208:223]
    ds_read_b64_tr_b16 a[200:201], v27 offset:50176
    ds_read_b64_tr_b16 a[202:203], v27 offset:50432
    v_mfma_f32_32x32x16_bf16 a[224:239], a[180:183], a[96:99], a[224:239]
    ds_read_b64_tr_b16 a[204:205], v27 offset:54272
    ds_read_b64_tr_b16 a[206:207], v27 offset:54528
    s_waitcnt lgkmcnt(6)
    v_mfma_f32_32x32x16_bf16 v[192:207], a[184:187], a[100:103], v[192:207]
    ds_read_b64_tr_b16 a[160:161], v21 offset:34816
    ds_read_b64_tr_b16 a[162:163], v21 offset:35328
    v_mfma_f32_32x32x16_bf16 v[208:223], a[188:191], a[100:103], v[208:223]
    ds_read_b64_tr_b16 a[164:165], v24 offset:34816
    ds_read_b64_tr_b16 a[166:167], v24 offset:35328
    v_mfma_f32_32x32x16_bf16 v[224:239], a[192:195], a[100:103], v[224:239]
    ds_read_b64_tr_b16 a[168:169], v21 offset:43008
    ds_read_b64_tr_b16 a[170:171], v21 offset:43520
    s_waitcnt lgkmcnt(6)
    v_mfma_f32_32x32x16_bf16 v[240:255], a[196:199], a[100:103], v[240:255]
    ds_read_b64_tr_b16 a[172:173], v24 offset:43008
    ds_read_b64_tr_b16 a[174:175], v24 offset:43520
    v_mfma_f32_32x32x16_bf16 a[208:223], a[200:203], a[100:103], a[208:223]
    ds_read_b64_tr_b16 a[176:177], v27 offset:51200
    ds_read_b64_tr_b16 a[178:179], v27 offset:51456
    v_mfma_f32_32x32x16_bf16 a[224:239], a[204:207], a[100:103], a[224:239]
    ds_read_b64_tr_b16 a[180:181], v27 offset:55296
    ds_read_b64_tr_b16 a[182:183], v27 offset:55552
    s_lshl_b32 s64, s86, 12
    s_waitcnt lgkmcnt(6)
    v_mfma_f32_32x32x16_bf16 v[192:207], a[160:163], a[104:107], v[192:207]
    ds_read_b64_tr_b16 a[184:185], v21 offset:35840
    ds_read_b64_tr_b16 a[186:187], v21 offset:36352
    v_mfma_f32_32x32x16_bf16 v[208:223], a[164:167], a[104:107], v[208:223]
    ds_read_b64_tr_b16 a[188:189], v24 offset:35840
    ds_read_b64_tr_b16 a[190:191], v24 offset:36352
    s_add_u32 s64, s64, 128
    v_mfma_f32_32x32x16_bf16 v[224:239], a[168:171], a[104:107], v[224:239]
    ds_read_b64_tr_b16 a[192:193], v21 offset:44032
    ds_read_b64_tr_b16 a[194:195], v21 offset:44544
    v_mov_b32 v57, s64
    s_waitcnt lgkmcnt(6)
    v_mfma_f32_32x32x16_bf16 v[240:255], a[172:175], a[104:107], v[240:255]
    ds_read_b64_tr_b16 a[196:197], v24 offset:44032
    ds_read_b64_tr_b16 a[198:199], v24 offset:44544
    v_mfma_f32_32x32x16_bf16 a[208:223], a[176:179], a[104:107], a[208:223]
    ds_read_b64_tr_b16 a[200:201], v27 offset:52224
    ds_read_b64_tr_b16 a[202:203], v27 offset:52480
    v_mov_b32 v58, 8
    v_mfma_f32_32x32x16_bf16 a[224:239], a[180:183], a[104:107], a[224:239]
    ds_read_b64_tr_b16 a[204:205], v27 offset:56320
    ds_read_b64_tr_b16 a[206:207], v27 offset:56576
    buffer_load_dword v59, v57, s[60:63], s73 offen sc1
    s_waitcnt lgkmcnt(6)
    v_mfma_f32_32x32x16_bf16 v[192:207], a[184:187], a[108:111], v[192:207]
    s_waitcnt vmcnt(1)
    v_cmp_le_u32 vcc, v31, v60
    s_nop 1
    s_cmp_eq_u64 vcc, -1
    s_cbranch_scc1 L_wd_4_ok
    s_cmp_lg_u32 s38, 0
    s_cbranch_scc1 L_wd_4_ok
    s_mov_b32 s69, 0
L_wd_4_spin:
    buffer_load_dword v60, v30, s[60:63], 0 offen sc1
    s_waitcnt vmcnt(0)
    v_cmp_le_u32 vcc, v31, v60
    s_nop 1
    s_cmp_eq_u64 vcc, -1
    s_cbranch_scc1 L_wd_4_ok
    s_sleep 2
    s_add_u32 s69, s69, 1
    s_cmp_lt_u32 s69, 0x4000
    s_cbranch_scc1 L_wd_4_spin
L_wd_4_ok:
    s_waitcnt lgkmcnt(0)
    v_mfma_f32_32x32x16_bf16 v[208:223], a[188:191], a[108:111], v[208:223]
    s_barrier
    ds_read_b64_tr_b16 a[160:161], v22 offset:0
    ds_read_b64_tr_b16 a[162:163], v22 offset:512
    ds_read_b64_tr_b16 a[164:165], v25 offset:0
    v_mfma_f32_32x32x16_bf16 v[224:239], a[192:195], a[108:111], v[224:239]
    ds_read_b64_tr_b16 a[166:167], v25 offset:512
    ds_read_b64_tr_b16 a[168:169], v22 offset:8192
    s_lshl_b32 s64, s40, 11
    s_add_u32 s64, s64, 87040
    v_lshlrev_b32 v43, 2, v1
    v_mfma_f32_32x32x16_bf16 v[240:255], a[196:199], a[108:111], v[240:255]
    ds_read_b64_tr_b16 a[170:171], v22 offset:8704
    ds_read_b64_tr_b16 a[172:173], v25 offset:8192
    ds_read_b64_tr_b16 a[174:175], v25 offset:8704
    buffer_load_dword v61, v43, s[60:63], s64 offen offset:0 sc1
    v_mfma_f32_32x32x16_bf16 a[208:223], a[200:203], a[108:111], a[208:223]
    ds_read_b64_tr_b16 a[176:177], v28 offset:16384
    ds_read_b64_tr_b16 a[178:179], v28 offset:16640
    buffer_load_dword v62, v43, s[60:63], s64 offen offset:256 sc1
    buffer_load_dword v63, v43, s[60:63], s64 offen offset:512 sc1
    v_mfma_f32_32x32x16_bf16 a[224:239], a[204:207], a[108:111], a[224:239]
    ds_read_b64_tr_b16 a[180:181], v28 offset:20480
    ds_read_b64_tr_b16 a[182:183], v28 offset:20736
    s_waitcnt lgkmcnt(6)
    v_mfma_f32_32x32x16_bf16 v[192:207], a[160:163], a[112:115], v[192:207]
    ds_read_b64_tr_b16 a[184:185], v22 offset:1024
    ds_read_b64_tr_b16 a[186:187], v22 offset:1536
    s_add_u32 s93, s88, 0
    s_cmp_ge_u32 s93, 5
    s_cselect_b32 s69, 5, 0
    s_sub_u32 s93, s93, s69
    s_mul_i32 s93, s93, 2
    s_add_u32 s93, s93, s24
    s_mul_i32 s93, s93, 5120
    s_add_u32 m0, s3, 122880
    s_add_u32 s93, s93, s26
    buffer_load_dwordx4 v8, s[16:19], s93 offen offset:0 sc1 lds
    v_mfma_f32_32x32x16_bf16 v[208:223], a[164:167], a[112:115], v[208:223]
    ds_read_b64_tr_b16 a[188:189], v25 offset:1024
    ds_read_b64_tr_b16 a[190:191], v25 offset:1536
    v_mfma_f32_32x32x16_bf16 v[224:239], a[168:171], a[112:115], v[224:239]
    ds_read_b64_tr_b16 a[192:193], v22 offset:9216
    ds_read_b64_tr_b16 a[194:195], v22 offset:9728
    buffer_load_dwordx4 v8, s[16:19], s93 offen offset:1024 sc1 lds
    s_waitcnt lgkmcnt(6)
    v_mfma_f32_32x32x16_bf16 v[240:255], a[172:175], a[112:115], v[240:255]
    ds_read_b64_tr_b16 a[196:197], v25 offset:9216
    ds_read_b64_tr_b16 a[198:199], v25 offset:9728
    v_mfma_f32_32x32x16_bf16 a[208:223], a[176:179], a[112:115], a[208:223]
    ds_read_b64_tr_b16 a[200:201], v28 offset:17408
    ds_read_b64_tr_b16 a[202:203], v28 offset:17664
    buffer_load_dwordx4 v8, s[16:19], s93 offen offset:2048 sc1 lds
    v_mfma_f32_32x32x16_bf16 a[224:239], a[180:183], a[112:115], a[224:239]
    ds_read_b64_tr_b16 a[204:205], v28 offset:21504
    ds_read_b64_tr_b16 a[206:207], v28 offset:21760
    s_waitcnt lgkmcnt(6)
    v_mfma_f32_32x32x16_bf16 v[192:207], a[184:187], a[116:119], v[192:207]
    ds_read_b64_tr_b16 a[160:161], v22 offset:2048
    ds_read_b64_tr_b16 a[162:163], v22 offset:2560
    buffer_load_dwordx4 v8, s[16:19], s93 offen offset:3072 sc1 lds
    v_mfma_f32_32x32x16_bf16 v[208:223], a[188:191], a[116:119], v[208:223]
    ds_read_b64_tr_b16 a[164:165], v25 offset:2048
    ds_read_b64_tr_b16 a[166:167], v25 offset:2560
    v_mfma_f32_32x32x16_bf16 v[224:239], a[192:195], a[116:119], v[224:239]
    ds_read_b64_tr_b16 a[168:169], v22 offset:10240
    ds_read_b64_tr_b16 a[170:171], v22 offset:10752
    s_add_u32 m0, s3, 126976
    s_add_u32 s93, s93, 4096
    buffer_load_dwordx4 v8, s[16:19], s93 offen offset:0 sc1 lds
    s_waitcnt lgkmcnt(6)
    v_mfma_f32_32x32x16_bf16 v[240:255], a[196:199], a[116:119], v[240:255]
    ds_read_b64_tr_b16 a[172:173], v25 offset:10240
    ds_read_b64_tr_b16 a[174:175], v25 offset:10752
    v_mfma_f32_32x32x16_bf16 a[208:223], a[200:203], a[116:119], a[208:223]
    ds_read_b64_tr_b16 a[176:177], v28 offset:18432
    ds_read_b64_tr_b16 a[178:179], v28 offset:18688
    s_add_u32 s93, s88, 1
    s_cmp_ge_u32 s93, 5
    s_cselect_b32 s69, 5, 0
    s_sub_u32 s93, s93, s69
    s_mul_i32 s93, s93, 2
    s_add_u32 s93, s93, s24
    s_mul_i32 s93, s93, 5120
    s_add_u32 m0, s3, 143360
    s_add_u32 s93, s93, s26
    buffer_load_dwordx4 v8, s[16:19], s93 offen offset:0 sc1 lds
    v_mfma_f32_32x32x16_bf16 a[224:239], a[204:207], a[116:119], a[224:239]
    ds_read_b64_tr_b16 a[180:181], v28 offset:22528
    ds_read_b64_tr_b16 a[182:183], v28 offset:22784
    s_waitcnt lgkmcnt(6)
    v_mfma_f32_32x32x16_bf16 v[192:207], a[160:163], a[120:123], v[192:207]
    ds_read_b64_tr_b16 a[184:185], v22 offset:3072
    ds_read_b64_tr_b16 a[186:187], v22 offset:3584
    buffer_load_dwordx4 v8, s[16:19], s93 offen offset:1024 sc1 lds
    v_mfma_f32_32x32x16_bf16 v[208:223], a[164:167], a[120:123], v[208:223]
    ds_read_b64_tr_b16 a[188:189], v25 offset:3072
    ds_read_b64_tr_b16 a[190:191], v25 offset:3584
    v_mfma_f32_32x32x16_bf16 v[224:239], a[168:171], a[120:123], v[224:239]
    ds_read_b64_tr_b16 a[192:193], v22 offset:11264
    ds_read_b64_tr_b16 a[194:195], v22 offset:11776
    buffer_load_dwordx4 v8, s[16:19], s93 offen offset:2048 sc1 lds
    s_waitcnt lgkmcnt(6)
    v_mfma_f32_32x32x16_bf16 v[240:255], a[172:175], a[120:123], v[240:255]
    ds_read_b64_tr_b16 a[196:197], v25 offset:11264
    ds_read_b64_tr_b16 a[198:199], v25 offset:11776
    v_mfma_f32_32x32x16_bf16 a[208:223], a[176:179], a[120:123], a[208:223]
    ds_read_b64_tr_b16 a[200:201], v28 offset:19456
    ds_read_b64_tr_b16 a[202:203], v28 offset:19712
    buffer_load_dwordx4 v8, s[16:19], s93 offen offset:3072 sc1 lds
    v_mfma_f32_32x32x16_bf16 a[224:239], a[180:183], a[120:123], a[224:239]
    ds_read_b64_tr_b16 a[204:205], v28 offset:23552
    ds_read_b64_tr_b16 a[206:207], v28 offset:23808
    s_waitcnt lgkmcnt(6)
    v_mfma_f32_32x32x16_bf16 v[192:207], a[184:187], a[124:127], v[192:207]
    s_waitcnt vmcnt(12)
    v_cmp_le_u32 vcc, v58, v59
    s_nop 1
    s_cmp_eq_u64 vcc, -1
    s_cbranch_scc1 L_h01_5_ok
    s_cmp_lg_u32 s38, 0
    s_cbranch_scc1 L_h01_5_ok
    s_mov_b32 s69, 0
L_h01_5_spin:
    buffer_load_dword v59, v57, s[60:63], 0 offen sc1
    s_waitcnt vmcnt(0)
    v_cmp_le_u32 vcc, v58, v59
    s_nop 1
    s_cmp_eq_u64 vcc, -1
    s_cbranch_scc1 L_h01_5_ok
    s_sleep 2
    s_add_u32 s69, s69, 1
    s_cmp_lt_u32 s69, 0x4000
    s_cbranch_scc1 L_h01_5_spin
L_h01_5_ok:
    s_waitcnt lgkmcnt(0)
    v_mfma_f32_32x32x16_bf16 v[208:223], a[188:191], a[124:127], v[208:223]
    s_barrier
    ds_read_b64_tr_b16 a[160:161], v22 offset:32768
    ds_read_b64_tr_b16 a[162:163], v22 offset:33280
    ds_read_b64_tr_b16 a[164:165], v25 offset:32768
    v_mfma_f32_32x32x16_bf16 v[224:239], a[192:195], a[124:127], v[224:239]
    ds_read_b64_tr_b16 a[166:167], v25 offset:33280
    ds_read_b64_tr_b16 a[168:169], v22 offset:40960
    v_mfma_f32_32x32x16_bf16 v[240:255], a[196:199], a[124:127], v[240:255]
    ds_read_b64_tr_b16 a[170:171], v22 offset:41472
    ds_read_b64_tr_b16 a[172:173], v25 offset:40960
    ds_read_b64_tr_b16 a[174:175], v25 offset:41472
    v_mfma_f32_32x32x16_bf16 a[208:223], a[200:203], a[124:127], a[208:223]
    ds_read_b64_tr_b16 a[176:177], v28 offset:49152
    ds_read_b64_tr_b16 a[178:179], v28 offset:49408
    s_add_u32 s94, s88, 0
    s_cmp_ge_u32 s94, 5
    s_cselect_b32 s69, 5, 0
    s_sub_u32 s94, s94, s69
    s_mul_i32 s94, s94, 2
    s_add_u32 s94, s94, s24
    s_mul_i32 s94, s94, 1024
    buffer_load_dwordx4 v[128:131], v11, s[20:23], s94 offen offset:0 sc1
    buffer_load_dwordx4 v[132:135], v11, s[20:23], s94 offen offset:512 sc1
    v_mfma_f32_32x32x16_bf16 a[224:239], a[204:207], a[124:127], a[224:239]
    ds_read_b64_tr_b16 a[180:181], v28 offset:53248
    ds_read_b64_tr_b16 a[182:183], v28 offset:53504
    s_waitcnt lgkmcnt(6)
    v_mfma_f32_32x32x16_bf16 v[192:207], a[160:163], a[128:131], v[192:207]
    ds_read_b64_tr_b16 a[184:185], v22 offset:33792
    ds_read_b64_tr_b16 a[186:187], v22 offset:34304
    s_add_u32 m0, s3, 147456
    s_add_u32 s93, s93, 4096
    buffer_load_dwordx4 v8, s[16:19], s93 offen offset:0 sc1 lds
    v_mfma_f32_32x32x16_bf16 v[208:223], a[164:167], a[128:131], v[208:223]
    ds_read_b64_tr_b16 a[188:189], v25 offset:33792
    ds_read_b64_tr_b16 a[190:191], v25 offset:34304
    v_mfma_f32_32x32x16_bf16 v[224:239], a[168:171], a[128:131], v[224:239]
    ds_read_b64_tr_b16 a[192:193], v22 offset:41984
    ds_read_b64_tr_b16 a[194:195], v22 offset:42496
    s_waitcnt lgkmcnt(6)
    v_mfma_f32_32x32x16_bf16 v[240:255], a[172:175], a[128:131], v[240:255]
    ds_read_b64_tr_b16 a[196:197], v25 offset:41984
    ds_read_b64_tr_b16 a[198:199], v25 offset:42496
    v_mfma_f32_32x32x16_bf16 a[208:223], a[176:179], a[128:131], a[208:223]
    ds_read_b64_tr_b16 a[200:201], v28 offset:50176
    ds_read_b64_tr_b16 a[202:203], v28 offset:50432
    buffer_load_dwordx4 v[136:139], v11, s[20:23], s94 offen offset:1024 sc1
    buffer_load_dwordx4 v[140:143], v11, s[20:23], s94 offen offset:1536 sc1
    v_mfma_f32_32x32x16_bf16 a[224:239], a[180:183], a[128:131], a[224:239]
    ds_read_b64_tr_b16 a[204:205], v28 offset:54272
    ds_read_b64_tr_b16 a[206:207], v28 offset:54528
    s_waitcnt lgkmcnt(6)
    v_mfma_f32_32x32x16_bf16 v[192:207], a[184:187], a[132:135], v[192:207]
    ds_read_b64_tr_b16 a[160:161], v22 offset:34816
    ds_read_b64_tr_b16 a[162:163], v22 offset:35328
    v_mfma_f32_32x32x16_bf16 v[208:223], a[188:191], a[132:135], v[208:223]
    ds_read_b64_tr_b16 a[164:165], v25 offset:34816
    ds_read_b64_tr_b16 a[166:167], v25 offset:35328
    v_mfma_f32_32x32x16_bf16 v[224:239], a[192:195], a[132:135], v[224:239]
    ds_read_b64_tr_b16 a[168:169], v22 offset:43008
    ds_read_b64_tr_b16 a[170:171], v22 offset:43520
    s_waitcnt lgkmcnt(6)
    v_mfma_f32_32x32x16_bf16 v[240:255], a[196:199], a[132:135], v[240:255]
    ds_read_b64_tr_b16 a[172:173], v25 offset:43008
    ds_read_b64_tr_b16 a[174:175], v25 offset:43520
    v_mfma_f32_32x32x16_bf16 a[208:223], a[200:203], a[132:135], a[208:223]
    ds_read_b64_tr_b16 a[176:177], v28 offset:51200
    ds_read_b64_tr_b16 a[178:179], v28 offset:51456
    s_add_u32 s95, s88, 1
    s_cmp_ge_u32 s95, 5
    s_cselect_b32 s69, 5, 0
    s_sub_u32 s95, s95, s69
    s_mul_i32 s95, s95, 2
    s_add_u32 s95, s95, s24
    s_mul_i32 s95, s95, 1024
    buffer_load_dwordx4 v[144:147], v11, s[20:23], s95 offen offset:0 sc1
    buffer_load_dwordx4 v[148:151], v11, s[20:23], s95 offen offset:512 sc1
    v_mfma_f32_32x32x16_bf16 a[224:239], a[204:207], a[132:135], a[224:239]
    ds_read_b64_tr_b16 a[180:181], v28 offset:55296
    ds_read_b64_tr_b16 a[182:183], v28 offset:55552
    s_waitcnt lgkmcnt(6)
    v_mfma_f32_32x32x16_bf16 v[192:207], a[160:163], a[136:139], v[192:207]
    ds_read_b64_tr_b16 a[184:185], v22 offset:35840
    ds_read_b64_tr_b16 a[186:187], v22 offset:36352
    v_mfma_f32_32x32x16_bf16 v[208:223], a[164:167], a[136:139], v[208:223]
    ds_read_b64_tr_b16 a[188:189], v25 offset:35840
    ds_read_b64_tr_b16 a[190:191], v25 offset:36352
    v_mfma_f32_32x32x16_bf16 v[224:239], a[168:171], a[136:139], v[224:239]
    ds_read_b64_tr_b16 a[192:193], v22 offset:44032
    ds_read_b64_tr_b16 a[194:195], v22 offset:44544
    s_waitcnt lgkmcnt(6)
    v_mfma_f32_32x32x16_bf16 v[240:255], a[172:175], a[136:139], v[240:255]
    ds_read_b64_tr_b16 a[196:197], v25 offset:44032
    ds_read_b64_tr_b16 a[198:199], v25 offset:44544
    v_mfma_f32_32x32x16_bf16 a[208:223], a[176:179], a[136:139], a[208:223]
    ds_read_b64_tr_b16 a[200:201], v28 offset:52224
    ds_read_b64_tr_b16 a[202:203], v28 offset:52480
    buffer_load_dwordx4 v[152:155], v11, s[20:23], s95 offen offset:1024 sc1
    buffer_load_dwordx4 v[156:159], v11, s[20:23], s95 offen offset:1536 sc1
    v_mfma_f32_32x32x16_bf16 a[224:239], a[180:183], a[136:139], a[224:239]
    ds_read_b64_tr_b16 a[204:205], v28 offset:56320
    ds_read_b64_tr_b16 a[206:207], v28 offset:56576
    s_waitcnt lgkmcnt(6)
    v_mfma_f32_32x32x16_bf16 v[192:207], a[184:187], a[140:143], v[192:207]
    s_waitcnt lgkmcnt(0)
    v_mfma_f32_32x32x16_bf16 v[208:223], a[188:191], a[140:143], v[208:223]
    s_barrier
    ds_read_b64_tr_b16 a[160:161], v21 offset:0
    ds_read_b64_tr_b16 a[162:163], v21 offset:512
    ds_read_b64_tr_b16 a[164:165], v24 offset:0
    v_mfma_f32_32x32x16_bf16 v[224:239], a[192:195], a[140:143], v[224:239]
    ds_read_b64_tr_b16 a[166:167], v24 offset:512
    ds_read_b64_tr_b16 a[168:169], v21 offset:8192
    v_mfma_f32_32x32x16_bf16 v[240:255], a[196:199], a[140:143], v[240:255]
    ds_read_b64_tr_b16 a[170:171], v21 offset:8704
    ds_read_b64_tr_b16 a[172:173], v24 offset:8192
    ds_read_b64_tr_b16 a[174:175], v24 offset:8704
    v_mfma_f32_32x32x16_bf16 a[208:223], a[200:203], a[140:143], a[208:223]
    ds_read_b64_tr_b16 a[176:177], v27 offset:16384
    ds_read_b64_tr_b16 a[178:179], v27 offset:16640
    s_add_u32 s94, s88, 2
    s_cmp_ge_u32 s94, 5
    s_cselect_b32 s69, 5, 0
    s_sub_u32 s94, s94, s69
    s_mul_i32 s94, s94, 2
    s_add_u32 s94, s94, s24
    s_mul_i32 s94, s94, 1024
    buffer_load_dwordx4 v[160:163], v11, s[20:23], s94 offen offset:0 sc1
    buffer_load_dwordx4 v[164:167], v11, s[20:23], s94 offen offset:512 sc1
    v_mfma_f32_32x32x16_bf16 a[224:239], a[204:207], a[140:143], a[224:239]
    ds_read_b64_tr_b16 a[180:181], v27 offset:20480
    ds_read_b64_tr_b16 a[182:183], v27 offset:20736
    s_waitcnt vmcnt(22)
    v_cvt_pk_bf16_f32 v56, v61, v61
    v_and_b32 v56, s11, v56
    v_sub_f32 v56, v61, v56
    v_cvt_pk_bf16_f32 v44, v61, v56
    v_and_b32 v57, s11, v44
    s_waitcnt lgkmcnt(6)
    v_mfma_f32_32x32x16_bf16 v[192:207], a[160:163], a[144:147], v[192:207]
    ds_read_b64_tr_b16 a[184:185], v21 offset:1024
    ds_read_b64_tr_b16 a[186:187], v21 offset:1536
    v_sub_f32 v56, v56, v57
    v_cvt_pk_bf16_f32 v45, v61, v56
    v_mov_b32 v46, v44
    v_mov_b32 v47, 0
    v_mfma_f32_32x32x16_bf16 v[208:223], a[164:167], a[144:147], v[208:223]
    ds_read_b64_tr_b16 a[188:189], v24 offset:1024
    ds_read_b64_tr_b16 a[190:191], v24 offset:1536
    s_waitcnt vmcnt(21)
    v_cvt_pk_bf16_f32 v56, v62, v62
    v_and_b32 v56, s11, v56
    v_sub_f32 v56, v62, v56
    v_cvt_pk_bf16_f32 v48, v62, v56
    v_and_b32 v57, s11, v48
    v_mfma_f32_32x32x16_bf16 v[224:239], a[168:171], a[144:147], v[224:239]
    ds_read_b64_tr_b16 a[192:193], v21 offset:9216
    ds_read_b64_tr_b16 a[194:195], v21 offset:9728
    v_sub_f32 v56, v56, v57
    v_cvt_pk_bf16_f32 v49, v62, v56
    v_mov_b32 v50, v48
    v_mov_b32 v51, 0
    s_waitcnt vmcnt(20)
    v_cvt_pk_bf16_f32 v56, v63, v63
    s_waitcnt lgkmcnt(6)
    v_mfma_f32_32x32x16_bf16 v[240:255], a[172:175], a[144:147], v[240:255]
    ds_read_b64_tr_b16 a[196:197], v24 offset:9216
    ds_read_b64_tr_b16 a[198:199], v24 offset:9728
    v_and_b32 v56, s11, v56
    v_sub_f32 v56, v63, v56
    v_cvt_pk_bf16_f32 v52, v63, v56
    v_mfma_f32_32x32x16_bf16 a[208:223], a[176:179], a[144:147], a[208:223]
    ds_read_b64_tr_b16 a[200:201], v27 offset:17408
    ds_read_b64_tr_b16 a[202:203], v27 offset:17664
    v_and_b32 v57, s11, v52
    v_sub_f32 v56, v56, v57
    v_cvt_pk_bf16_f32 v53, v63, v56
    v_mov_b32 v54, v52
    v_mov_b32 v55, 0
    v_mfma_f32_32x32x16_bf16 a[224:239], a[180:183], a[144:147], a[224:239]
    ds_read_b64_tr_b16 a[204:205], v27 offset:21504
    ds_read_b64_tr_b16 a[206:207], v27 offset:21760
    buffer_load_dwordx4 v[168:171], v11, s[20:23], s94 offen offset:1024 sc1
    buffer_load_dwordx4 v[172:175], v11, s[20:23], s94 offen offset:1536 sc1
    s_waitcnt lgkmcnt(6)
    v_mfma_f32_32x32x16_bf16 v[192:207], a[184:187], a[148:151], v[192:207]
    ds_read_b64_tr_b16 a[160:161], v21 offset:2048
    ds_read_b64_tr_b16 a[162:163], v21 offset:2560
    v_mfma_f32_32x32x16_bf16 v[208:223], a[188:191], a[148:151], v[208:223]
    ds_read_b64_tr_b16 a[164:165], v24 offset:2048
    ds_read_b64_tr_b16 a[166:167], v24 offset:2560
    v_mfma_f32_32x32x16_bf16 v[224:239], a[192:195], a[148:151], v[224:239]
    ds_read_b64_tr_b16 a[168:169], v21 offset:10240
    ds_read_b64_tr_b16 a[170:171], v21 offset:10752
    s_waitcnt lgkmcnt(6)
    v_mfma_f32_32x32x16_bf16 v[240:255], a[196:199], a[148:151], v[240:255]
    ds_read_b64_tr_b16 a[172:173], v24 offset:10240
    ds_read_b64_tr_b16 a[174:175], v24 offset:10752
    v_mfma_f32_32x32x16_bf16 a[208:223], a[200:203], a[148:151], a[208:223]
    ds_read_b64_tr_b16 a[176:177], v27 offset:18432
    ds_read_b64_tr_b16 a[178:179], v27 offset:18688
    s_add_u32 s95, s88, 3
    s_cmp_ge_u32 s95, 5
    s_cselect_b32 s69, 5, 0
    s_sub_u32 s95, s95, s69
    s_mul_i32 s95, s95, 2
    s_add_u32 s95, s95, s24
    s_mul_i32 s95, s95, 1024
    buffer_load_dwordx4 v[176:179], v11, s[20:23], s95 offen offset:0 sc1
    buffer_load_dwordx4 v[180:183], v11, s[20:23], s95 offen offset:512 sc1
    v_mfma_f32_32x32x16_bf16 a[224:239], a[204:207], a[148:151], a[224:239]
    ds_read_b64_tr_b16 a[180:181], v27 offset:22528
    ds_read_b64_tr_b16 a[182:183], v27 offset:22784
    s_waitcnt lgkmcnt(6)
    v_mfma_f32_32x32x16_bf16 v[192:207], a[160:163], a[152:155], v[192:207]
    ds_read_b64_tr_b16 a[184:185], v21 offset:3072
    ds_read_b64_tr_b16 a[186:187], v21 offset:3584
    v_mfma_f32_32x32x16_bf16 v[208:223], a[164:167], a[152:155], v[208:223]
    ds_read_b64_tr_b16 a[188:189], v24 offset:3072
    ds_read_b64_tr_b16 a[190:191], v24 offset:3584
    v_mfma_f32_32x32x16_bf16 v[224:239], a[168:171], a[152:155], v[224:239]
    ds_read_b64_tr_b16 a[192:193], v21 offset:11264
    ds_read_b64_tr_b16 a[194:195], v21 offset:11776
    s_waitcnt lgkmcnt(6)
    v_mfma_f32_32x32x16_bf16 v[240:255], a[172:175], a[152:155], v[240:255]
    ds_read_b64_tr_b16 a[196:197], v24 offset:11264
    ds_read_b64_tr_b16 a[198:199], v24 offset:11776
    v_mfma_f32_32x32x16_bf16 a[208:223], a[176:179], a[152:155], a[208:223]
    ds_read_b64_tr_b16 a[200:201], v27 offset:19456
    ds_read_b64_tr_b16 a[202:203], v27 offset:19712
    buffer_load_dwordx4 v[184:187], v11, s[20:23], s95 offen offset:1024 sc1
    buffer_load_dwordx4 v[188:191], v11, s[20:23], s95 offen offset:1536 sc1
    v_mfma_f32_32x32x16_bf16 a[224:239], a[180:183], a[152:155], a[224:239]
    ds_read_b64_tr_b16 a[204:205], v27 offset:23552
    ds_read_b64_tr_b16 a[206:207], v27 offset:23808
    s_waitcnt lgkmcnt(6)
    v_mfma_f32_32x32x16_bf16 v[192:207], a[184:187], a[156:159], v[192:207]
    v_mfma_f32_32x32x16_bf16 v[208:223], a[188:191], a[156:159], v[208:223]
    v_mfma_f32_32x32x16_bf16 v[224:239], a[192:195], a[156:159], v[224:239]
    s_waitcnt lgkmcnt(0)
    v_mfma_f32_32x32x16_bf16 v[240:255], a[196:199], a[156:159], v[240:255]
    v_mfma_f32_32x32x16_bf16 a[208:223], a[200:203], a[156:159], a[208:223]
    v_mfma_f32_32x32x16_bf16 a[224:239], a[204:207], a[156:159], a[224:239]
    v_mfma_f32_32x32x16_bf16 v[192:207], v[44:47], v[32:35], v[192:207]
    v_mfma_f32_32x32x16_bf16 v[224:239], v[48:51], v[32:35], v[224:239]
    v_mfma_f32_32x32x16_bf16 v[208:223], v[44:47], v[36:39], v[208:223]
    v_mfma_f32_32x32x16_bf16 v[240:255], v[48:51], v[36:39], v[240:255]
    v_mfma_f32_32x32x16_bf16 a[208:223], v[52:55], v[32:35], a[208:223]
    v_mfma_f32_32x32x16_bf16 a[224:239], v[52:55], v[36:39], a[224:239]
    s_lshl_b32 s64, s39, 12
    s_add_u32 s64, s64, 256
    s_lshl_b32 s65, s38, 7
    s_add_u32 s64, s64, s65
    v_mov_b32 v41, 0x40000000
    v_writelane_b32 v41, s64, 0
    s_add_u32 s93, s88, 2
    s_cmp_ge_u32 s93, 5
    s_cselect_b32 s69, 5, 0
    s_sub_u32 s93, s93, s69
    s_mul_i32 s93, s93, 2
    s_add_u32 s93, s93, s24
    s_mul_i32 s93, s93, 5120
    s_add_u32 m0, s3, 40960
    s_add_u32 s93, s93, s26
    buffer_load_dwordx4 v8, s[16:19], s93 offen offset:0 sc1 lds
    buffer_load_dwordx4 v8, s[16:19], s93 offen offset:1024 sc1 lds
    buffer_load_dwordx4 v8, s[16:19], s93 offen offset:2048 sc1 lds
    buffer_load_dwordx4 v8, s[16:19], s93 offen offset:3072 sc1 lds
    s_add_u32 m0, s3, 45056
    s_add_u32 s93, s93, 4096
    buffer_load_dwordx4 v8, s[16:19], s93 offen offset:0 sc1 lds
    s_add_u32 s93, s88, 3
    s_cmp_ge_u32 s93, 5
    s_cselect_b32 s69, 5, 0
    s_sub_u32 s93, s93, s69
    s_mul_i32 s93, s93, 2
    s_add_u32 s93, s93, s24
    s_mul_i32 s93, s93, 5120
    s_add_u32 m0, s3, 61440
    s_add_u32 s93, s93, s26
    buffer_load_dwordx4 v8, s[16:19], s93 offen offset:0 sc1 lds
    buffer_load_dwordx4 v8, s[16:19], s93 offen offset:1024 sc1 lds
    buffer_load_dwordx4 v8, s[16:19], s93 offen offset:2048 sc1 lds
    buffer_load_dwordx4 v8, s[16:19], s93 offen offset:3072 sc1 lds
    s_add_u32 m0, s3, 65536
    s_add_u32 s93, s93, 4096
    buffer_load_dwordx4 v8, s[16:19], s93 offen offset:0 sc1 lds
    v_max_f32 v192, 0, v192
    v_max_f32 v193, 0, v193
    v_pk_mul_f32 v[224:225], v[224:225], v[4:5] op_sel_hi:[1,0]
    v_pk_mul_f32 v[192:193], v[192:193], v[224:225]
    v_cvt_pk_bf16_f32 v192, v192, v193
    v_max_f32 v194, 0, v194
    v_max_f32 v195, 0, v195
    v_pk_mul_f32 v[226:227], v[226:227], v[4:5] op_sel_hi:[1,0]
    v_pk_mul_f32 v[194:195], v[194:195], v[226:227]
    v_cvt_pk_bf16_f32 v193, v194, v195
    v_max_f32 v196, 0, v196
    v_max_f32 v197, 0, v197
    v_pk_mul_f32 v[228:229], v[228:229], v[4:5] op_sel_hi:[1,0]
    v_pk_mul_f32 v[196:197], v[196:197], v[228:229]
    v_cvt_pk_bf16_f32 v194, v196, v197
    v_max_f32 v198, 0, v198
    v_max_f32 v199, 0, v199
    v_pk_mul_f32 v[230:231], v[230:231], v[4:5] op_sel_hi:[1,0]
    v_pk_mul_f32 v[198:199], v[198:199], v[230:231]
    v_cvt_pk_bf16_f32 v195, v198, v199
    v_max_f32 v200, 0, v200
    v_max_f32 v201, 0, v201
    v_pk_mul_f32 v[232:233], v[232:233], v[4:5] op_sel_hi:[1,0]
    v_pk_mul_f32 v[200:201], v[200:201], v[232:233]
    v_cvt_pk_bf16_f32 v196, v200, v201
    v_max_f32 v202, 0, v202
    v_max_f32 v203, 0, v203
    v_pk_mul_f32 v[234:235], v[234:235], v[4:5] op_sel_hi:[1,0]
    v_pk_mul_f32 v[202:203], v[202:203], v[234:235]
    v_cvt_pk_bf16_f32 v197, v202, v203
    v_max_f32 v204, 0, v204
    v_max_f32 v205, 0, v205
    v_pk_mul_f32 v[236:237], v[236:237], v[4:5] op_sel_hi:[1,0]
    v_pk_mul_f32 v[204:205], v[204:205], v[236:237]
    v_cvt_pk_bf16_f32 v198, v204, v205
    v_max_f32 v206, 0, v206
    v_max_f32 v207, 0, v207
    v_pk_mul_f32 v[238:239], v[238:239], v[4:5] op_sel_hi:[1,0]
    v_pk_mul_f32 v[206:207], v[206:207], v[238:239]
    v_cvt_pk_bf16_f32 v199, v206, v207
    s_lshl_b32 s41, s10, 11
    s_add_u32 s41, s41, 32768
    s_add_u32 s41, s41, s75
    buffer_store_dwordx4 v[192:195], v6, s[56:59], s41 offen offset:0 sc1
    buffer_store_dwordx4 v[196:199], v6, s[56:59], s41 offen offset:512 sc1
    v_max_f32 v208, 0, v208
    v_max_f32 v209, 0, v209
    v_pk_mul_f32 v[240:241], v[240:241], v[4:5] op_sel_hi:[1,0]
    v_pk_mul_f32 v[208:209], v[208:209], v[240:241]
    v_cvt_pk_bf16_f32 v208, v208, v209
    v_max_f32 v210, 0, v210
    v_max_f32 v211, 0, v211
    v_pk_mul_f32 v[242:243], v[242:243], v[4:5] op_sel_hi:[1,0]
    v_pk_mul_f32 v[210:211], v[210:211], v[242:243]
    v_cvt_pk_bf16_f32 v209, v210, v211
    v_max_f32 v212, 0, v212
    v_max_f32 v213, 0, v213
    v_pk_mul_f32 v[244:245], v[244:245], v[4:5] op_sel_hi:[1,0]
    v_pk_mul_f32 v[212:213], v[212:213], v[244:245]
    v_cvt_pk_bf16_f32 v210, v212, v213
    v_max_f32 v214, 0, v214
    v_max_f32 v215, 0, v215
    v_pk_mul_f32 v[246:247], v[246:247], v[4:5] op_sel_hi:[1,0]
    v_pk_mul_f32 v[214:215], v[214:215], v[246:247]
    v_cvt_pk_bf16_f32 v211, v214, v215
    v_max_f32 v216, 0, v216
    v_max_f32 v217, 0, v217
    v_pk_mul_f32 v[248:249], v[248:249], v[4:5] op_sel_hi:[1,0]
    v_pk_mul_f32 v[216:217], v[216:217], v[248:249]
    v_cvt_pk_bf16_f32 v212, v216, v217
    v_max_f32 v218, 0, v218
    v_max_f32 v219, 0, v219
    v_pk_mul_f32 v[250:251], v[250:251], v[4:5] op_sel_hi:[1,0]
    v_pk_mul_f32 v[218:219], v[218:219], v[250:251]
    v_cvt_pk_bf16_f32 v213, v218, v219
    v_max_f32 v220, 0, v220
    v_max_f32 v221, 0, v221
    v_pk_mul_f32 v[252:253], v[252:253], v[4:5] op_sel_hi:[1,0]
    v_pk_mul_f32 v[220:221], v[220:221], v[252:253]
    v_cvt_pk_bf16_f32 v214, v220, v221
    v_max_f32 v222, 0, v222
    v_max_f32 v223, 0, v223
    v_pk_mul_f32 v[254:255], v[254:255], v[4:5] op_sel_hi:[1,0]
    v_pk_mul_f32 v[222:223], v[222:223], v[254:255]
    v_cvt_pk_bf16_f32 v215, v222, v223
    s_lshl_b32 s41, s10, 11
    s_add_u32 s41, s41, 33792
    s_add_u32 s41, s41, s75
    buffer_store_dwordx4 v[208:211], v6, s[56:59], s41 offen offset:0 sc1
    buffer_store_dwordx4 v[212:215], v6, s[56:59], s41 offen offset:512 sc1
    v_accvgpr_read_b32 v224, a208
    v_accvgpr_read_b32 v225, a209
    v_accvgpr_read_b32 v226, a210
    v_accvgpr_read_b32 v227, a211
    v_accvgpr_read_b32 v228, a212
    v_accvgpr_read_b32 v229, a213
    v_accvgpr_read_b32 v230, a214
    v_accvgpr_read_b32 v231, a215
    v_accvgpr_read_b32 v232, a216
    v_accvgpr_read_b32 v233, a217
    v_accvgpr_read_b32 v234, a218
    v_accvgpr_read_b32 v235, a219
    v_accvgpr_read_b32 v236, a220
    v_accvgpr_read_b32 v237, a221
    v_accvgpr_read_b32 v238, a222
    v_accvgpr_read_b32 v239, a223
    v_accvgpr_read_b32 v240, a224
    v_accvgpr_read_b32 v241, a225
    v_accvgpr_read_b32 v242, a226
    v_accvgpr_read_b32 v243, a227
    v_accvgpr_read_b32 v244, a228
    v_accvgpr_read_b32 v245, a229
    v_accvgpr_read_b32 v246, a230
    v_accvgpr_read_b32 v247, a231
    v_accvgpr_read_b32 v248, a232
    v_accvgpr_read_b32 v249, a233
    v_accvgpr_read_b32 v250, a234
    v_accvgpr_read_b32 v251, a235
    v_accvgpr_read_b32 v252, a236
    v_accvgpr_read_b32 v253, a237
    v_accvgpr_read_b32 v254, a238
    v_accvgpr_read_b32 v255, a239
    v_max_f32 v224, 0, v224
    v_max_f32 v225, 0, v225
    v_pk_mul_f32 v[240:241], v[240:241], v[4:5] op_sel_hi:[1,0]
    v_pk_mul_f32 v[224:225], v[224:225], v[240:241]
    v_cvt_pk_bf16_f32 v224, v224, v225
    v_max_f32 v226, 0, v226
    v_max_f32 v227, 0, v227
    v_pk_mul_f32 v[242:243], v[242:243], v[4:5] op_sel_hi:[1,0]
    v_pk_mul_f32 v[226:227], v[226:227], v[242:243]
    v_cvt_pk_bf16_f32 v225, v226, v227
    v_max_f32 v228, 0, v228
    v_max_f32 v229, 0, v229
    v_pk_mul_f32 v[244:245], v[244:245], v[4:5] op_sel_hi:[1,0]
    v_pk_mul_f32 v[228:229], v[228:229], v[244:245]
    v_cvt_pk_bf16_f32 v226, v228, v229
    v_max_f32 v230, 0, v230
    v_max_f32 v231, 0, v231
    v_pk_mul_f32 v[246:247], v[246:247], v[4:5] op_sel_hi:[1,0]
    v_pk_mul_f32 v[230:231], v[230:231], v[246:247]
    v_cvt_pk_bf16_f32 v227, v230, v231
    v_max_f32 v232, 0, v232
    v_max_f32 v233, 0, v233
    v_pk_mul_f32 v[248:249], v[248:249], v[4:5] op_sel_hi:[1,0]
    v_pk_mul_f32 v[232:233], v[232:233], v[248:249]
    v_cvt_pk_bf16_f32 v228, v232, v233
    v_max_f32 v234, 0, v234
    v_max_f32 v235, 0, v235
    v_pk_mul_f32 v[250:251], v[250:251], v[4:5] op_sel_hi:[1,0]
    v_pk_mul_f32 v[234:235], v[234:235], v[250:251]
    v_cvt_pk_bf16_f32 v229, v234, v235
    v_max_f32 v236, 0, v236
    v_max_f32 v237, 0, v237
    v_pk_mul_f32 v[252:253], v[252:253], v[4:5] op_sel_hi:[1,0]
    v_pk_mul_f32 v[236:237], v[236:237], v[252:253]
    v_cvt_pk_bf16_f32 v230, v236, v237
    v_max_f32 v238, 0, v238
    v_max_f32 v239, 0, v239
    v_pk_mul_f32 v[254:255], v[254:255], v[4:5] op_sel_hi:[1,0]
    v_pk_mul_f32 v[238:239], v[238:239], v[254:255]
    v_cvt_pk_bf16_f32 v231, v238, v239
    s_add_u32 s41, s10, 48
    s_lshl_b32 s41, s41, 10
    s_add_u32 s41, s41, s75
    s_cmp_lt_u32 s10, 6
    s_cselect_b32 s58, s58, 0
    buffer_store_dwordx4 v[224:227], v6, s[56:59], s41 offen offset:0 sc1
    buffer_store_dwordx4 v[228:231], v6, s[56:59], s41 offen offset:512 sc1
    s_waitcnt vmcnt(30)
    s_barrier
    ds_read_b128 a[0:3], v13 offset:57344
    ds_read_b128 a[4:7], v13 offset:59392
    ds_read_b128 a[8:11], v13 offset:61440
    ds_read_b128 a[12:15], v13 offset:63488
    ds_read_b128 a[16:19], v14 offset:0
    ds_read_b128 a[20:23], v13 offset:57856
    ds_read_b128 a[24:27], v13 offset:59904
    ds_read_b128 a[28:31], v13 offset:61952
    ds_read_b128 a[32:35], v13 offset:64000
    ds_read_b128 a[36:39], v14 offset:512
    s_waitcnt lgkmcnt(0)
    v_mfma_f32_32x32x16_bf16 v[64:79], a[0:3], v[128:131], 0
    ds_read_b128 a[40:43], v14 offset:2048
    ds_read_b128 a[44:47], v14 offset:4096
    v_mfma_f32_32x32x16_bf16 v[80:95], a[4:7], v[128:131], 0
    ds_read_b128 a[48:51], v14 offset:6144
    ds_read_b128 a[52:55], v14 offset:8192
    v_mfma_f32_32x32x16_bf16 v[96:111], a[8:11], v[128:131], 0
    s_add_u32 s93, s88, 4
    s_cmp_ge_u32 s93, 5
    s_cselect_b32 s69, 5, 0
    s_sub_u32 s93, s93, s69
    s_mul_i32 s93, s93, 2
    s_add_u32 s93, s93, s24
    s_mul_i32 s93, s93, 5120
    s_add_u32 m0, s3, 81920
    s_add_u32 s93, s93, s26
    buffer_load_dwordx4 v8, s[16:19], s93 offen offset:0 sc1 lds
    v_mfma_f32_32x32x16_bf16 v[112:127], a[12:15], v[128:131], 0
    ds_read_b128 a[56:59], v14 offset:10240
    ds_read_b128 a[60:63], v14 offset:2560
    v_mfma_f32_32x32x16_bf16 v[192:207], a[16:19], v[128:131], 0
    buffer_load_dwordx4 v8, s[16:19], s93 offen offset:1024 sc1 lds
    v_mfma_f32_32x32x16_bf16 v[64:79], a[20:23], v[132:135], v[64:79]
    ds_read_b128 a[64:67], v14 offset:4608
    ds_read_b128 a[68:71], v14 offset:6656
    v_mfma_f32_32x32x16_bf16 v[80:95], a[24:27], v[132:135], v[80:95]
    buffer_load_dwordx4 v8, s[16:19], s93 offen offset:2048 sc1 lds
    v_mfma_f32_32x32x16_bf16 v[96:111], a[28:31], v[132:135], v[96:111]
    ds_read_b128 a[72:75], v14 offset:8704
    ds_read_b128 a[76:79], v14 offset:10752
    v_mfma_f32_32x32x16_bf16 v[112:127], a[32:35], v[132:135], v[112:127]
    s_add_u32 s94, s88, 4
    s_cmp_ge_u32 s94, 5
    s_cselect_b32 s69, 5, 0
    s_sub_u32 s94, s94, s69
    s_mul_i32 s94, s94, 2
    s_add_u32 s94, s94, s24
    s_mul_i32 s94, s94, 1024
    buffer_load_dwordx4 v[128:131], v11, s[20:23], s94 offen offset:0 sc1
    v_mfma_f32_32x32x16_bf16 v[192:207], a[36:39], v[132:135], v[192:207]
    buffer_load_dwordx4 v[132:135], v11, s[20:23], s94 offen offset:512 sc1
    s_waitcnt lgkmcnt(0)
    s_waitcnt vmcnt(33)
    v_mfma_f32_32x32x16_bf16 v[64:79], a[40:43], v[136:139], v[64:79]
    ds_read_b128 a[0:3], v14 offset:12288
    ds_read_b128 a[4:7], v14 offset:14336
    v_mfma_f32_32x32x16_bf16 v[80:95], a[44:47], v[136:139], v[80:95]
    ds_read_b128 a[8:11], v14 offset:16384
    ds_read_b128 a[12:15], v14 offset:18432
    v_mfma_f32_32x32x16_bf16 v[96:111], a[48:51], v[136:139], v[96:111]
    buffer_load_dwordx4 v8, s[16:19], s93 offen offset:3072 sc1 lds
    v_mfma_f32_32x32x16_bf16 v[112:127], a[52:55], v[136:139], v[112:127]
    ds_read_b128 a[16:19], v14 offset:20480
    ds_read_b128 a[20:23], v14 offset:12800
    v_mfma_f32_32x32x16_bf16 v[192:207], a[56:59], v[136:139], v[192:207]
    s_add_u32 m0, s3, 86016
    s_add_u32 s93, s93, 4096
    buffer_load_dwordx4 v8, s[16:19], s93 offen offset:0 sc1 lds
    v_mfma_f32_32x32x16_bf16 v[64:79], a[60:63], v[140:143], v[64:79]
    ds_read_b128 a[24:27], v14 offset:14848
    ds_read_b128 a[28:31], v14 offset:16896
    s_waitcnt vmcnt(7)
    v_mov_b32 v42, 1
    buffer_atomic_add v42, v41, s[60:63], 0 offen
    v_mfma_f32_32x32x16_bf16 v[80:95], a[64:67], v[140:143], v[80:95]
    s_add_u32 s93, s72, 0
    s_cmp_ge_u32 s93, 5
    s_cselect_b32 s69, 5, 0
    s_sub_u32 s93, s93, s69
    s_mul_i32 s93, s93, 2
    s_add_u32 s93, s93, s25
    s_mul_i32 s93, s93, 5120
    s_add_u32 m0, s3, 102400
    s_add_u32 s93, s93, s26
    buffer_load_dwordx4 v8, s[16:19], s93 offen offset:0 sc1 lds
    v_mfma_f32_32x32x16_bf16 v[96:111], a[68:71], v[140:143], v[96:111]
    ds_read_b128 a[32:35], v14 offset:18944
    ds_read_b128 a[36:39], v14 offset:20992
    v_mfma_f32_32x32x16_bf16 v[112:127], a[72:75], v[140:143], v[112:127]
    buffer_load_dwordx4 v[136:139], v11, s[20:23], s94 offen offset:1024 sc1
    v_mfma_f32_32x32x16_bf16 v[192:207], a[76:79], v[140:143], v[192:207]
    buffer_load_dwordx4 v[140:143], v11, s[20:23], s94 offen offset:1536 sc1
    s_waitcnt lgkmcnt(0)
    v_mfma_f32_32x32x16_bf16 v[64:79], a[0:3], v[144:147], v[64:79]
    ds_read_b128 a[40:43], v14 offset:22528
    ds_read_b128 a[44:47], v14 offset:24576
    v_mfma_f32_32x32x16_bf16 v[80:95], a[4:7], v[144:147], v[80:95]
    ds_read_b128 a[48:51], v14 offset:26624
    ds_read_b128 a[52:55], v14 offset:28672
    v_mfma_f32_32x32x16_bf16 v[96:111], a[8:11], v[144:147], v[96:111]
    buffer_load_dwordx4 v8, s[16:19], s93 offen offset:1024 sc1 lds
    v_mfma_f32_32x32x16_bf16 v[112:127], a[12:15], v[144:147], v[112:127]
    ds_read_b128 a[56:59], v14 offset:30720
    ds_read_b128 a[60:63], v14 offset:23040
    v_mfma_f32_32x32x16_bf16 v[192:207], a[16:19], v[144:147], v[192:207]
    buffer_load_dwordx4 v8, s[16:19], s93 offen offset:2048 sc1 lds
    v_mfma_f32_32x32x16_bf16 v[64:79], a[20:23], v[148:151], v[64:79]
    ds_read_b128 a[64:67], v14 offset:25088
    ds_read_b128 a[68:71], v14 offset:27136
    v_mfma_f32_32x32x16_bf16 v[80:95], a[24:27], v[148:151], v[80:95]
    buffer_load_dwordx4 v8, s[16:19], s93 offen offset:3072 sc1 lds
    v_mfma_f32_32x32x16_bf16 v[96:111], a[28:31], v[148:151], v[96:111]
    ds_read_b128 a[72:75], v14 offset:29184
    ds_read_b128 a[76:79], v14 offset:31232
    v_mfma_f32_32x32x16_bf16 v[112:127], a[32:35], v[148:151], v[112:127]
    v_mfma_f32_32x32x16_bf16 v[192:207], a[36:39], v[148:151], v[192:207]
    s_waitcnt lgkmcnt(0)
    v_mfma_f32_32x32x16_bf16 v[64:79], a[40:43], v[152:155], v[64:79]
    s_barrier
    ds_read_b128 a[0:3], v12 offset:40960
    ds_read_b128 a[4:7], v12 offset:43008
    v_mfma_f32_32x32x16_bf16 v[80:95], a[44:47], v[152:155], v[80:95]
    ds_read_b128 a[8:11], v12 offset:45056
    ds_read_b128 a[12:15], v12 offset:47104
    v_mfma_f32_32x32x16_bf16 v[96:111], a[48:51], v[152:155], v[96:111]
    s_add_u32 m0, s3, 106496
    s_add_u32 s93, s93, 4096
    buffer_load_dwordx4 v8, s[16:19], s93 offen offset:0 sc1 lds
    v_mfma_f32_32x32x16_bf16 v[112:127], a[52:55], v[152:155], v[112:127]
    ds_read_b128 a[16:19], v12 offset:49152
    ds_read_b128 a[20:23], v12 offset:41472
    v_mfma_f32_32x32x16_bf16 v[192:207], a[56:59], v[152:155], v[192:207]
    s_add_u32 s93, s72, 1
    s_cmp_ge_u32 s93, 5
    s_cselect_b32 s69, 5, 0
    s_sub_u32 s93, s93, s69
    s_mul_i32 s93, s93, 2
    s_add_u32 s93, s93, s25
    s_mul_i32 s93, s93, 5120
    s_add_u32 m0, s3, 0
    s_add_u32 s93, s93, s26
    buffer_load_dwordx4 v8, s[16:19], s93 offen offset:0 sc1 lds
    v_mfma_f32_32x32x16_bf16 v[64:79], a[60:63], v[156:159], v[64:79]
    ds_read_b128 a[24:27], v12 offset:43520
    ds_read_b128 a[28:31], v12 offset:45568
    v_mfma_f32_32x32x16_bf16 v[80:95], a[64:67], v[156:159], v[80:95]
    buffer_load_dwordx4 v8, s[16:19], s93 offen offset:1024 sc1 lds
    v_mfma_f32_32x32x16_bf16 v[96:111], a[68:71], v[156:159], v[96:111]
    ds_read_b128 a[32:35], v12 offset:47616
    ds_read_b128 a[36:39], v12 offset:49664
    v_mfma_f32_32x32x16_bf16 v[112:127], a[72:75], v[156:159], v[112:127]
    v_mfma_f32_32x32x16_bf16 v[192:207], a[76:79], v[156:159], v[192:207]
    s_waitcnt lgkmcnt(0)
    v_mfma_f32_32x32x16_bf16 v[64:79], a[0:3], v[160:163], v[64:79]
    ds_read_b128 a[40:43], v12 offset:51200
    ds_read_b128 a[44:47], v12 offset:53248
    v_mfma_f32_32x32x16_bf16 v[80:95], a[4:7], v[160:163], v[80:95]
    ds_read_b128 a[48:51], v12 offset:55296
    ds_read_b128 a[52:55], v12 offset:57344
    v_mfma_f32_32x32x16_bf16 v[96:111], a[8:11], v[160:163], v[96:111]
    buffer_load_dwordx4 v8, s[16:19], s93 offen offset:2048 sc1 lds
    v_mfma_f32_32x32x16_bf16 v[112:127], a[12:15], v[160:163], v[112:127]
    ds_read_b128 a[56:59], v12 offset:59392
    ds_read_b128 a[60:63], v12 offset:51712
    s_lshl_b32 s64, s86, 12
    s_add_u32 s64, s64, 256
    v_mfma_f32_32x32x16_bf16 v[192:207], a[16:19], v[160:163], v[192:207]
    buffer_load_dwordx4 v8, s[16:19], s93 offen offset:3072 sc1 lds
    v_mfma_f32_32x32x16_bf16 v[64:79], a[20:23], v[164:167], v[64:79]
    ds_read_b128 a[64:67], v12 offset:53760
    ds_read_b128 a[68:71], v12 offset:55808
    v_min_u32 v30, 3, v1
    v_mfma_f32_32x32x16_bf16 v[80:95], a[24:27], v[164:167], v[80:95]
    s_add_u32 m0, s3, 4096
    s_add_u32 s93, s93, 4096
    buffer_load_dwordx4 v8, s[16:19], s93 offen offset:0 sc1 lds
    v_mfma_f32_32x32x16_bf16 v[96:111], a[28:31], v[164:167], v[96:111]
    ds_read_b128 a[72:75], v12 offset:57856
    ds_read_b128 a[76:79], v12 offset:59904
    v_lshl_add_u32 v30, v30, 7, s64
    v_mfma_f32_32x32x16_bf16 v[112:127], a[32:35], v[164:167], v[112:127]
    v_mov_b32 v31, 8
    buffer_load_dword v40, v30, s[60:63], s73 offen sc1
    v_mfma_f32_32x32x16_bf16 v[192:207], a[36:39], v[164:167], v[192:207]
    s_waitcnt lgkmcnt(0)
    v_mfma_f32_32x32x16_bf16 v[64:79], a[40:43], v[168:171], v[64:79]
    ds_read_b128 a[0:3], v12 offset:61440
    ds_read_b128 a[4:7], v12 offset:63488
    v_mfma_f32_32x32x16_bf16 v[80:95], a[44:47], v[168:171], v[80:95]
    ds_read_b128 a[8:11], v13 offset:0
    ds_read_b128 a[12:15], v13 offset:2048
    v_mfma_f32_32x32x16_bf16 v[96:111], a[48:51], v[168:171], v[96:111]
    s_add_u32 s93, s72, 2
    s_cmp_ge_u32 s93, 5
    s_cselect_b32 s69, 5, 0
    s_sub_u32 s93, s93, s69
    s_mul_i32 s93, s93, 2
    s_add_u32 s93, s93, s25
    s_mul_i32 s93, s93, 5120
    s_add_u32 m0, s3, 20480
    s_add_u32 s93, s93, s26
    buffer_load_dwordx4 v8, s[16:19], s93 offen offset:0 sc1 lds
    v_mfma_f32_32x32x16_bf16 v[112:127], a[52:55], v[168:171], v[112:127]
    ds_read_b128 a[16:19], v13 offset:4096
    ds_read_b128 a[20:23], v12 offset:61952
    v_mfma_f32_32x32x16_bf16 v[192:207], a[56:59], v[168:171], v[192:207]
    buffer_load_dwordx4 v8, s[16:19], s93 offen offset:1024 sc1 lds
    v_mfma_f32_32x32x16_bf16 v[64:79], a[60:63], v[172:175], v[64:79]
    ds_read_b128 a[24:27], v12 offset:64000
    ds_read_b128 a[28:31], v13 offset:512
    v_mfma_f32_32x32x16_bf16 v[80:95], a[64:67], v[172:175], v[80:95]
    buffer_load_dwordx4 v8, s[16:19], s93 offen offset:2048 sc1 lds
    v_mfma_f32_32x32x16_bf16 v[96:111], a[68:71], v[172:175], v[96:111]
    ds_read_b128 a[32:35], v13 offset:2560
    ds_read_b128 a[36:39], v13 offset:4608
    v_mfma_f32_32x32x16_bf16 v[112:127], a[72:75], v[172:175], v[112:127]
    v_mfma_f32_32x32x16_bf16 v[192:207], a[76:79], v[172:175], v[192:207]
    s_waitcnt lgkmcnt(0)
    v_mfma_f32_32x32x16_bf16 v[64:79], a[0:3], v[176:179], v[64:79]
    ds_read_b128 a[40:43], v13 offset:6144
    ds_read_b128 a[44:47], v13 offset:8192
    v_mfma_f32_32x32x16_bf16 v[80:95], a[4:7], v[176:179], v[80:95]
    ds_read_b128 a[48:51], v13 offset:10240
    ds_read_b128 a[52:55], v13 offset:12288
    v_mfma_f32_32x32x16_bf16 v[96:111], a[8:11], v[176:179], v[96:111]
    buffer_load_dwordx4 v8, s[16:19], s93 offen offset:3072 sc1 lds
    v_mfma_f32_32x32x16_bf16 v[112:127], a[12:15], v[176:179], v[112:127]
    ds_read_b128 a[56:59], v13 offset:14336
    ds_read_b128 a[60:63], v13 offset:6656
    v_mfma_f32_32x32x16_bf16 v[192:207], a[16:19], v[176:179], v[192:207]
    s_add_u32 m0, s3, 24576
    s_add_u32 s93, s93, 4096
    buffer_load_dwordx4 v8, s[16:19], s93 offen offset:0 sc1 lds
    v_mfma_f32_32x32x16_bf16 v[64:79], a[20:23], v[180:183], v[64:79]
    ds_read_b128 a[64:67], v13 offset:8704
    ds_read_b128 a[68:71], v13 offset:10752
    v_mfma_f32_32x32x16_bf16 v[80:95], a[24:27], v[180:183], v[80:95]
    s_add_u32 s93, s72, 3
    s_cmp_ge_u32 s93, 5
    s_cselect_b32 s69, 5, 0
    s_sub_u32 s93, s93, s69
    s_mul_i32 s93, s93, 2
    s_add_u32 s93, s93, s25
    s_mul_i32 s93, s93, 5120
    s_add_u32 m0, s3, 122880
    s_add_u32 s93, s93, s26
    buffer_load_dwordx4 v8, s[16:19], s93 offen offset:0 sc1 lds
    v_mfma_f32_32x32x16_bf16 v[96:111], a[28:31], v[180:183], v[96:111]
    ds_read_b128 a[72:75], v13 offset:12800
    ds_read_b128 a[76:79], v13 offset:14848
    v_mfma_f32_32x32x16_bf16 v[112:127], a[32:35], v[180:183], v[112:127]
    v_mfma_f32_32x32x16_bf16 v[192:207], a[36:39], v[180:183], v[192:207]
    s_waitcnt vmcnt(6)
    v_cmp_le_u32 vcc, v31, v40
    s_nop 1
    s_cmp_eq_u64 vcc, -1
    s_cbranch_scc1 L_h2_6_ok
    s_cmp_lg_u32 s38, 0
    s_cbranch_scc1 L_h2_6_ok
    s_mov_b32 s69, 0
L_h2_6_spin:
    buffer_load_dword v40, v30, s[60:63], 0 offen sc1
    s_waitcnt vmcnt(0)
    v_cmp_le_u32 vcc, v31, v40
    s_nop 1
    s_cmp_eq_u64 vcc, -1
    s_cbranch_scc1 L_h2_6_ok
    s_sleep 2
    s_add_u32 s69, s69, 1
    s_cmp_lt_u32 s69, 0x4000
    s_cbranch_scc1 L_h2_6_spin
L_h2_6_ok:
    s_waitcnt lgkmcnt(0)
    v_mfma_f32_32x32x16_bf16 v[64:79], a[40:43], v[184:187], v[64:79]
    s_barrier
    ds_read_b128 a[0:3], v13 offset:16384
    ds_read_b128 a[4:7], v13 offset:18432
    v_mfma_f32_32x32x16_bf16 v[80:95], a[44:47], v[184:187], v[80:95]
    ds_read_b128 a[8:11], v13 offset:20480
    ds_read_b128 a[12:15], v13 offset:22528
    s_add_u32 m0, s3, 122880
    v_mfma_f32_32x32x16_bf16 v[96:111], a[48:51], v[184:187], v[96:111]
    buffer_load_dwordx4 v8, s[16:19], s93 offen offset:1024 sc1 lds
    v_mfma_f32_32x32x16_bf16 v[112:127], a[52:55], v[184:187], v[112:127]
    ds_read_b128 a[16:19], v13 offset:24576
    ds_read_b128 a[20:23], v13 offset:16896
    v_mfma_f32_32x32x16_bf16 v[192:207], a[56:59], v[184:187], v[192:207]
    buffer_load_dwordx4 v8, s[16:19], s93 offen offset:2048 sc1 lds
    v_mfma_f32_32x32x16_bf16 v[64:79], a[60:63], v[188:191], v[64:79]
    ds_read_b128 a[24:27], v13 offset:18944
    ds_read_b128 a[28:31], v13 offset:20992
    v_mfma_f32_32x32x16_bf16 v[80:95], a[64:67], v[188:191], v[80:95]
    buffer_load_dwordx4 v8, s[16:19], s93 offen offset:3072 sc1 lds
    v_mfma_f32_32x32x16_bf16 v[96:111], a[68:71], v[188:191], v[96:111]
    ds_read_b128 a[32:35], v13 offset:23040
    ds_read_b128 a[36:39], v13 offset:25088
    v_mfma_f32_32x32x16_bf16 v[112:127], a[72:75], v[188:191], v[112:127]
    s_add_u32 s95, s72, 0
    s_cmp_ge_u32 s95, 5
    s_cselect_b32 s69, 5, 0
    s_sub_u32 s95, s95, s69
    s_mul_i32 s95, s95, 2
    s_add_u32 s95, s95, s25
    s_mul_i32 s95, s95, 1024
    buffer_load_dwordx4 v[144:147], v11, s[20:23], s95 offen offset:0 sc1
    v_mfma_f32_32x32x16_bf16 v[192:207], a[76:79], v[188:191], v[192:207]
    buffer_load_dwordx4 v[148:151], v11, s[20:23], s95 offen offset:512 sc1
    buffer_load_dwordx4 v[152:155], v11, s[20:23], s95 offen offset:1024 sc1
    buffer_load_dwordx4 v[156:159], v11, s[20:23], s95 offen offset:1536 sc1
    s_add_u32 s94, s72, 1
    s_cmp_ge_u32 s94, 5
    s_cselect_b32 s69, 5, 0
    s_sub_u32 s94, s94, s69
    s_mul_i32 s94, s94, 2
    s_add_u32 s94, s94, s25
    s_mul_i32 s94, s94, 1024
    buffer_load_dwordx4 v[160:163], v11, s[20:23], s94 offen offset:0 sc1
    buffer_load_dwordx4 v[164:167], v11, s[20:23], s94 offen offset:512 sc1
    buffer_load_dwordx4 v[168:171], v11, s[20:23], s94 offen offset:1024 sc1
    buffer_load_dwordx4 v[172:175], v11, s[20:23], s94 offen offset:1536 sc1
    s_add_u32 s95, s72, 2
    s_cmp_ge_u32 s95, 5
    s_cselect_b32 s69, 5, 0
    s_sub_u32 s95, s95, s69
    s_mul_i32 s95, s95, 2
    s_add_u32 s95, s95, s25
    s_mul_i32 s95, s95, 1024
    buffer_load_dwordx4 v[176:179], v11, s[20:23], s95 offen offset:0 sc1
    buffer_load_dwordx4 v[180:183], v11, s[20:23], s95 offen offset:512 sc1
    buffer_load_dwordx4 v[184:187], v11, s[20:23], s95 offen offset:1024 sc1
    buffer_load_dwordx4 v[188:191], v11, s[20:23], s95 offen offset:1536 sc1
    s_waitcnt lgkmcnt(0)
    v_mfma_f32_32x32x16_bf16 v[64:79], a[0:3], v[128:131], v[64:79]
    ds_read_b128 a[40:43], v13 offset:26624
    ds_read_b128 a[44:47], v13 offset:28672
    v_mfma_f32_32x32x16_bf16 v[80:95], a[4:7], v[128:131], v[80:95]
    ds_read_b128 a[48:51], v13 offset:30720
    ds_read_b128 a[52:55], v13 offset:32768
    v_mfma_f32_32x32x16_bf16 v[96:111], a[8:11], v[128:131], v[96:111]
    s_add_u32 m0, s3, 126976
    s_add_u32 s93, s93, 4096
    buffer_load_dwordx4 v8, s[16:19], s93 offen offset:0 sc1 lds
    v_mfma_f32_32x32x16_bf16 v[112:127], a[12:15], v[128:131], v[112:127]
    ds_read_b128 a[56:59], v13 offset:34816
    ds_read_b128 a[60:63], v13 offset:27136
    v_mfma_f32_32x32x16_bf16 v[192:207], a[16:19], v[128:131], v[192:207]
    s_add_u32 s93, s72, 4
    s_cmp_ge_u32 s93, 5
    s_cselect_b32 s69, 5, 0
    s_sub_u32 s93, s93, s69
    s_mul_i32 s93, s93, 2
    s_add_u32 s93, s93, s25
    s_mul_i32 s93, s93, 5120
    s_add_u32 m0, s3, 143360
    s_add_u32 s93, s93, s26
    buffer_load_dwordx4 v8, s[16:19], s93 offen offset:0 sc1 lds
    v_mfma_f32_32x32x16_bf16 v[64:79], a[20:23], v[132:135], v[64:79]
    ds_read_b128 a[64:67], v13 offset:29184
    ds_read_b128 a[68:71], v13 offset:31232
    v_mfma_f32_32x32x16_bf16 v[80:95], a[24:27], v[132:135], v[80:95]
    buffer_load_dwordx4 v8, s[16:19], s93 offen offset:1024 sc1 lds
    v_mfma_f32_32x32x16_bf16 v[96:111], a[28:31], v[132:135], v[96:111]
    ds_read_b128 a[72:75], v13 offset:33280
    ds_read_b128 a[76:79], v13 offset:35328
    v_mfma_f32_32x32x16_bf16 v[112:127], a[32:35], v[132:135], v[112:127]
    s_add_u32 s94, s72, 3
    s_cmp_ge_u32 s94, 5
    s_cselect_b32 s69, 5, 0
    s_sub_u32 s94, s94, s69
    s_mul_i32 s94, s94, 2
    s_add_u32 s94, s94, s25
    s_mul_i32 s94, s94, 1024
    buffer_load_dwordx4 v[128:131], v11, s[20:23], s94 offen offset:0 sc1
    v_mfma_f32_32x32x16_bf16 v[192:207], a[36:39], v[132:135], v[192:207]
    buffer_load_dwordx4 v[132:135], v11, s[20:23], s94 offen offset:512 sc1
    s_waitcnt lgkmcnt(0)
    v_mfma_f32_32x32x16_bf16 v[64:79], a[40:43], v[136:139], v[64:79]
    ds_read_b128 a[0:3], v13 offset:36864
    ds_read_b128 a[4:7], v13 offset:38912
    v_mfma_f32_32x32x16_bf16 v[80:95], a[44:47], v[136:139], v[80:95]
    ds_read_b128 a[8:11], v13 offset:40960
    ds_read_b128 a[12:15], v13 offset:43008
    v_mfma_f32_32x32x16_bf16 v[96:111], a[48:51], v[136:139], v[96:111]
    buffer_load_dwordx4 v8, s[16:19], s93 offen offset:2048 sc1 lds
    v_mfma_f32_32x32x16_bf16 v[112:127], a[52:55], v[136:139], v[112:127]
    ds_read_b128 a[16:19], v13 offset:45056
    ds_read_b128 a[20:23], v13 offset:37376
    v_mfma_f32_32x32x16_bf16 v[192:207], a[56:59], v[136:139], v[192:207]
    buffer_load_dwordx4 v8, s[16:19], s93 offen offset:3072 sc1 lds
    v_mfma_f32_32x32x16_bf16 v[64:79], a[60:63], v[140:143], v[64:79]
    ds_read_b128 a[24:27], v13 offset:39424
    ds_read_b128 a[28:31], v13 offset:41472
    v_mfma_f32_32x32x16_bf16 v[80:95], a[64:67], v[140:143], v[80:95]
    s_add_u32 m0, s3, 147456
    s_add_u32 s93, s93, 4096
    buffer_load_dwordx4 v8, s[16:19], s93 offen offset:0 sc1 lds
    v_mfma_f32_32x32x16_bf16 v[96:111], a[68:71], v[140:143], v[96:111]
    ds_read_b128 a[32:35], v13 offset:43520
    ds_read_b128 a[36:39], v13 offset:45568
    v_mfma_f32_32x32x16_bf16 v[112:127], a[72:75], v[140:143], v[112:127]
    buffer_load_dwordx4 v[136:139], v11, s[20:23], s94 offen offset:1024 sc1
    v_mfma_f32_32x32x16_bf16 v[192:207], a[76:79], v[140:143], v[192:207]
    buffer_load_dwordx4 v[140:143], v11, s[20:23], s94 offen offset:1536 sc1
    s_waitcnt lgkmcnt(0)
    s_waitcnt vmcnt(20)
    v_mfma_f32_32x32x16_bf16 v[64:79], a[0:3], v[144:147], v[64:79]
    ds_read_b128 a[40:43], v13 offset:47104
    ds_read_b128 a[44:47], v13 offset:49152
    v_mfma_f32_32x32x16_bf16 v[80:95], a[4:7], v[144:147], v[80:95]
    ds_read_b128 a[48:51], v13 offset:51200
    ds_read_b128 a[52:55], v13 offset:53248
    v_mfma_f32_32x32x16_bf16 v[96:111], a[8:11], v[144:147], v[96:111]
    v_mfma_f32_32x32x16_bf16 v[112:127], a[12:15], v[144:147], v[112:127]
    ds_read_b128 a[56:59], v13 offset:55296
    ds_read_b128 a[60:63], v13 offset:47616
    v_mfma_f32_32x32x16_bf16 v[192:207], a[16:19], v[144:147], v[192:207]
    v_mfma_f32_32x32x16_bf16 v[64:79], a[20:23], v[148:151], v[64:79]
    ds_read_b128 a[64:67], v13 offset:49664
    ds_read_b128 a[68:71], v13 offset:51712
    v_mfma_f32_32x32x16_bf16 v[80:95], a[24:27], v[148:151], v[80:95]
    v_mfma_f32_32x32x16_bf16 v[96:111], a[28:31], v[148:151], v[96:111]
    ds_read_b128 a[72:75], v13 offset:53760
    ds_read_b128 a[76:79], v13 offset:55808
    v_mfma_f32_32x32x16_bf16 v[112:127], a[32:35], v[148:151], v[112:127]
    s_add_u32 s95, s72, 4
    s_cmp_ge_u32 s95, 5
    s_cselect_b32 s69, 5, 0
    s_sub_u32 s95, s95, s69
    s_mul_i32 s95, s95, 2
    s_add_u32 s95, s95, s25
    s_mul_i32 s95, s95, 1024
    buffer_load_dwordx4 v[144:147], v11, s[20:23], s95 offen offset:0 sc1
    v_mfma_f32_32x32x16_bf16 v[192:207], a[36:39], v[148:151], v[192:207]
    buffer_load_dwordx4 v[148:151], v11, s[20:23], s95 offen offset:512 sc1
    s_waitcnt lgkmcnt(0)
    s_waitcnt vmcnt(20)
    v_mfma_f32_32x32x16_bf16 v[64:79], a[40:43], v[152:155], v[64:79]
    s_barrier
    ds_read_b128 a[0:3], v12 offset:0
    ds_read_b128 a[4:7], v12 offset:2048
    v_mfma_f32_32x32x16_bf16 v[80:95], a[44:47], v[152:155], v[80:95]
    ds_read_b128 a[8:11], v12 offset:4096
    ds_read_b128 a[12:15], v12 offset:6144
    v_mfma_f32_32x32x16_bf16 v[96:111], a[48:51], v[152:155], v[96:111]
    v_mfma_f32_32x32x16_bf16 v[112:127], a[52:55], v[152:155], v[112:127]
    ds_read_b128 a[16:19], v12 offset:8192
    ds_read_b128 a[20:23], v12 offset:512
    v_mfma_f32_32x32x16_bf16 v[192:207], a[56:59], v[152:155], v[192:207]
    v_mfma_f32_32x32x16_bf16 v[64:79], a[60:63], v[156:159], v[64:79]
    ds_read_b128 a[24:27], v12 offset:2560
    ds_read_b128 a[28:31], v12 offset:4608
    v_mfma_f32_32x32x16_bf16 v[80:95], a[64:67], v[156:159], v[80:95]
    v_mfma_f32_32x32x16_bf16 v[96:111], a[68:71], v[156:159], v[96:111]
    ds_read_b128 a[32:35], v12 offset:6656
    ds_read_b128 a[36:39], v12 offset:8704
    v_mfma_f32_32x32x16_bf16 v[112:127], a[72:75], v[156:159], v[112:127]
    buffer_load_dwordx4 v[152:155], v11, s[20:23], s95 offen offset:1024 sc1
    v_mfma_f32_32x32x16_bf16 v[192:207], a[76:79], v[156:159], v[192:207]
    buffer_load_dwordx4 v[156:159], v11, s[20:23], s95 offen offset:1536 sc1
    s_waitcnt lgkmcnt(0)
    s_waitcnt vmcnt(20)
    v_mfma_f32_32x32x16_bf16 v[64:79], a[0:3], v[160:163], v[64:79]
    ds_read_b128 a[40:43], v12 offset:10240
    ds_read_b128 a[44:47], v12 offset:12288
    v_mfma_f32_32x32x16_bf16 v[80:95], a[4:7], v[160:163], v[80:95]
    ds_read_b128 a[48:51], v12 offset:14336
    ds_read_b128 a[52:55], v12 offset:16384
    v_mfma_f32_32x32x16_bf16 v[96:111], a[8:11], v[160:163], v[96:111]
    v_mfma_f32_32x32x16_bf16 v[112:127], a[12:15], v[160:163], v[112:127]
    ds_read_b128 a[56:59], v12 offset:18432
    ds_read_b128 a[60:63], v12 offset:10752
    v_mfma_f32_32x32x16_bf16 v[192:207], a[16:19], v[160:163], v[192:207]
    v_mfma_f32_32x32x16_bf16 v[64:79], a[20:23], v[164:167], v[64:79]
    ds_read_b128 a[64:67], v12 offset:12800
    ds_read_b128 a[68:71], v12 offset:14848
    v_mfma_f32_32x32x16_bf16 v[80:95], a[24:27], v[164:167], v[80:95]
    v_mfma_f32_32x32x16_bf16 v[96:111], a[28:31], v[164:167], v[96:111]
    ds_read_b128 a[72:75], v12 offset:16896
    ds_read_b128 a[76:79], v12 offset:18944
    v_mfma_f32_32x32x16_bf16 v[112:127], a[32:35], v[164:167], v[112:127]
    v_mfma_f32_32x32x16_bf16 v[192:207], a[36:39], v[164:167], v[192:207]
    s_waitcnt lgkmcnt(0)
    s_waitcnt vmcnt(18)
    v_mfma_f32_32x32x16_bf16 v[64:79], a[40:43], v[168:171], v[64:79]
    ds_read_b128 a[0:3], v12 offset:20480
    ds_read_b128 a[4:7], v12 offset:22528
    v_mfma_f32_32x32x16_bf16 v[80:95], a[44:47], v[168:171], v[80:95]
    ds_read_b128 a[8:11], v12 offset:24576
    ds_read_b128 a[12:15], v12 offset:26624
    v_mfma_f32_32x32x16_bf16 v[96:111], a[48:51], v[168:171], v[96:111]
    v_mfma_f32_32x32x16_bf16 v[112:127], a[52:55], v[168:171], v[112:127]
    ds_read_b128 a[16:19], v12 offset:28672
    ds_read_b128 a[20:23], v12 offset:20992
    v_mfma_f32_32x32x16_bf16 v[192:207], a[56:59], v[168:171], v[192:207]
    v_mfma_f32_32x32x16_bf16 v[64:79], a[60:63], v[172:175], v[64:79]
    ds_read_b128 a[24:27], v12 offset:23040
    ds_read_b128 a[28:31], v12 offset:25088
    v_mfma_f32_32x32x16_bf16 v[80:95], a[64:67], v[172:175], v[80:95]
    v_mfma_f32_32x32x16_bf16 v[96:111], a[68:71], v[172:175], v[96:111]
    ds_read_b128 a[32:35], v12 offset:27136
    ds_read_b128 a[36:39], v12 offset:29184
    v_mfma_f32_32x32x16_bf16 v[112:127], a[72:75], v[172:175], v[112:127]
    v_mfma_f32_32x32x16_bf16 v[192:207], a[76:79], v[172:175], v[192:207]
    s_waitcnt lgkmcnt(0)
    s_waitcnt vmcnt(16)
    v_mfma_f32_32x32x16_bf16 v[64:79], a[0:3], v[176:179], v[64:79]
    ds_read_b128 a[40:43], v12 offset:30720
    ds_read_b128 a[44:47], v12 offset:32768
    v_mfma_f32_32x32x16_bf16 v[80:95], a[4:7], v[176:179], v[80:95]
    ds_read_b128 a[48:51], v12 offset:34816
    ds_read_b128 a[52:55], v12 offset:36864
    v_mfma_f32_32x32x16_bf16 v[96:111], a[8:11], v[176:179], v[96:111]
    v_mfma_f32_32x32x16_bf16 v[112:127], a[12:15], v[176:179], v[112:127]
    ds_read_b128 a[56:59], v12 offset:38912
    ds_read_b128 a[60:63], v12 offset:31232
    v_mfma_f32_32x32x16_bf16 v[192:207], a[16:19], v[176:179], v[192:207]
    v_mfma_f32_32x32x16_bf16 v[64:79], a[20:23], v[180:183], v[64:79]
    ds_read_b128 a[64:67], v12 offset:33280
    ds_read_b128 a[68:71], v12 offset:35328
    v_mfma_f32_32x32x16_bf16 v[80:95], a[24:27], v[180:183], v[80:95]
    v_mfma_f32_32x32x16_bf16 v[96:111], a[28:31], v[180:183], v[96:111]
    ds_read_b128 a[72:75], v12 offset:37376
    ds_read_b128 a[76:79], v12 offset:39424
    v_mfma_f32_32x32x16_bf16 v[112:127], a[32:35], v[180:183], v[112:127]
    v_mfma_f32_32x32x16_bf16 v[192:207], a[36:39], v[180:183], v[192:207]
    s_waitcnt vmcnt(6) lgkmcnt(0)
    v_mfma_f32_32x32x16_bf16 v[64:79], a[40:43], v[184:187], v[64:79]
    s_barrier
    ds_read_b128 a[0:3], v13 offset:57344
    ds_read_b128 a[4:7], v13 offset:59392
    v_mfma_f32_32x32x16_bf16 v[80:95], a[44:47], v[184:187], v[80:95]
    ds_read_b128 a[8:11], v13 offset:61440
    ds_read_b128 a[12:15], v13 offset:63488
    v_mfma_f32_32x32x16_bf16 v[96:111], a[48:51], v[184:187], v[96:111]
    s_lshl_b32 s64, s86, 3
    s_add_u32 s64, s64, s87
    v_mfma_f32_32x32x16_bf16 v[112:127], a[52:55], v[184:187], v[112:127]
    ds_read_b128 a[16:19], v14 offset:0
    ds_read_b128 a[20:23], v13 offset:57856
    v_mfma_f32_32x32x16_bf16 v[192:207], a[56:59], v[184:187], v[192:207]
    s_mul_i32 s64, s64, 40960
    v_mfma_f32_32x32x16_bf16 v[64:79], a[60:63], v[188:191], v[64:79]
    ds_read_b128 a[24:27], v13 offset:59904
    ds_read_b128 a[28:31], v13 offset:61952
    v_mfma_f32_32x32x16_bf16 v[80:95], a[64:67], v[188:191], v[80:95]
    s_mul_i32 s65, s38, 10240
    v_mfma_f32_32x32x16_bf16 v[96:111], a[68:71], v[188:191], v[96:111]
    ds_read_b128 a[32:35], v13 offset:64000
    ds_read_b128 a[36:39], v14 offset:512
    v_mfma_f32_32x32x16_bf16 v[112:127], a[72:75], v[188:191], v[112:127]
    s_add_u32 s64, s64, s65
    v_mfma_f32_32x32x16_bf16 v[192:207], a[76:79], v[188:191], v[192:207]
    s_add_u32 s64, s64, 13631488
    s_waitcnt lgkmcnt(0)
    v_mfma_f32_32x32x16_bf16 v[64:79], a[0:3], v[128:131], v[64:79]
    ds_read_b128 a[40:43], v14 offset:2048
    ds_read_b128 a[44:47], v14 offset:4096
    v_mfma_f32_32x32x16_bf16 v[80:95], a[4:7], v[128:131], v[80:95]
    ds_read_b128 a[48:51], v14 offset:6144
    ds_read_b128 a[52:55], v14 offset:8192
    v_mfma_f32_32x32x16_bf16 v[96:111], a[8:11], v[128:131], v[96:111]
    s_add_u32 s12, s36, s64
    s_addc_u32 s13, s37, 0
    v_mfma_f32_32x32x16_bf16 v[112:127], a[12:15], v[128:131], v[112:127]
    ds_read_b128 a[56:59], v14 offset:10240
    ds_read_b128 a[60:63], v14 offset:2560
    v_mfma_f32_32x32x16_bf16 v[192:207], a[16:19], v[128:131], v[192:207]
    s_mov_b32 s14, 10240
    v_mfma_f32_32x32x16_bf16 v[64:79], a[20:23], v[132:135], v[64:79]
    ds_read_b128 a[64:67], v14 offset:4608
    ds_read_b128 a[68:71], v14 offset:6656
    v_mfma_f32_32x32x16_bf16 v[80:95], a[24:27], v[132:135], v[80:95]
    s_mov_b32 s15, 0x00020000
    s_lshl_b32 s64, s86, 12
    v_mfma_f32_32x32x16_bf16 v[96:111], a[28:31], v[132:135], v[96:111]
    ds_read_b128 a[72:75], v14 offset:8704
    ds_read_b128 a[76:79], v14 offset:10752
    v_mfma_f32_32x32x16_bf16 v[112:127], a[32:35], v[132:135], v[112:127]
    s_lshl_b32 s65, s87, 7
    v_mfma_f32_32x32x16_bf16 v[192:207], a[36:39], v[132:135], v[192:207]
    s_waitcnt lgkmcnt(0)
    s_waitcnt vmcnt(4)
    v_mfma_f32_32x32x16_bf16 v[64:79], a[40:43], v[136:139], v[64:79]
    ds_read_b128 a[0:3], v14 offset:12288
    ds_read_b128 a[4:7], v14 offset:14336
    v_mfma_f32_32x32x16_bf16 v[80:95], a[44:47], v[136:139], v[80:95]
    ds_read_b128 a[8:11], v14 offset:16384
    ds_read_b128 a[12:15], v14 offset:18432
    v_mfma_f32_32x32x16_bf16 v[96:111], a[48:51], v[136:139], v[96:111]
    s_add_u32 s64, s64, s65
    s_add_u32 s64, s64, 1280
    v_mfma_f32_32x32x16_bf16 v[112:127], a[52:55], v[136:139], v[112:127]
    ds_read_b128 a[16:19], v14 offset:20480
    ds_read_b128 a[20:23], v14 offset:12800
    v_mfma_f32_32x32x16_bf16 v[192:207], a[56:59], v[136:139], v[192:207]
    v_mov_b32 v46, 0x40000000
    v_mfma_f32_32x32x16_bf16 v[64:79], a[60:63], v[140:143], v[64:79]
    ds_read_b128 a[24:27], v14 offset:14848
    ds_read_b128 a[28:31], v14 offset:16896
    v_mfma_f32_32x32x16_bf16 v[80:95], a[64:67], v[140:143], v[80:95]
    v_writelane_b32 v46, s64, 0
    v_mfma_f32_32x32x16_bf16 v[96:111], a[68:71], v[140:143], v[96:111]
    ds_read_b128 a[32:35], v14 offset:18944
    ds_read_b128 a[36:39], v14 offset:20992
    v_mfma_f32_32x32x16_bf16 v[112:127], a[72:75], v[140:143], v[112:127]
    v_mov_b32 v47, 1
    v_mfma_f32_32x32x16_bf16 v[192:207], a[76:79], v[140:143], v[192:207]
    s_waitcnt lgkmcnt(0)
    s_waitcnt vmcnt(2)
    v_mfma_f32_32x32x16_bf16 v[64:79], a[0:3], v[144:147], v[64:79]
    ds_read_b128 a[40:43], v14 offset:22528
    ds_read_b128 a[44:47], v14 offset:24576
    v_mfma_f32_32x32x16_bf16 v[80:95], a[4:7], v[144:147], v[80:95]
    ds_read_b128 a[48:51], v14 offset:26624
    ds_read_b128 a[52:55], v14 offset:28672
    v_mfma_f32_32x32x16_bf16 v[96:111], a[8:11], v[144:147], v[96:111]
    v_mfma_f32_32x32x16_bf16 v[112:127], a[12:15], v[144:147], v[112:127]
    ds_read_b128 a[56:59], v14 offset:30720
    ds_read_b128 a[60:63], v14 offset:23040
    v_mfma_f32_32x32x16_bf16 v[192:207], a[16:19], v[144:147], v[192:207]
    v_mfma_f32_32x32x16_bf16 v[64:79], a[20:23], v[148:151], v[64:79]
    ds_read_b128 a[64:67], v14 offset:25088
    ds_read_b128 a[68:71], v14 offset:27136
    v_mfma_f32_32x32x16_bf16 v[80:95], a[24:27], v[148:151], v[80:95]
    v_mfma_f32_32x32x16_bf16 v[96:111], a[28:31], v[148:151], v[96:111]
    ds_read_b128 a[72:75], v14 offset:29184
    ds_read_b128 a[76:79], v14 offset:31232
    v_mfma_f32_32x32x16_bf16 v[112:127], a[32:35], v[148:151], v[112:127]
    v_mfma_f32_32x32x16_bf16 v[192:207], a[36:39], v[148:151], v[192:207]
    s_waitcnt lgkmcnt(0)
    s_waitcnt vmcnt(0)
    v_mfma_f32_32x32x16_bf16 v[64:79], a[40:43], v[152:155], v[64:79]
    v_mfma_f32_32x32x16_bf16 v[80:95], a[44:47], v[152:155], v[80:95]
    v_mfma_f32_32x32x16_bf16 v[64:79], a[60:63], v[156:159], v[64:79]
    v_mfma_f32_32x32x16_bf16 v[80:95], a[64:67], v[156:159], v[80:95]
    v_mfma_f32_32x32x16_bf16 v[96:111], a[48:51], v[152:155], v[96:111]
    v_mfma_f32_32x32x16_bf16 v[112:127], a[52:55], v[152:155], v[112:127]
    s_mov_b32 s65, 0
    s_nop 7
    v_cvt_pk_bf16_f32 v208, v64, v65
    v_cvt_pk_bf16_f32 v209, v66, v67
    v_cvt_pk_bf16_f32 v210, v68, v69
    v_cvt_pk_bf16_f32 v211, v70, v71
    buffer_store_dwordx4 v[208:211], v8, s[12:15], s65 offen offset:0 sc1
    v_cvt_pk_bf16_f32 v212, v72, v73
    v_cvt_pk_bf16_f32 v213, v74, v75
    v_cvt_pk_bf16_f32 v214, v76, v77
    v_cvt_pk_bf16_f32 v215, v78, v79
    buffer_store_dwordx4 v[212:215], v8, s[12:15], s65 offen offset:1024 sc1
    v_mfma_f32_32x32x16_bf16 v[96:111], a[68:71], v[156:159], v[96:111]
    v_mfma_f32_32x32x16_bf16 v[112:127], a[72:75], v[156:159], v[112:127]
    v_cvt_pk_bf16_f32 v216, v80, v81
    v_cvt_pk_bf16_f32 v217, v82, v83
    v_cvt_pk_bf16_f32 v218, v84, v85
    v_cvt_pk_bf16_f32 v219, v86, v87
    buffer_store_dwordx4 v[216:219], v8, s[12:15], s65 offen offset:2048 sc1
    v_cvt_pk_bf16_f32 v220, v88, v89
    v_cvt_pk_bf16_f32 v221, v90, v91
    v_cvt_pk_bf16_f32 v222, v92, v93
    v_cvt_pk_bf16_f32 v223, v94, v95
    buffer_store_dwordx4 v[220:223], v8, s[12:15], s65 offen offset:3072 sc1
    v_mfma_f32_32x32x16_bf16 v[192:207], a[56:59], v[152:155], v[192:207]
    v_mfma_f32_32x32x16_bf16 v[192:207], a[76:79], v[156:159], v[192:207]
    s_mov_b32 s65, 4096
    v_cvt_pk_bf16_f32 v224, v96, v97
    v_cvt_pk_bf16_f32 v225, v98, v99
    v_cvt_pk_bf16_f32 v226, v100, v101
    v_cvt_pk_bf16_f32 v227, v102, v103
    buffer_store_dwordx4 v[224:227], v8, s[12:15], s65 offen offset:0 sc1
    v_cvt_pk_bf16_f32 v228, v104, v105
    v_cvt_pk_bf16_f32 v229, v106, v107
    v_cvt_pk_bf16_f32 v230, v108, v109
    v_cvt_pk_bf16_f32 v231, v110, v111
    buffer_store_dwordx4 v[228:231], v8, s[12:15], s65 offen offset:1024 sc1
    v_cvt_pk_bf16_f32 v232, v112, v113
    v_cvt_pk_bf16_f32 v233, v114, v115
    v_cvt_pk_bf16_f32 v234, v116, v117
    v_cvt_pk_bf16_f32 v235, v118, v119
    buffer_store_dwordx4 v[232:235], v8, s[12:15], s65 offen offset:2048 sc1
    v_cvt_pk_bf16_f32 v236, v120, v121
    v_cvt_pk_bf16_f32 v237, v122, v123
    v_cvt_pk_bf16_f32 v238, v124, v125
    v_cvt_pk_bf16_f32 v239, v126, v127
    buffer_store_dwordx4 v[236:239], v8, s[12:15], s65 offen offset:3072 sc1
    s_mov_b32 s65, 8192
    v_cvt_pk_bf16_f32 v240, v192, v193
    v_cvt_pk_bf16_f32 v241, v194, v195
    v_cvt_pk_bf16_f32 v242, v196, v197
    v_cvt_pk_bf16_f32 v243, v198, v199
    buffer_store_dwordx4 v[240:243], v8, s[12:15], s65 offen offset:0 sc1
    v_cvt_pk_bf16_f32 v244, v200, v201
    v_cvt_pk_bf16_f32 v245, v202, v203
    v_cvt_pk_bf16_f32 v246, v204, v205
    v_cvt_pk_bf16_f32 v247, v206, v207
    buffer_store_dwordx4 v[244:247], v8, s[12:15], s65 offen offset:1024 sc1
    s_waitcnt vmcnt(0)
    buffer_atomic_add v47, v46, s[60:63], 0 offen
    s_endpgm
L_att:
    s_mov_b32 s48, s18
    s_mov_b32 s49, s19
    s_mov_b32 s50, 2457600
    s_mov_b32 s51, 0x00020000
    s_mul_i32 s41, s10, 160
    s_mul_i32 s42, s38, 61440
    s_add_u32 s41, s41, s42
    s_mul_i32 s3, s38, 5120
    s_mul_i32 s74, s38, 3072
    v_add_u32 v32, 0, v1
    v_mul_u32_u24 v33, 3277, v32
    v_lshrrev_b32 v33, 16, v33
    v_mul_u32_u24 v34, 20, v33
    v_sub_u32 v34, v32, v34
    v_cmp_gt_u32 vcc, 10, v34
    v_lshlrev_b32 v34, 4, v34
    v_mul_u32_u24 v33, 3840, v33
    v_add_u32 v35, 1280, v34
    v_add_u32 v36, 2400, v34
    v_cndmask_b32 v34, v36, v35, vcc
    v_add_u32 v33, v33, v34
    v_add_u32 v33, s41, v33
    v_subrev_u32 v16, 0, v33
    v_add_u32 v32, 64, v1
    v_mul_u32_u24 v33, 3277, v32
    v_lshrrev_b32 v33, 16, v33
    v_mul_u32_u24 v34, 20, v33
    v_sub_u32 v34, v32, v34
    v_cmp_gt_u32 vcc, 10, v34
    v_lshlrev_b32 v34, 4, v34
    v_mul_u32_u24 v33, 3840, v33
    v_add_u32 v35, 1280, v34
    v_add_u32 v36, 2400, v34
    v_cndmask_b32 v34, v36, v35, vcc
    v_add_u32 v33, v33, v34
    v_add_u32 v33, s41, v33
    v_subrev_u32 v17, 1024, v33
    v_add_u32 v32, 128, v1
    v_mul_u32_u24 v33, 3277, v32
    v_lshrrev_b32 v33, 16, v33
    v_mul_u32_u24 v34, 20, v33
    v_sub_u32 v34, v32, v34
    v_cmp_gt_u32 vcc, 10, v34
    v_lshlrev_b32 v34, 4, v34
    v_mul_u32_u24 v33, 3840, v33
    v_add_u32 v35, 1280, v34
    v_add_u32 v36, 2400, v34
    v_cndmask_b32 v34, v36, v35, vcc
    v_add_u32 v33, v33, v34
    v_add_u32 v33, s41, v33
    v_subrev_u32 v18, 2048, v33
    v_add_u32 v32, 192, v1
    v_mul_u32_u24 v33, 3277, v32
    v_lshrrev_b32 v33, 16, v33
    v_mul_u32_u24 v34, 20, v33
    v_sub_u32 v34, v32, v34
    v_cmp_gt_u32 vcc, 10, v34
    v_lshlrev_b32 v34, 4, v34
    v_mul_u32_u24 v33, 3840, v33
    v_add_u32 v35, 1280, v34
    v_add_u32 v36, 2400, v34
    v_cndmask_b32 v34, v36, v35, vcc
    v_add_u32 v33, v33, v34
    v_add_u32 v33, s41, v33
    v_subrev_u32 v19, 3072, v33
    v_add_u32 v32, 256, v1
    v_mul_u32_u24 v33, 3277, v32
    v_lshrrev_b32 v33, 16, v33
    v_mul_u32_u24 v34, 20, v33
    v_sub_u32 v34, v32, v34
    v_cmp_gt_u32 vcc, 10, v34
    v_lshlrev_b32 v34, 4, v34
    v_mul_u32_u24 v33, 3840, v33
    v_add_u32 v35, 1280, v34
    v_add_u32 v36, 2400, v34
    v_cndmask_b32 v34, v36, v35, vcc
    v_add_u32 v33, v33, v34
    v_add_u32 v33, s41, v33
    v_subrev_u32 v20, 0, v33
    v_add_u32 v32, 0, v1
    v_mul_u32_u24 v33, 5462, v32
    v_lshrrev_b32 v33, 16, v33
    v_mul_u32_u24 v34, 12, v33
    v_sub_u32 v34, v32, v34
    v_mul_u32_u24 v33, 3840, v33
    v_lshl_add_u32 v33, v34, 4, v33
    v_add_u32 v33, s41, v33
    v_subrev_u32 v21, 0, v33
    v_add_u32 v32, 64, v1
    v_mul_u32_u24 v33, 5462, v32
    v_lshrrev_b32 v33, 16, v33
    v_mul_u32_u24 v34, 12, v33
    v_sub_u32 v34, v32, v34
    v_mul_u32_u24 v33, 3840, v33
    v_lshl_add_u32 v33, v34, 4, v33
    v_add_u32 v33, s41, v33
    v_subrev_u32 v22, 1024, v33
    v_add_u32 v32, 128, v1
    v_mul_u32_u24 v33, 5462, v32
    v_lshrrev_b32 v33, 16, v33
    v_mul_u32_u24 v34, 12, v33
    v_sub_u32 v34, v32, v34
    v_mul_u32_u24 v33, 3840, v33
    v_lshl_add_u32 v33, v34, 4, v33
    v_add_u32 v33, s41, v33
    v_subrev_u32 v23, 2048, v33
    s_mul_i32 s9, s76, 1920
    s_add_u32 m0, s3, 0
    s_nop 0
    buffer_load_dwordx4 v16, s[48:51], s9 offen offset:0 lds
    buffer_load_dwordx4 v17, s[48:51], s9 offen offset:1024 lds
    buffer_load_dwordx4 v18, s[48:51], s9 offen offset:2048 lds
    buffer_load_dwordx4 v19, s[48:51], s9 offen offset:3072 lds
    s_add_u32 s78, s77, 128
    s_cmp_eq_u32 s78, 1280
    s_cselect_b32 s78, 0, s78
    s_add_u32 s79, s78, 128
    s_cmp_eq_u32 s79, 1280
    s_cselect_b32 s79, 0, s79
    s_add_u32 s80, s79, 128
    s_cmp_eq_u32 s80, 1280
    s_cselect_b32 s80, 0, s80
    s_add_u32 s81, s80, 128
    s_cmp_eq_u32 s81, 1280
    s_cselect_b32 s81, 0, s81
    s_add_u32 s82, s81, 128
    s_cmp_eq_u32 s82, 1280
    s_cselect_b32 s82, 0, s82
    s_add_u32 s83, s82, 128
    s_cmp_eq_u32 s83, 1280
    s_cselect_b32 s83, 0, s83
    s_add_u32 s84, s83, 128
    s_cmp_eq_u32 s84, 1280
    s_cselect_b32 s84, 0, s84
    s_add_u32 s85, s84, 128
    s_cmp_eq_u32 s85, 1280
    s_cselect_b32 s85, 0, s85
    v_lshrrev_b32 v32, 1, v2
    v_and_b32 v32, 7, v32
    v_xor_b32 v32, v3, v32
    v_lshlrev_b32 v33, 7, v2
    v_add_u32 v33, s43, v33
    v_add_u32 v33, 0x10000, v33
    v_xor_b32 v34, 0, v32
    v_lshl_add_u32 v12, v34, 4, v33
    v_xor_b32 v34, 2, v32
    v_lshl_add_u32 v13, v34, 4, v33
    v_xor_b32 v34, 4, v32
    v_lshl_add_u32 v14, v34, 4, v33
    v_xor_b32 v34, 6, v32
    v_lshl_add_u32 v15, v34, 4, v33
    s_mov_b32 s11, 0xffff0000
    v_bfe_u32 v32, v1, 2, 2
    v_lshl_add_u32 v32, v3, 3, v32
    v_bfe_u32 v33, v1, 4, 1
    v_lshlrev_b32 v33, 5, v33
    v_and_b32 v34, 3, v1
    v_lshl_add_u32 v33, v34, 3, v33
    v_mul_u32_u24 v34, 320, v32
    v_add_u32 v24, v34, v33
    v_add_u32 v25, 0x10000, v24
    v_mul_u32_u24 v34, 192, v32
    v_add_u32 v26, v34, v33
    v_add_u32 v27, 0x10000, v26
    v_add_u32 v28, 0x20000, v26
    s_mov_b32 s15, 0x00020000
    s_cmp_eq_u32 s39, 0
    s_cbranch_scc1 L_zf_7
L_zf_7_ret:
    s_add_u32 m0, s3, 4096
    s_nop 0
    buffer_load_dwordx4 v20, s[48:51], s9 offen offset:0 lds
    s_mul_i32 s8, s76, 1920
    s_add_u32 m0, s74, 81920
    s_nop 0
    buffer_load_dwordx4 v21, s[48:51], s8 offen offset:0 lds
    buffer_load_dwordx4 v22, s[48:51], s8 offen offset:1024 lds
    buffer_load_dwordx4 v23, s[48:51], s8 offen offset:2048 lds
    s_lshl_b32 s41, s10, 2
    s_add_u32 s41, s41, s38
    s_mul_i32 s41, s41, 800
    s_add_u32 s92, s20, s41
    s_addc_u32 s93, s21, 0
    s_mov_b32 s94, 800
    s_mov_b32 s95, 0x00020000
    v_lshlrev_b32 v32, 1, v2
    v_subrev_u32 v33, 4, v32
    v_cmp_gt_u32 vcc, 18, v2
    s_nop 1
    v_cndmask_b32 v33, v33, v32, vcc
    v_and_b32 v34, 30, v2
    v_cmp_eq_u32 s[66:67], 20, v34
    s_nop 1
    s_or_b64 vcc, vcc, s[66:67]
    v_mov_b32 v35, 0x40000000
    v_cndmask_b32 v33, v35, v33, vcc
    s_lshl_b32 s41, s38, 2
    v_lshlrev_b32 v36, 2, v3
    v_add_u32 v36, 0, v36
    v_subrev_u32 v36, s41, v36
    v_cmp_gt_u32 vcc, 20, v36
    v_mul_u32_u24 v37, 40, v36
    v_add_u32 v37, v37, v33
    v_cndmask_b32 v108, v35, v37, vcc
    v_lshlrev_b32 v36, 2, v3
    v_add_u32 v36, 8, v36
    v_subrev_u32 v36, s41, v36
    v_cmp_gt_u32 vcc, 20, v36
    v_mul_u32_u24 v37, 40, v36
    v_add_u32 v37, v37, v33
    v_cndmask_b32 v109, v35, v37, vcc
    v_lshlrev_b32 v36, 2, v3
    v_add_u32 v36, 16, v36
    v_subrev_u32 v36, s41, v36
    v_cmp_gt_u32 vcc, 20, v36
    v_mul_u32_u24 v37, 40, v36
    v_add_u32 v37, v37, v33
    v_cndmask_b32 v110, v35, v37, vcc
    v_lshlrev_b32 v36, 2, v3
    v_add_u32 v36, 24, v36
    v_subrev_u32 v36, s41, v36
    v_cmp_gt_u32 vcc, 20, v36
    v_mul_u32_u24 v37, 40, v36
    v_add_u32 v37, v37, v33
    v_cndmask_b32 v111, v35, v37, vcc
    v_lshrrev_b32 v32, 4, v2
    v_mul_u32_u24 v32, 75776, v32
    v_and_b32 v33, 15, v2
    v_lshl_add_u32 v33, v3, 4, v33
    v_lshl_add_u32 v6, v33, 4, v32
    s_lshl_b32 s41, s39, 2
    s_add_u32 s41, s41, s38
    s_mul_i32 s41, s41, 151552
    s_add_u32 s56, s36, s41
    s_addc_u32 s57, s37, 0
    s_mov_b32 s58, 151552
    s_mov_b32 s59, 0x00020000
    s_add_u32 s60, s36, 25165824
    s_addc_u32 s61, s37, 0
    s_mov_b32 s62, 282624
    s_mov_b32 s63, 0x00020000
    s_and_b32 s86, s39, 11
    s_and_b32 s41, s40, 4
    s_add_u32 s86, s86, s41
    s_lshr_b32 s87, s40, 3
    s_lshl_b32 s87, s87, 2
    s_and_b32 s41, s40, 1
    s_lshl_b32 s41, s41, 1
    s_add_u32 s87, s87, s41
    s_bfe_u32 s41, s39, 0x10002
    s_add_u32 s87, s87, s41
    s_mul_i32 s41, s10, 20480
    s_add_u32 s41, s41, 25284608
    s_add_u32 s24, s36, s41
    s_addc_u32 s25, s37, 0
    s_mov_b32 s26, 20480
    s_mov_b32 s27, 0x00020000
    s_lshl_b32 s64, s39, 3
    s_add_u32 s64, s64, s10
    s_lshl_b32 s64, s64, 2
    s_add_u32 s64, s64, s38
    s_lshr_b32 s89, s64, 3
    s_and_b32 s65, s64, 7
    s_lshr_b32 s66, s89, 2
    s_mul_i32 s66, s66, 6
    s_and_b32 s67, s89, 3
    s_add_u32 s66, s66, s67
    s_sub_u32 s67, s89, 32
    s_lshr_b32 s67, s67, 1
    s_mul_i32 s67, s67, 6
    s_and_b32 s68, s89, 1
    s_add_u32 s67, s67, s68
    s_add_u32 s67, s67, 4
    s_cmp_lt_u32 s89, 32
    s_cselect_b32 s66, s66, s67
    s_cmp_lt_u32 s89, 48
    s_cselect_b32 s66, s66, s89
    s_mul_i32 s66, s66, 40960
    s_mul_i32 s67, s65, 160
    s_add_u32 s66, s66, s67
    s_add_u32 s4, s30, s66
    s_addc_u32 s5, s31, 0
    s_mov_b32 s7, 0x00020000
    s_cmp_lt_u32 s89, 54
    s_cselect_b32 s6, 39840, 0
    v_add_u32 v32, 0, v1
    v_mul_u32_u24 v33, 6554, v32
    v_lshrrev_b32 v33, 16, v33
    v_mul_u32_u24 v34, 10, v33
    v_sub_u32 v34, v32, v34
    v_mul_u32_u24 v33, 1280, v33
    v_lshl_add_u32 v33, v34, 4, v33
    v_subrev_u32 v208, 0, v33
    v_add_u32 v32, 64, v1
    v_mul_u32_u24 v33, 6554, v32
    v_lshrrev_b32 v33, 16, v33
    v_mul_u32_u24 v34, 10, v33
    v_sub_u32 v34, v32, v34
    v_mul_u32_u24 v33, 1280, v33
    v_lshl_add_u32 v33, v34, 4, v33
    v_subrev_u32 v209, 1024, v33
    v_add_u32 v32, 128, v1
    v_mul_u32_u24 v33, 6554, v32
    v_lshrrev_b32 v33, 16, v33
    v_mul_u32_u24 v34, 10, v33
    v_sub_u32 v34, v32, v34
    v_mul_u32_u24 v33, 1280, v33
    v_lshl_add_u32 v33, v34, 4, v33
    v_subrev_u32 v210, 2048, v33
    v_add_u32 v32, 192, v1
    v_mul_u32_u24 v33, 6554, v32
    v_lshrrev_b32 v33, 16, v33
    v_mul_u32_u24 v34, 10, v33
    v_sub_u32 v34, v32, v34
    v_mul_u32_u24 v33, 1280, v33
    v_lshl_add_u32 v33, v34, 4, v33
    v_subrev_u32 v211, 3072, v33
    v_add_u32 v32, 256, v1
    v_mul_u32_u24 v33, 6554, v32
    v_lshrrev_b32 v33, 16, v33
    v_mul_u32_u24 v34, 10, v33
    v_sub_u32 v34, v32, v34
    v_mul_u32_u24 v33, 1280, v33
    v_lshl_add_u32 v33, v34, 4, v33
    v_subrev_u32 v212, 0, v33
    s_mul_i32 s65, s65, 74
    s_add_u32 s65, s65, s89
    s_mul_i32 s65, s65, 5120
    s_add_u32 s65, s65, 10485760
    s_add_u32 s90, s36, s65
    s_addc_u32 s91, s37, 0
    s_lshl_b32 s41, s38, 6
    v_add_u32 v106, s41, v24
    s_add_u32 s42, s41, 81856
    s_mov_b32 s75, 3072
    s_movk_i32 s64, 768
    s_cmp_eq_u32 s38, 0
    s_cselect_b64 vcc, -1, 0
    s_cselect_b32 s75, 5120, s75
    s_cselect_b32 s64, 1280, s64
    v_add_u32 v32, 256, v24
    v_add_u32 v33, s42, v26
    v_cndmask_b32 v107, v33, v32, vcc
    v_add_u32 v36, s64, v107
    v_mov_b32 v32, 0x3f803f80
    v_mov_b32 v33, 0x3f803f80
    v_mov_b32 v34, 0x3f803f80
    v_mov_b32 v35, 0x3f803f80
    s_lshl_b32 s64, s39, 2
    s_add_u32 s64, s64, s38
    s_lshl_b32 s64, s64, 8
    s_add_u32 s64, s64, 69632
    s_lshr_b32 s65, 0x0aff, s40
    s_and_b32 s65, s65, 1
    s_cmp_eq_u32 s65, 1
    s_cselect_b32 s64, s64, 0x40000000
    v_lshlrev_b32 v213, 3, v2
    v_lshl_add_u32 v213, v3, 2, v213
    v_add_u32 v213, s64, v213
    s_lshl_b32 s64, s40, 11
    s_add_u32 s64, s64, 86016
    s_lshl_b32 s65, s38, 8
    s_add_u32 s64, s64, s65
    s_cmp_lt_u32 s39, 10
    s_cselect_b32 s64, s64, 0x40000000
    v_lshlrev_b32 v214, 2, v1
    v_add_u32 v214, s64, v214
    s_lshl_b32 s69, s39, 12
    s_lshr_b32 s68, 0x0aff, s40
    s_and_b32 s68, s68, 1
    s_cmp_eq_u32 s68, 1
    s_cselect_b32 s69, s69, 0x40000000
    s_lshl_b32 s68, s40, 8
    s_add_u32 s68, s68, 65536
    s_cmp_lt_u32 s39, 10
    s_cselect_b32 s68, s68, 0x40000000
    s_cmp_eq_u32 s38, 0
    s_cselect_b32 s69, s69, 0x40000000
    s_cselect_b32 s68, s68, 0x40000000
    v_mov_b32 v215, 0x40000000
    v_writelane_b32 v215, s69, 0
    v_writelane_b32 v215, s68, 1
    s_cmp_lt_u32 s89, 54
    s_cselect_b32 s64, 0, 0x40000000
    s_or_b32 s64, s64, s73
    s_mov_b32 s65, s10
    s_lshl_b32 s65, s65, 7
    s_add_u32 s64, s64, s65
    v_lshlrev_b32 v29, 12, v1
    v_add_u32 v29, 2304, v29
    v_cmp_gt_u32 vcc, 16, v1
    v_mov_b32 v30, 0x40000000
    s_nop 0
    v_cndmask_b32 v29, v30, v29, vcc
    v_add_u32 v29, s64, v29
    s_lshl_b32 s64, s39, 12
    s_lshl_b32 s65, s40, 8
    s_add_u32 s65, s65, 65536
    v_mov_b32 v218, s64
    v_writelane_b32 v218, s65, 1
    v_mov_b32 v219, 10
    v_and_b32 v220, 15, v1
    v_lshlrev_b32 v220, 2, v220
    v_mov_b32 v221, 1
    s_add_u32 s96, s34, 0
    s_addc_u32 s97, s35, 0
    s_mov_b32 s98, 64
    s_mov_b32 s99, 0x00020000
    s_mov_b32 s12, s90
    s_mov_b32 s13, s91
    s_cmp_lt_u32 s89, 54
    s_cselect_b32 s14, 5120, 0
    v_lshrrev_b32 v224, 5, v1
    v_lshlrev_b32 v224, 4, v224
    v_bfe_u32 v225, v1, 4, 1
    v_lshl_add_u32 v224, v225, 2, v224
    v_bfe_u32 v225, v1, 2, 2
    v_add_u32 v224, v224, v225
    v_mul_u32_u24 v224, 160, v224
    v_and_b32 v225, 3, v1
    v_lshl_add_u32 v224, v225, 3, v224
    v_add_u32 v224, s3, v224
    v_add_u32 v224, 139264, v224
    s_add_u32 m0, s43, 114688
    v_lshlrev_b32 v225, 4, v1
    buffer_load_dwordx4 v8, s[44:47], s77 offen offset:0 lds
    buffer_load_dwordx4 v9, s[44:47], s77 offen offset:1024 lds
    buffer_load_dwordx4 v10, s[44:47], s77 offen offset:2048 lds
    buffer_load_dwordx4 v11, s[44:47], s77 offen offset:3072 lds
    s_mul_i32 s9, s77, 1920
    s_add_u32 m0, s3, 20480
    s_nop 0
    buffer_load_dwordx4 v16, s[48:51], s9 offen offset:0 lds
    buffer_load_dwordx4 v17, s[48:51], s9 offen offset:1024 lds
    buffer_load_dwordx4 v18, s[48:51], s9 offen offset:2048 lds
    buffer_load_dwordx4 v19, s[48:51], s9 offen offset:3072 lds
    s_add_u32 m0, s3, 24576
    s_nop 0
    buffer_load_dwordx4 v20, s[48:51], s9 offen offset:0 lds
    s_add_u32 m0, s3, 139264
    s_nop 0
    buffer_load_dwordx4 v208, s[4:7], 0 offen offset:0 lds
    buffer_load_dwordx4 v209, s[4:7], 0 offen offset:1024 lds
    buffer_load_dwordx4 v210, s[4:7], 0 offen offset:2048 lds
    buffer_load_dwordx4 v211, s[4:7], 0 offen offset:3072 lds
    s_add_u32 m0, s3, 143360
    s_nop 0
    buffer_load_dwordx4 v212, s[4:7], 0 offen offset:0 lds
    s_waitcnt vmcnt(14)
    s_barrier
    ds_read_b128 a[0:3], v12 offset:32768
    ds_read_b64_tr_b16 a[160:161], v24 offset:0
    ds_read_b64_tr_b16 a[162:163], v24 offset:1280
    ds_read_b64_tr_b16 a[164:165], v24 offset:64
    ds_read_b64_tr_b16 a[166:167], v24 offset:1344
    ds_read_b64_tr_b16 a[168:169], v24 offset:128
    ds_read_b64_tr_b16 a[170:171], v24 offset:1408
    ds_read_b64_tr_b16 a[172:173], v24 offset:192
    ds_read_b64_tr_b16 a[174:175], v24 offset:1472
    ds_read_b64_tr_b16 a[176:177], v24 offset:256
    ds_read_b64_tr_b16 a[178:179], v24 offset:1536
    s_waitcnt lgkmcnt(6)
    v_mfma_f32_32x32x16_bf16 v[128:143], a[160:163], a[0:3], 0
    ds_read_b128 a[4:7], v13 offset:32768
    ds_read_b128 v[40:43], v12 offset:32768
    ds_read_b64_tr_b16 a[180:181], v24 offset:5120
    ds_read_b64_tr_b16 a[182:183], v24 offset:6400
    s_mul_i32 s9, s78, 1920
    s_add_u32 m0, s3, 40960
    s_nop 0
    buffer_load_dwordx4 v16, s[48:51], s9 offen offset:0 lds
    v_mfma_f32_32x32x16_bf16 v[144:159], a[164:167], a[0:3], 0
    ds_read_b128 a[8:11], v14 offset:32768
    ds_read_b128 v[44:47], v13 offset:32768
    ds_read_b64_tr_b16 a[184:185], v24 offset:5184
    ds_read_b64_tr_b16 a[186:187], v24 offset:6464
    buffer_load_dwordx4 v17, s[48:51], s9 offen offset:1024 lds
    s_waitcnt lgkmcnt(8)
    v_mfma_f32_32x32x16_bf16 v[160:175], a[168:171], a[0:3], 0
    ds_read_b128 a[12:15], v15 offset:32768
    ds_read_b128 v[48:51], v14 offset:32768
    ds_read_b64_tr_b16 a[188:189], v24 offset:5248
    ds_read_b64_tr_b16 a[190:191], v24 offset:6528
    buffer_load_dwordx4 v18, s[48:51], s9 offen offset:2048 lds
    v_mfma_f32_32x32x16_bf16 v[176:191], a[172:175], a[0:3], 0
    ds_read_b128 v[52:55], v15 offset:32768
    ds_read_b64_tr_b16 a[192:193], v24 offset:5312
    ds_read_b64_tr_b16 a[194:195], v24 offset:6592
    buffer_load_dwordx4 v19, s[48:51], s9 offen offset:3072 lds
    v_mfma_f32_32x32x16_bf16 v[192:207], a[176:179], a[0:3], 0
    s_waitcnt lgkmcnt(14)
    ds_read_b64_tr_b16 a[196:197], v24 offset:5376
    s_waitcnt lgkmcnt(14)
    ds_read_b64_tr_b16 a[198:199], v24 offset:6656
    buffer_load_dword v37, v220, s[96:99], s73 offen sc1
    s_waitcnt lgkmcnt(14)
    ds_read_b64_tr_b16 v[96:97], v106 offset:0
    s_waitcnt lgkmcnt(14)
    ds_read_b64_tr_b16 v[98:99], v106 offset:1280
    s_waitcnt lgkmcnt(14)
    ds_read_b64_tr_b16 v[100:101], v107
    s_add_u32 m0, s3, 45056
    s_waitcnt lgkmcnt(14)
    ds_read_b64_tr_b16 v[102:103], v36
    buffer_load_dwordx4 v20, s[48:51], s9 offen offset:0 lds
    s_waitcnt lgkmcnt(13)
    v_mfma_f32_32x32x16_bf16 v[128:143], a[180:183], a[4:7], v[128:143]
    ds_read_b64_tr_b16 a[160:161], v24 offset:10240
    ds_read_b64_tr_b16 a[162:163], v24 offset:11520
    v_add_u32 v107, s75, v107
    v_add_u32 v36, s75, v36
    s_add_u32 m0, s43, 98304
    s_waitcnt lgkmcnt(4)
    v_mfma_f32_32x32x16_bf16 v[64:79], v[32:35], v[96:99], 0
    buffer_load_dwordx4 v8, s[44:47], s78 offen offset:0 lds
    v_mfma_f32_32x32x16_bf16 v[144:159], a[184:187], a[4:7], v[144:159]
    ds_read_b64_tr_b16 a[164:165], v24 offset:10304
    ds_read_b64_tr_b16 a[166:167], v24 offset:11584
    s_waitcnt lgkmcnt(4)
    v_mfma_f32_32x32x16_bf16 v[80:95], v[32:35], v[100:103], 0
    ds_read_b64_tr_b16 v[96:97], v106 offset:5120
    ds_read_b64_tr_b16 v[98:99], v106 offset:6400
    ds_read_b64_tr_b16 v[100:101], v107
    ds_read_b64_tr_b16 v[102:103], v36
    buffer_load_dwordx4 v9, s[44:47], s78 offen offset:1024 lds
    v_mfma_f32_32x32x16_bf16 v[160:175], a[188:191], a[4:7], v[160:175]
    ds_read_b64_tr_b16 a[168:169], v24 offset:10368
    ds_read_b64_tr_b16 a[170:171], v24 offset:11648
    v_add_u32 v107, s75, v107
    v_add_u32 v36, s75, v36
    v_mov_b32 v60, 0
    v_mov_b32 v61, 0
    v_mov_b32 v62, 0
    buffer_load_dwordx4 v10, s[44:47], s78 offen offset:2048 lds
    v_mfma_f32_32x32x16_bf16 v[176:191], a[192:195], a[4:7], v[176:191]
    ds_read_b64_tr_b16 a[172:173], v24 offset:10432
    ds_read_b64_tr_b16 a[174:175], v24 offset:11712
    v_mov_b32 v63, 0
    v_lshlrev_b32 v56, 16, v40
    v_and_b32 v57, s11, v40
    s_waitcnt lgkmcnt(6)
    v_mfma_f32_32x32x16_bf16 v[64:79], v[32:35], v[96:99], v[64:79]
    s_waitcnt lgkmcnt(4)
    v_mfma_f32_32x32x16_bf16 v[80:95], v[32:35], v[100:103], v[80:95]
    buffer_load_dwordx4 v11, s[44:47], s78 offen offset:3072 lds
    v_mfma_f32_32x32x16_bf16 v[192:207], a[196:199], a[4:7], v[192:207]
    ds_read_b64_tr_b16 a[176:177], v24 offset:10496
    ds_read_b64_tr_b16 a[178:179], v24 offset:11776
    v_add_f32 v60, v60, v56
    v_add_f32 v61, v61, v57
    v_fmac_f32 v62, v56, v56
    v_fmac_f32 v63, v57, v57
    v_lshlrev_b32 v58, 16, v41
    ds_read_b64_tr_b16 v[96:97], v106 offset:10240
    ds_read_b64_tr_b16 v[98:99], v106 offset:11520
    ds_read_b64_tr_b16 v[100:101], v107
    ds_read_b64_tr_b16 v[102:103], v36
    v_mfma_f32_32x32x16_bf16 v[128:143], a[160:163], a[8:11], v[128:143]
    ds_read_b64_tr_b16 a[180:181], v24 offset:15360
    ds_read_b64_tr_b16 a[182:183], v24 offset:16640
    v_add_u32 v107, s75, v107
    v_add_u32 v36, s75, v36
    v_and_b32 v59, s11, v41
    v_add_f32 v60, v60, v58
    s_mul_i32 s9, s79, 1920
    s_add_u32 m0, s3, 61440
    s_nop 0
    buffer_load_dwordx4 v16, s[48:51], s9 offen offset:0 lds
    v_mfma_f32_32x32x16_bf16 v[144:159], a[164:167], a[8:11], v[144:159]
    ds_read_b64_tr_b16 a[184:185], v24 offset:15424
    ds_read_b64_tr_b16 a[186:187], v24 offset:16704
    v_add_f32 v61, v61, v59
    v_fmac_f32 v62, v58, v58
    v_fmac_f32 v63, v59, v59
    v_lshlrev_b32 v56, 16, v42
    v_and_b32 v57, s11, v42
    v_add_f32 v60, v60, v56
    buffer_load_dwordx4 v17, s[48:51], s9 offen offset:1024 lds
    s_waitcnt lgkmcnt(8)
    v_mfma_f32_32x32x16_bf16 v[160:175], a[168:171], a[8:11], v[160:175]
    ds_read_b64_tr_b16 a[188:189], v24 offset:15488
    ds_read_b64_tr_b16 a[190:191], v24 offset:16768
    v_add_f32 v61, v61, v57
    v_fmac_f32 v62, v56, v56
    v_fmac_f32 v63, v57, v57
    s_waitcnt lgkmcnt(8)
    v_mfma_f32_32x32x16_bf16 v[64:79], v[32:35], v[96:99], v[64:79]
    buffer_load_dwordx4 v18, s[48:51], s9 offen offset:2048 lds
    v_mfma_f32_32x32x16_bf16 v[176:191], a[172:175], a[8:11], v[176:191]
    ds_read_b64_tr_b16 a[192:193], v24 offset:15552
    ds_read_b64_tr_b16 a[194:195], v24 offset:16832
    s_waitcnt lgkmcnt(8)
    v_mfma_f32_32x32x16_bf16 v[80:95], v[32:35], v[100:103], v[80:95]
    v_lshlrev_b32 v58, 16, v43
    v_and_b32 v59, s11, v43
    v_add_f32 v60, v60, v58
    v_add_f32 v61, v61, v59
    buffer_load_dwordx4 v19, s[48:51], s9 offen offset:3072 lds
    v_mfma_f32_32x32x16_bf16 v[192:207], a[176:179], a[8:11], v[192:207]
    ds_read_b64_tr_b16 a[196:197], v24 offset:15616
    ds_read_b64_tr_b16 a[198:199], v24 offset:16896
    v_fmac_f32 v62, v58, v58
    v_fmac_f32 v63, v59, v59
    ds_read_b64_tr_b16 v[96:97], v106 offset:15360
    ds_read_b64_tr_b16 v[98:99], v106 offset:16640
    ds_read_b64_tr_b16 v[100:101], v107
    ds_read_b64_tr_b16 v[102:103], v36
    v_lshlrev_b32 v56, 16, v44
    s_add_u32 m0, s3, 65536
    v_and_b32 v57, s11, v44
    buffer_load_dwordx4 v20, s[48:51], s9 offen offset:0 lds
    s_waitcnt lgkmcnt(10)
    v_mfma_f32_32x32x16_bf16 v[128:143], a[180:183], a[12:15], v[128:143]
    v_add_f32 v60, v60, v56
    v_add_f32 v61, v61, v57
    v_fmac_f32 v62, v56, v56
    v_fmac_f32 v63, v57, v57
    v_lshlrev_b32 v58, 16, v45
    v_and_b32 v59, s11, v45
    v_add_f32 v60, v60, v58
    v_add_f32 v61, v61, v59
    v_fmac_f32 v62, v58, v58
    s_waitcnt lgkmcnt(2)
    v_mfma_f32_32x32x16_bf16 v[64:79], v[32:35], v[96:99], v[64:79]
    s_waitcnt lgkmcnt(0)
    v_mfma_f32_32x32x16_bf16 v[80:95], v[32:35], v[100:103], v[80:95]
    s_waitcnt vmcnt(10)
    v_cmp_le_u32 vcc, v221, v37
    s_nop 1
    s_cmp_eq_u64 vcc, -1
    s_cbranch_scc1 L_zd_8_ok
    s_cmp_lg_u32 s38, 0
    s_cbranch_scc1 L_zd_8_ok
    s_mov_b32 s69, 0
L_zd_8_spin:
    buffer_load_dword v37, v220, s[96:99], 0 offen sc1
    s_waitcnt vmcnt(0)
    v_cmp_le_u32 vcc, v221, v37
    s_nop 1
    s_cmp_eq_u64 vcc, -1
    s_cbranch_scc1 L_zd_8_ok
    s_sleep 2
    s_add_u32 s69, s69, 1
    s_cmp_lt_u32 s69, 0x4000
    s_cbranch_scc1 L_zd_8_spin
L_zd_8_ok:
    v_mfma_f32_32x32x16_bf16 v[144:159], a[184:187], a[12:15], v[144:159]
    s_barrier
    ds_read_b128 a[16:19], v12 offset:49152
    ds_read_b64_tr_b16 a[160:161], v24 offset:20480
    ds_read_b64_tr_b16 a[162:163], v24 offset:21760
    v_mfma_f32_32x32x16_bf16 v[160:175], a[188:191], a[12:15], v[160:175]
    ds_read_b64_tr_b16 a[164:165], v24 offset:20544
    ds_read_b64_tr_b16 a[166:167], v24 offset:21824
    ds_read_b64_tr_b16 a[168:169], v24 offset:20608
    v_fmac_f32 v63, v59, v59
    v_lshlrev_b32 v56, 16, v46
    v_and_b32 v57, s11, v46
    v_add_f32 v60, v60, v56
    v_add_f32 v61, v61, v57
    v_fmac_f32 v62, v56, v56
    v_mfma_f32_32x32x16_bf16 v[176:191], a[192:195], a[12:15], v[176:191]
    ds_read_b64_tr_b16 a[170:171], v24 offset:21888
    ds_read_b64_tr_b16 a[172:173], v24 offset:20672
    ds_read_b64_tr_b16 a[174:175], v24 offset:21952
    v_fmac_f32 v63, v57, v57
    v_lshlrev_b32 v58, 16, v47
    v_and_b32 v59, s11, v47
    v_add_f32 v60, v60, v58
    v_add_f32 v61, v61, v59
    v_fmac_f32 v62, v58, v58
    v_fmac_f32 v63, v59, v59
    v_mfma_f32_32x32x16_bf16 v[192:207], a[196:199], a[12:15], v[192:207]
    ds_read_b64_tr_b16 a[176:177], v24 offset:20736
    ds_read_b64_tr_b16 a[178:179], v24 offset:22016
    v_lshlrev_b32 v56, 16, v48
    v_and_b32 v57, s11, v48
    v_add_f32 v60, v60, v56
    v_add_f32 v61, v61, v57
    v_fmac_f32 v62, v56, v56
    v_fmac_f32 v63, v57, v57
    v_lshlrev_b32 v58, 16, v49
    v_and_b32 v59, s11, v49
    v_add_f32 v60, v60, v58
    s_waitcnt lgkmcnt(6)
    v_mfma_f32_32x32x16_bf16 v[128:143], a[160:163], a[16:19], v[128:143]
    ds_read_b128 a[20:23], v13 offset:49152
    ds_read_b64_tr_b16 a[180:181], v24 offset:25600
    ds_read_b64_tr_b16 a[182:183], v24 offset:26880
    v_add_f32 v61, v61, v59
    v_fmac_f32 v62, v58, v58
    s_mul_i32 s9, s80, 1920
    s_add_u32 m0, s3, 0
    s_nop 0
    buffer_load_dwordx4 v16, s[48:51], s9 offen offset:0 lds
    v_mfma_f32_32x32x16_bf16 v[144:159], a[164:167], a[16:19], v[144:159]
    ds_read_b128 a[24:27], v14 offset:49152
    ds_read_b64_tr_b16 a[184:185], v24 offset:25664
    ds_read_b64_tr_b16 a[186:187], v24 offset:26944
    v_fmac_f32 v63, v59, v59
    v_lshlrev_b32 v56, 16, v50
    v_and_b32 v57, s11, v50
    v_add_f32 v60, v60, v56
    buffer_load_dwordx4 v17, s[48:51], s9 offen offset:1024 lds
    s_waitcnt lgkmcnt(6)
    v_mfma_f32_32x32x16_bf16 v[160:175], a[168:171], a[16:19], v[160:175]
    ds_read_b128 a[28:31], v15 offset:49152
    ds_read_b64_tr_b16 a[188:189], v24 offset:25728
    ds_read_b64_tr_b16 a[190:191], v24 offset:27008
    v_add_f32 v61, v61, v57
    v_fmac_f32 v62, v56, v56
    v_fmac_f32 v63, v57, v57
    buffer_load_dwordx4 v18, s[48:51], s9 offen offset:2048 lds
    v_mfma_f32_32x32x16_bf16 v[176:191], a[172:175], a[16:19], v[176:191]
    ds_read_b64_tr_b16 a[192:193], v24 offset:25792
    ds_read_b64_tr_b16 a[194:195], v24 offset:27072
    v_lshlrev_b32 v58, 16, v51
    v_and_b32 v59, s11, v51
    v_add_f32 v60, v60, v58
    v_add_f32 v61, v61, v59
    v_fmac_f32 v62, v58, v58
    buffer_load_dwordx4 v19, s[48:51], s9 offen offset:3072 lds
    v_mfma_f32_32x32x16_bf16 v[192:207], a[176:179], a[16:19], v[192:207]
    ds_read_b64_tr_b16 a[196:197], v24 offset:25856
    ds_read_b64_tr_b16 a[198:199], v24 offset:27136
    v_fmac_f32 v63, v59, v59
    v_lshlrev_b32 v56, 16, v52
    v_permlane32_swap_b32 v64, v80
    v_mov_b32 v105, v64
    s_add_u32 m0, s3, 4096
    v_and_b32 v57, s11, v52
    buffer_load_dwordx4 v20, s[48:51], s9 offen offset:0 lds
    s_waitcnt lgkmcnt(7)
    v_mfma_f32_32x32x16_bf16 v[128:143], a[180:183], a[20:23], v[128:143]
    ds_read_b64_tr_b16 a[160:161], v24 offset:30720
    ds_read_b64_tr_b16 a[162:163], v24 offset:32000
    v_add_f32 v60, v60, v56
    v_add_f32 v61, v61, v57
    v_fmac_f32 v62, v56, v56
    s_add_u32 m0, s43, 114688
    v_fmac_f32 v63, v57, v57
    buffer_load_dwordx4 v8, s[44:47], s79 offen offset:0 lds
    v_mfma_f32_32x32x16_bf16 v[144:159], a[184:187], a[20:23], v[144:159]
    ds_read_b64_tr_b16 a[164:165], v24 offset:30784
    ds_read_b64_tr_b16 a[166:167], v24 offset:32064
    v_lshlrev_b32 v58, 16, v53
    v_and_b32 v59, s11, v53
    v_add_f32 v60, v60, v58
    v_add_f32 v61, v61, v59
    v_fmac_f32 v62, v58, v58
    buffer_load_dwordx4 v9, s[44:47], s79 offen offset:1024 lds
    s_waitcnt lgkmcnt(4)
    v_mfma_f32_32x32x16_bf16 v[160:175], a[188:191], a[20:23], v[160:175]
    ds_read_b64_tr_b16 a[168:169], v24 offset:30848
    ds_read_b64_tr_b16 a[170:171], v24 offset:32128
    v_fmac_f32 v63, v59, v59
    v_lshlrev_b32 v56, 16, v54
    v_and_b32 v57, s11, v54
    v_add_f32 v60, v60, v56
    buffer_load_dwordx4 v10, s[44:47], s79 offen offset:2048 lds
    v_mfma_f32_32x32x16_bf16 v[176:191], a[192:195], a[20:23], v[176:191]
    ds_read_b64_tr_b16 a[172:173], v24 offset:30912
    ds_read_b64_tr_b16 a[174:175], v24 offset:32192
    v_add_f32 v61, v61, v57
    v_fmac_f32 v62, v56, v56
    v_fmac_f32 v63, v57, v57
    v_lshlrev_b32 v58, 16, v55
    v_and_b32 v59, s11, v55
    buffer_load_dwordx4 v11, s[44:47], s79 offen offset:3072 lds
    v_mfma_f32_32x32x16_bf16 v[192:207], a[196:199], a[20:23], v[192:207]
    ds_read_b64_tr_b16 a[176:177], v24 offset:30976
    ds_read_b64_tr_b16 a[178:179], v24 offset:32256
    v_add_f32 v60, v60, v58
    v_add_f32 v61, v61, v59
    v_fmac_f32 v62, v58, v58
    v_fmac_f32 v63, v59, v59
    v_add_f32 v104, v60, v61
    v_add_f32 v62, v62, v63
    s_nop 1
    v_permlane32_swap_b32 v104, v62
    v_add_f32 v104, v104, v62
    s_waitcnt lgkmcnt(6)
    v_mfma_f32_32x32x16_bf16 v[128:143], a[160:163], a[24:27], v[128:143]
    ds_read_b64_tr_b16 a[180:181], v24 offset:35840
    ds_read_b64_tr_b16 a[182:183], v24 offset:37120
    v_mfma_f32_32x32x16_bf16 v[144:159], a[164:167], a[24:27], v[144:159]
    ds_read_b64_tr_b16 a[184:185], v24 offset:35904
    ds_read_b64_tr_b16 a[186:187], v24 offset:37184
    buffer_atomic_add_f32 v104, v213, s[60:63], 0 offen
    s_waitcnt lgkmcnt(4)
    v_mfma_f32_32x32x16_bf16 v[160:175], a[168:171], a[24:27], v[160:175]
    ds_read_b64_tr_b16 a[188:189], v24 offset:35968
    ds_read_b64_tr_b16 a[190:191], v24 offset:37248
    buffer_atomic_add_f32 v105, v214, s[60:63], 0 offen
    v_mfma_f32_32x32x16_bf16 v[176:191], a[172:175], a[24:27], v[176:191]
    ds_read_b64_tr_b16 a[192:193], v24 offset:36032
    ds_read_b64_tr_b16 a[194:195], v24 offset:37312
    buffer_load_ushort v112, v108, s[92:95], 0 offen offset:0
    buffer_load_ushort v113, v108, s[92:95], 0 offen offset:40
    buffer_load_ushort v114, v108, s[92:95], 0 offen offset:80
    buffer_load_ushort v115, v108, s[92:95], 0 offen offset:120
    v_mfma_f32_32x32x16_bf16 v[192:207], a[176:179], a[24:27], v[192:207]
    ds_read_b64_tr_b16 a[196:197], v24 offset:36096
    ds_read_b64_tr_b16 a[198:199], v24 offset:37376
    buffer_load_ushort v116, v109, s[92:95], 0 offen offset:0
    buffer_load_ushort v117, v109, s[92:95], 0 offen offset:40
    buffer_load_ushort v118, v109, s[92:95], 0 offen offset:80
    buffer_load_ushort v119, v109, s[92:95], 0 offen offset:120
    s_waitcnt lgkmcnt(6)
    v_mfma_f32_32x32x16_bf16 v[128:143], a[180:183], a[28:31], v[128:143]
    buffer_load_ushort v120, v110, s[92:95], 0 offen offset:0
    buffer_load_ushort v121, v110, s[92:95], 0 offen offset:40
    buffer_load_ushort v122, v110, s[92:95], 0 offen offset:80
    buffer_load_ushort v123, v110, s[92:95], 0 offen offset:120
    s_waitcnt vmcnt(28) lgkmcnt(0)
    v_mfma_f32_32x32x16_bf16 v[144:159], a[184:187], a[28:31], v[144:159]
    s_barrier
    ds_read_b128 a[32:35], v12 offset:32768
    ds_read_b64_tr_b16 a[160:161], v24 offset:40960
    ds_read_b64_tr_b16 a[162:163], v24 offset:42240
    buffer_load_ushort v124, v111, s[92:95], 0 offen offset:0
    buffer_load_ushort v125, v111, s[92:95], 0 offen offset:40
    buffer_load_ushort v126, v111, s[92:95], 0 offen offset:80
    buffer_load_ushort v127, v111, s[92:95], 0 offen offset:120
    v_mfma_f32_32x32x16_bf16 v[160:175], a[188:191], a[28:31], v[160:175]
    ds_read_b64_tr_b16 a[164:165], v24 offset:41024
    ds_read_b64_tr_b16 a[166:167], v24 offset:42304
    ds_read_b64_tr_b16 a[168:169], v24 offset:41088
    v_mfma_f32_32x32x16_bf16 v[176:191], a[192:195], a[28:31], v[176:191]
    ds_read_b64_tr_b16 a[170:171], v24 offset:42368
    ds_read_b64_tr_b16 a[172:173], v24 offset:41152
    ds_read_b64_tr_b16 a[174:175], v24 offset:42432
    v_mfma_f32_32x32x16_bf16 v[192:207], a[196:199], a[28:31], v[192:207]
    ds_read_b64_tr_b16 a[176:177], v24 offset:41216
    ds_read_b64_tr_b16 a[178:179], v24 offset:42496
    s_waitcnt lgkmcnt(6)
    v_mfma_f32_32x32x16_bf16 v[128:143], a[160:163], a[32:35], v[128:143]
    ds_read_b128 a[36:39], v13 offset:32768
    ds_read_b64_tr_b16 a[180:181], v24 offset:46080
    ds_read_b64_tr_b16 a[182:183], v24 offset:47360
    v_mfma_f32_32x32x16_bf16 v[144:159], a[164:167], a[32:35], v[144:159]
    ds_read_b128 a[40:43], v14 offset:32768
    ds_read_b64_tr_b16 a[184:185], v24 offset:46144
    ds_read_b64_tr_b16 a[186:187], v24 offset:47424
    s_mul_i32 s9, s81, 1920
    s_add_u32 m0, s3, 20480
    s_nop 0
    buffer_load_dwordx4 v16, s[48:51], s9 offen offset:0 lds
    s_waitcnt lgkmcnt(6)
    v_mfma_f32_32x32x16_bf16 v[160:175], a[168:171], a[32:35], v[160:175]
    ds_read_b128 a[44:47], v15 offset:32768
    ds_read_b64_tr_b16 a[188:189], v24 offset:46208
    ds_read_b64_tr_b16 a[190:191], v24 offset:47488
    v_mfma_f32_32x32x16_bf16 v[176:191], a[172:175], a[32:35], v[176:191]
    ds_read_b64_tr_b16 a[192:193], v24 offset:46272
    ds_read_b64_tr_b16 a[194:195], v24 offset:47552
    buffer_load_dwordx4 v17, s[48:51], s9 offen offset:1024 lds
    v_mfma_f32_32x32x16_bf16 v[192:207], a[176:179], a[32:35], v[192:207]
    ds_read_b64_tr_b16 a[196:197], v24 offset:46336
    ds_read_b64_tr_b16 a[198:199], v24 offset:47616
    s_waitcnt lgkmcnt(7)
    v_mfma_f32_32x32x16_bf16 v[128:143], a[180:183], a[36:39], v[128:143]
    ds_read_b64_tr_b16 a[160:161], v24 offset:51200
    s_add_u32 m0, s43, 98304
    ds_read_b64_tr_b16 a[162:163], v24 offset:52480
    buffer_load_dwordx4 v8, s[44:47], s80 offen offset:0 lds
    v_mfma_f32_32x32x16_bf16 v[144:159], a[184:187], a[36:39], v[144:159]
    ds_read_b64_tr_b16 a[164:165], v24 offset:51264
    ds_read_b64_tr_b16 a[166:167], v24 offset:52544
    buffer_load_dwordx4 v9, s[44:47], s80 offen offset:1024 lds
    s_waitcnt lgkmcnt(4)
    v_mfma_f32_32x32x16_bf16 v[160:175], a[188:191], a[36:39], v[160:175]
    ds_read_b64_tr_b16 a[168:169], v24 offset:51328
    ds_read_b64_tr_b16 a[170:171], v24 offset:52608
    buffer_load_dwordx4 v10, s[44:47], s80 offen offset:2048 lds
    v_mfma_f32_32x32x16_bf16 v[176:191], a[192:195], a[36:39], v[176:191]
    ds_read_b64_tr_b16 a[172:173], v24 offset:51392
    ds_read_b64_tr_b16 a[174:175], v24 offset:52672
    buffer_load_dwordx4 v11, s[44:47], s80 offen offset:3072 lds
    v_mfma_f32_32x32x16_bf16 v[192:207], a[196:199], a[36:39], v[192:207]
    ds_read_b64_tr_b16 a[176:177], v24 offset:51456
    ds_read_b64_tr_b16 a[178:179], v24 offset:52736
    s_waitcnt lgkmcnt(6)
    v_mfma_f32_32x32x16_bf16 v[128:143], a[160:163], a[40:43], v[128:143]
    ds_read_b64_tr_b16 a[180:181], v24 offset:56320
    s_add_u32 m0, s3, 20480
    ds_read_b64_tr_b16 a[182:183], v24 offset:57600
    buffer_load_dwordx4 v18, s[48:51], s9 offen offset:2048 lds
    v_mfma_f32_32x32x16_bf16 v[144:159], a[164:167], a[40:43], v[144:159]
    ds_read_b64_tr_b16 a[184:185], v24 offset:56384
    ds_read_b64_tr_b16 a[186:187], v24 offset:57664
    s_waitcnt lgkmcnt(4)
    v_mfma_f32_32x32x16_bf16 v[160:175], a[168:171], a[40:43], v[160:175]
    ds_read_b64_tr_b16 a[188:189], v24 offset:56448
    ds_read_b64_tr_b16 a[190:191], v24 offset:57728
    buffer_load_dwordx4 v19, s[48:51], s9 offen offset:3072 lds
    v_mfma_f32_32x32x16_bf16 v[176:191], a[172:175], a[40:43], v[176:191]
    ds_read_b64_tr_b16 a[192:193], v24 offset:56512
    ds_read_b64_tr_b16 a[194:195], v24 offset:57792
    v_mfma_f32_32x32x16_bf16 v[192:207], a[176:179], a[40:43], v[192:207]
    ds_read_b64_tr_b16 a[196:197], v24 offset:56576
    s_add_u32 m0, s3, 24576
    ds_read_b64_tr_b16 a[198:199], v24 offset:57856
    buffer_load_dwordx4 v20, s[48:51], s9 offen offset:0 lds
    s_waitcnt lgkmcnt(6)
    v_mfma_f32_32x32x16_bf16 v[128:143], a[180:183], a[44:47], v[128:143]
    s_waitcnt vmcnt(27) lgkmcnt(0)
    v_mfma_f32_32x32x16_bf16 v[144:159], a[184:187], a[44:47], v[144:159]
    s_barrier
    ds_read_b128 a[48:51], v12 offset:49152
    ds_read_b64_tr_b16 a[160:161], v24 offset:61440
    ds_read_b64_tr_b16 a[162:163], v24 offset:62720
    v_mfma_f32_32x32x16_bf16 v[160:175], a[188:191], a[44:47], v[160:175]
    ds_read_b64_tr_b16 a[164:165], v24 offset:61504
    ds_read_b64_tr_b16 a[166:167], v24 offset:62784
    ds_read_b64_tr_b16 a[168:169], v24 offset:61568
    v_mfma_f32_32x32x16_bf16 v[176:191], a[192:195], a[44:47], v[176:191]
    ds_read_b64_tr_b16 a[170:171], v24 offset:62848
    ds_read_b64_tr_b16 a[172:173], v24 offset:61632
    ds_read_b64_tr_b16 a[174:175], v24 offset:62912
    v_mfma_f32_32x32x16_bf16 v[192:207], a[196:199], a[44:47], v[192:207]
    ds_read_b64_tr_b16 a[176:177], v24 offset:61696
    ds_read_b64_tr_b16 a[178:179], v24 offset:62976
    s_waitcnt lgkmcnt(6)
    v_mfma_f32_32x32x16_bf16 v[128:143], a[160:163], a[48:51], v[128:143]
    ds_read_b128 a[52:55], v13 offset:49152
    ds_read_b64_tr_b16 a[180:181], v25 offset:1024
    ds_read_b64_tr_b16 a[182:183], v25 offset:2304
    v_mfma_f32_32x32x16_bf16 v[144:159], a[164:167], a[48:51], v[144:159]
    ds_read_b128 a[56:59], v14 offset:49152
    ds_read_b64_tr_b16 a[184:185], v25 offset:1088
    ds_read_b64_tr_b16 a[186:187], v25 offset:2368
    s_mul_i32 s9, s82, 1920
    s_add_u32 m0, s3, 40960
    s_nop 0
    buffer_load_dwordx4 v16, s[48:51], s9 offen offset:0 lds
    s_waitcnt lgkmcnt(6)
    v_mfma_f32_32x32x16_bf16 v[160:175], a[168:171], a[48:51], v[160:175]
    ds_read_b128 a[60:63], v15 offset:49152
    ds_read_b64_tr_b16 a[188:189], v25 offset:1152
    ds_read_b64_tr_b16 a[190:191], v25 offset:2432
    v_mfma_f32_32x32x16_bf16 v[176:191], a[172:175], a[48:51], v[176:191]
    ds_read_b64_tr_b16 a[192:193], v25 offset:1216
    ds_read_b64_tr_b16 a[194:195], v25 offset:2496
    buffer_load_dwordx4 v17, s[48:51], s9 offen offset:1024 lds
    v_mfma_f32_32x32x16_bf16 v[192:207], a[176:179], a[48:51], v[192:207]
    ds_read_b64_tr_b16 a[196:197], v25 offset:1280
    ds_read_b64_tr_b16 a[198:199], v25 offset:2560
    s_waitcnt lgkmcnt(7)
    v_mfma_f32_32x32x16_bf16 v[128:143], a[180:183], a[52:55], v[128:143]
    ds_read_b64_tr_b16 a[160:161], v25 offset:6144
    s_add_u32 m0, s43, 114688
    ds_read_b64_tr_b16 a[162:163], v25 offset:7424
    buffer_load_dwordx4 v8, s[44:47], s81 offen offset:0 lds
    v_mfma_f32_32x32x16_bf16 v[144:159], a[184:187], a[52:55], v[144:159]
    ds_read_b64_tr_b16 a[164:165], v25 offset:6208
    ds_read_b64_tr_b16 a[166:167], v25 offset:7488
    buffer_load_dwordx4 v9, s[44:47], s81 offen offset:1024 lds
    s_waitcnt lgkmcnt(4)
    v_mfma_f32_32x32x16_bf16 v[160:175], a[188:191], a[52:55], v[160:175]
    ds_read_b64_tr_b16 a[168:169], v25 offset:6272
    ds_read_b64_tr_b16 a[170:171], v25 offset:7552
    buffer_load_dwordx4 v10, s[44:47], s81 offen offset:2048 lds
    v_mfma_f32_32x32x16_bf16 v[176:191], a[192:195], a[52:55], v[176:191]
    ds_read_b64_tr_b16 a[172:173], v25 offset:6336
    ds_read_b64_tr_b16 a[174:175], v25 offset:7616
    buffer_load_dwordx4 v11, s[44:47], s81 offen offset:3072 lds
    v_mfma_f32_32x32x16_bf16 v[192:207], a[196:199], a[52:55], v[192:207]
    ds_read_b64_tr_b16 a[176:177], v25 offset:6400
    ds_read_b64_tr_b16 a[178:179], v25 offset:7680
    s_waitcnt lgkmcnt(6)
    v_mfma_f32_32x32x16_bf16 v[128:143], a[160:163], a[56:59], v[128:143]
    ds_read_b64_tr_b16 a[180:181], v25 offset:11264
    s_add_u32 m0, s3, 40960
    ds_read_b64_tr_b16 a[182:183], v25 offset:12544
    buffer_load_dwordx4 v18, s[48:51], s9 offen offset:2048 lds
    v_mfma_f32_32x32x16_bf16 v[144:159], a[164:167], a[56:59], v[144:159]
    ds_read_b64_tr_b16 a[184:185], v25 offset:11328
    ds_read_b64_tr_b16 a[186:187], v25 offset:12608
    s_waitcnt lgkmcnt(4)
    v_mfma_f32_32x32x16_bf16 v[160:175], a[168:171], a[56:59], v[160:175]
    ds_read_b64_tr_b16 a[188:189], v25 offset:11392
    ds_read_b64_tr_b16 a[190:191], v25 offset:12672
    buffer_load_dwordx4 v19, s[48:51], s9 offen offset:3072 lds
    v_mfma_f32_32x32x16_bf16 v[176:191], a[172:175], a[56:59], v[176:191]
    ds_read_b64_tr_b16 a[192:193], v25 offset:11456
    ds_read_b64_tr_b16 a[194:195], v25 offset:12736
    v_mfma_f32_32x32x16_bf16 v[192:207], a[176:179], a[56:59], v[192:207]
    ds_read_b64_tr_b16 a[196:197], v25 offset:11520
    s_add_u32 m0, s3, 45056
    ds_read_b64_tr_b16 a[198:199], v25 offset:12800
    buffer_load_dwordx4 v20, s[48:51], s9 offen offset:0 lds
    s_waitcnt lgkmcnt(6)
    v_mfma_f32_32x32x16_bf16 v[128:143], a[180:183], a[60:63], v[128:143]
    s_waitcnt vmcnt(12) lgkmcnt(0)
    v_mfma_f32_32x32x16_bf16 v[144:159], a[184:187], a[60:63], v[144:159]
    s_barrier
    ds_read_b128 a[64:67], v12 offset:32768
    ds_read_b64_tr_b16 a[160:161], v24 offset:0
    ds_read_b64_tr_b16 a[162:163], v24 offset:1280
    v_mfma_f32_32x32x16_bf16 v[160:175], a[188:191], a[60:63], v[160:175]
    ds_read_b64_tr_b16 a[164:165], v24 offset:64
    ds_read_b64_tr_b16 a[166:167], v24 offset:1344
    ds_read_b64_tr_b16 a[168:169], v24 offset:128
    v_mfma_f32_32x32x16_bf16 v[176:191], a[192:195], a[60:63], v[176:191]
    ds_read_b64_tr_b16 a[170:171], v24 offset:1408
    ds_read_b64_tr_b16 a[172:173], v24 offset:192
    ds_read_b64_tr_b16 a[174:175], v24 offset:1472
    v_mov_b32 v104, 1
    buffer_atomic_add v104, v215, s[60:63], 0 offen
    v_mfma_f32_32x32x16_bf16 v[192:207], a[196:199], a[60:63], v[192:207]
    ds_read_b64_tr_b16 a[176:177], v24 offset:256
    ds_read_b64_tr_b16 a[178:179], v24 offset:1536
    s_lshl_b32 s64, s38, 11
    s_add_u32 s64, s64, 131072
    v_lshlrev_b32 v96, 4, v1
    s_waitcnt lgkmcnt(6)
    v_mfma_f32_32x32x16_bf16 v[128:143], a[160:163], a[64:67], v[128:143]
    ds_read_b128 a[68:71], v13 offset:32768
    ds_read_b64_tr_b16 a[180:181], v24 offset:5120
    ds_read_b64_tr_b16 a[182:183], v24 offset:6400
    v_add_u32 v96, s64, v96
    v_lshl_or_b32 v112, v113, 16, v112
    v_mfma_f32_32x32x16_bf16 v[144:159], a[164:167], a[64:67], v[144:159]
    ds_read_b128 a[72:75], v14 offset:32768
    ds_read_b64_tr_b16 a[184:185], v24 offset:5184
    ds_read_b64_tr_b16 a[186:187], v24 offset:6464
    s_mul_i32 s9, s83, 1920
    s_add_u32 m0, s3, 61440
    s_nop 0
    buffer_load_dwordx4 v16, s[48:51], s9 offen offset:0 lds
    s_waitcnt lgkmcnt(6)
    v_mfma_f32_32x32x16_bf16 v[160:175], a[168:171], a[64:67], v[160:175]
    ds_read_b128 a[76:79], v15 offset:32768
    ds_read_b64_tr_b16 a[188:189], v24 offset:5248
    ds_read_b64_tr_b16 a[190:191], v24 offset:6528
    v_lshl_or_b32 v113, v115, 16, v114
    v_mfma_f32_32x32x16_bf16 v[176:191], a[172:175], a[64:67], v[176:191]
    ds_read_b64_tr_b16 a[192:193], v24 offset:5312
    ds_read_b64_tr_b16 a[194:195], v24 offset:6592
    buffer_load_dwordx4 v17, s[48:51], s9 offen offset:1024 lds
    v_mfma_f32_32x32x16_bf16 v[192:207], a[176:179], a[64:67], v[192:207]
    ds_read_b64_tr_b16 a[196:197], v24 offset:5376
    ds_read_b64_tr_b16 a[198:199], v24 offset:6656
    v_lshl_or_b32 v114, v117, 16, v116
    v_lshl_or_b32 v115, v119, 16, v118
    v_lshl_or_b32 v116, v121, 16, v120
    s_waitcnt lgkmcnt(7)
    v_mfma_f32_32x32x16_bf16 v[128:143], a[180:183], a[68:71], v[128:143]
    ds_read_b64_tr_b16 a[160:161], v24 offset:10240
    s_add_u32 m0, s43, 98304
    ds_read_b64_tr_b16 a[162:163], v24 offset:11520
    buffer_load_dwordx4 v8, s[44:47], s82 offen offset:0 lds
    v_mfma_f32_32x32x16_bf16 v[144:159], a[184:187], a[68:71], v[144:159]
    ds_read_b64_tr_b16 a[164:165], v24 offset:10304
    ds_read_b64_tr_b16 a[166:167], v24 offset:11584
    buffer_load_dwordx4 v9, s[44:47], s82 offen offset:1024 lds
    s_waitcnt lgkmcnt(4)
    v_mfma_f32_32x32x16_bf16 v[160:175], a[188:191], a[68:71], v[160:175]
    ds_read_b64_tr_b16 a[168:169], v24 offset:10368
    ds_read_b64_tr_b16 a[170:171], v24 offset:11648
    buffer_load_dwordx4 v10, s[44:47], s82 offen offset:2048 lds
    v_mfma_f32_32x32x16_bf16 v[176:191], a[192:195], a[68:71], v[176:191]
    ds_read_b64_tr_b16 a[172:173], v24 offset:10432
    ds_read_b64_tr_b16 a[174:175], v24 offset:11712
    buffer_load_dwordx4 v11, s[44:47], s82 offen offset:3072 lds
    v_mfma_f32_32x32x16_bf16 v[192:207], a[196:199], a[68:71], v[192:207]
    ds_read_b64_tr_b16 a[176:177], v24 offset:10496
    ds_read_b64_tr_b16 a[178:179], v24 offset:11776
    v_lshl_or_b32 v117, v123, 16, v122
    v_lshl_or_b32 v118, v125, 16, v124
    v_lshl_or_b32 v119, v127, 16, v126
    s_waitcnt lgkmcnt(6)
    v_mfma_f32_32x32x16_bf16 v[128:143], a[160:163], a[72:75], v[128:143]
    ds_read_b64_tr_b16 a[180:181], v24 offset:15360
    s_add_u32 m0, s3, 61440
    ds_read_b64_tr_b16 a[182:183], v24 offset:16640
    buffer_load_dwordx4 v18, s[48:51], s9 offen offset:2048 lds
    v_mfma_f32_32x32x16_bf16 v[144:159], a[164:167], a[72:75], v[144:159]
    ds_read_b64_tr_b16 a[184:185], v24 offset:15424
    ds_read_b64_tr_b16 a[186:187], v24 offset:16704
    ds_write_b128 v96, v[112:115] offset:0
    ds_write_b128 v96, v[116:119] offset:1024
    s_waitcnt lgkmcnt(6)
    v_mfma_f32_32x32x16_bf16 v[160:175], a[168:171], a[72:75], v[160:175]
    ds_read_b64_tr_b16 a[188:189], v24 offset:15488
    ds_read_b64_tr_b16 a[190:191], v24 offset:16768
    buffer_load_dwordx4 v19, s[48:51], s9 offen offset:3072 lds
    v_mfma_f32_32x32x16_bf16 v[176:191], a[172:175], a[72:75], v[176:191]
    ds_read_b64_tr_b16 a[192:193], v24 offset:15552
    ds_read_b64_tr_b16 a[194:195], v24 offset:16832
    v_mfma_f32_32x32x16_bf16 v[192:207], a[176:179], a[72:75], v[192:207]
    ds_read_b64_tr_b16 a[196:197], v24 offset:15616
    s_add_u32 m0, s3, 65536
    ds_read_b64_tr_b16 a[198:199], v24 offset:16896
    buffer_load_dwordx4 v20, s[48:51], s9 offen offset:0 lds
    s_waitcnt lgkmcnt(8)
    v_mfma_f32_32x32x16_bf16 v[128:143], a[180:183], a[76:79], v[128:143]
    s_waitcnt vmcnt(13) lgkmcnt(0)
    v_mfma_f32_32x32x16_bf16 v[144:159], a[184:187], a[76:79], v[144:159]
    s_barrier
    ds_read_b128 a[80:83], v12 offset:49152
    ds_read_b64_tr_b16 a[160:161], v24 offset:20480
    ds_read_b64_tr_b16 a[162:163], v24 offset:21760
    v_mfma_f32_32x32x16_bf16 v[160:175], a[188:191], a[76:79], v[160:175]
    ds_read_b64_tr_b16 a[164:165], v24 offset:20544
    ds_read_b64_tr_b16 a[166:167], v24 offset:21824
    ds_read_b64_tr_b16 a[168:169], v24 offset:20608
    v_mfma_f32_32x32x16_bf16 v[176:191], a[192:195], a[76:79], v[176:191]
    ds_read_b64_tr_b16 a[170:171], v24 offset:21888
    ds_read_b64_tr_b16 a[172:173], v24 offset:20672
    ds_read_b64_tr_b16 a[174:175], v24 offset:21952
    v_lshlrev_b32 v100, 4, v1
    v_add_u32 v100, 131072, v100
    v_mfma_f32_32x32x16_bf16 v[192:207], a[196:199], a[76:79], v[192:207]
    ds_read_b64_tr_b16 a[176:177], v24 offset:20736
    ds_read_b64_tr_b16 a[178:179], v24 offset:22016
    ds_read_b128 a[200:203], v100 offset:0
    ds_read_b128 a[204:207], v100 offset:1024
    ds_read_b128 a[208:211], v100 offset:2048
    s_waitcnt lgkmcnt(9)
    v_mfma_f32_32x32x16_bf16 v[128:143], a[160:163], a[80:83], v[128:143]
    ds_read_b128 a[84:87], v13 offset:49152
    ds_read_b64_tr_b16 a[180:181], v24 offset:25600
    ds_read_b64_tr_b16 a[182:183], v24 offset:26880
    ds_read_b128 a[212:215], v100 offset:3072
    v_mfma_f32_32x32x16_bf16 v[144:159], a[164:167], a[80:83], v[144:159]
    ds_read_b128 a[88:91], v14 offset:49152
    ds_read_b64_tr_b16 a[184:185], v24 offset:25664
    s_waitcnt lgkmcnt(14)
    ds_read_b64_tr_b16 a[186:187], v24 offset:26944
    s_mul_i32 s9, s84, 1920
    s_add_u32 m0, s3, 0
    s_nop 0
    buffer_load_dwordx4 v16, s[48:51], s9 offen offset:0 lds
    s_waitcnt lgkmcnt(10)
    v_mfma_f32_32x32x16_bf16 v[160:175], a[168:171], a[80:83], v[160:175]
    ds_read_b128 a[92:95], v15 offset:49152
    ds_read_b64_tr_b16 a[188:189], v24 offset:25728
    ds_read_b64_tr_b16 a[190:191], v24 offset:27008
    ds_read_b128 a[216:219], v100 offset:4096
    v_mfma_f32_32x32x16_bf16 v[176:191], a[172:175], a[80:83], v[176:191]
    ds_read_b64_tr_b16 a[192:193], v24 offset:25792
    s_waitcnt lgkmcnt(14)
    ds_read_b64_tr_b16 a[194:195], v24 offset:27072
    buffer_load_dwordx4 v17, s[48:51], s9 offen offset:1024 lds
    v_mfma_f32_32x32x16_bf16 v[192:207], a[176:179], a[80:83], v[192:207]
    s_waitcnt lgkmcnt(14)
    ds_read_b64_tr_b16 a[196:197], v24 offset:25856
    s_waitcnt lgkmcnt(14)
    ds_read_b64_tr_b16 a[198:199], v24 offset:27136
    s_waitcnt lgkmcnt(14)
    ds_read_b128 a[220:223], v100 offset:5120
    s_waitcnt lgkmcnt(14)
    ds_read_b128 a[224:227], v100 offset:6144
    s_waitcnt lgkmcnt(14)
    ds_read_b128 a[228:231], v100 offset:7168
    s_waitcnt lgkmcnt(11)
    v_mfma_f32_32x32x16_bf16 v[128:143], a[180:183], a[84:87], v[128:143]
    ds_read_b64_tr_b16 a[160:161], v24 offset:30720
    s_add_u32 m0, s43, 114688
    ds_read_b64_tr_b16 a[162:163], v24 offset:32000
    buffer_load_dwordx4 v8, s[44:47], s83 offen offset:0 lds
    v_mfma_f32_32x32x16_bf16 v[144:159], a[184:187], a[84:87], v[144:159]
    ds_read_b64_tr_b16 a[164:165], v24 offset:30784
    ds_read_b64_tr_b16 a[166:167], v24 offset:32064
    buffer_load_dwordx4 v9, s[44:47], s83 offen offset:1024 lds
    s_waitcnt lgkmcnt(7)
    v_mfma_f32_32x32x16_bf16 v[160:175], a[188:191], a[84:87], v[160:175]
    ds_read_b64_tr_b16 a[168:169], v24 offset:30848
    ds_read_b64_tr_b16 a[170:171], v24 offset:32128
    buffer_load_dwordx4 v10, s[44:47], s83 offen offset:2048 lds
    v_mfma_f32_32x32x16_bf16 v[176:191], a[192:195], a[84:87], v[176:191]
    ds_read_b64_tr_b16 a[172:173], v24 offset:30912
    ds_read_b64_tr_b16 a[174:175], v24 offset:32192
    buffer_load_dwordx4 v11, s[44:47], s83 offen offset:3072 lds
    v_mfma_f32_32x32x16_bf16 v[192:207], a[196:199], a[84:87], v[192:207]
    ds_read_b64_tr_b16 a[176:177], v24 offset:30976
    ds_read_b64_tr_b16 a[178:179], v24 offset:32256
    s_waitcnt lgkmcnt(6)
    v_mfma_f32_32x32x16_bf16 v[128:143], a[160:163], a[88:91], v[128:143]
    ds_read_b64_tr_b16 a[180:181], v24 offset:35840
    s_add_u32 m0, s3, 0
    ds_read_b64_tr_b16 a[182:183], v24 offset:37120
    buffer_load_dwordx4 v18, s[48:51], s9 offen offset:2048 lds
    v_mfma_f32_32x32x16_bf16 v[144:159], a[164:167], a[88:91], v[144:159]
    ds_read_b64_tr_b16 a[184:185], v24 offset:35904
    ds_read_b64_tr_b16 a[186:187], v24 offset:37184
    s_waitcnt lgkmcnt(4)
    v_mfma_f32_32x32x16_bf16 v[160:175], a[168:171], a[88:91], v[160:175]
    ds_read_b64_tr_b16 a[188:189], v24 offset:35968
    ds_read_b64_tr_b16 a[190:191], v24 offset:37248
    buffer_load_dwordx4 v19, s[48:51], s9 offen offset:3072 lds
    v_mfma_f32_32x32x16_bf16 v[176:191], a[172:175], a[88:91], v[176:191]
    ds_read_b64_tr_b16 a[192:193], v24 offset:36032
    ds_read_b64_tr_b16 a[194:195], v24 offset:37312
    v_mfma_f32_32x32x16_bf16 v[192:207], a[176:179], a[88:91], v[192:207]
    ds_read_b64_tr_b16 a[196:197], v24 offset:36096
    s_add_u32 m0, s3, 4096
    ds_read_b64_tr_b16 a[198:199], v24 offset:37376
    buffer_load_dwordx4 v20, s[48:51], s9 offen offset:0 lds
    s_waitcnt lgkmcnt(6)
    v_mfma_f32_32x32x16_bf16 v[128:143], a[180:183], a[92:95], v[128:143]
    s_waitcnt vmcnt(12) lgkmcnt(0)
    v_mfma_f32_32x32x16_bf16 v[144:159], a[184:187], a[92:95], v[144:159]
    s_barrier
    ds_read_b128 a[96:99], v12 offset:32768
    ds_read_b64_tr_b16 a[160:161], v24 offset:40960
    ds_read_b64_tr_b16 a[162:163], v24 offset:42240
    v_mfma_f32_32x32x16_bf16 v[160:175], a[188:191], a[92:95], v[160:175]
    ds_read_b64_tr_b16 a[164:165], v24 offset:41024
    ds_read_b64_tr_b16 a[166:167], v24 offset:42304
    ds_read_b64_tr_b16 a[168:169], v24 offset:41088
    v_mfma_f32_32x32x16_bf16 v[176:191], a[192:195], a[92:95], v[176:191]
    ds_read_b64_tr_b16 a[170:171], v24 offset:42368
    ds_read_b64_tr_b16 a[172:173], v24 offset:41152
    ds_read_b64_tr_b16 a[174:175], v24 offset:42432
    buffer_load_dword v37, v218, s[60:63], s73 offen sc1
    v_mfma_f32_32x32x16_bf16 v[192:207], a[196:199], a[92:95], v[192:207]
    ds_read_b64_tr_b16 a[176:177], v24 offset:41216
    ds_read_b64_tr_b16 a[178:179], v24 offset:42496
    s_waitcnt lgkmcnt(6)
    v_mfma_f32_32x32x16_bf16 v[128:143], a[160:163], a[96:99], v[128:143]
    ds_read_b128 a[100:103], v13 offset:32768
    ds_read_b64_tr_b16 a[180:181], v24 offset:46080
    ds_read_b64_tr_b16 a[182:183], v24 offset:47360
    v_mfma_f32_32x32x16_bf16 v[144:159], a[164:167], a[96:99], v[144:159]
    ds_read_b128 a[104:107], v14 offset:32768
    ds_read_b64_tr_b16 a[184:185], v24 offset:46144
    ds_read_b64_tr_b16 a[186:187], v24 offset:47424
    s_mul_i32 s9, s85, 1920
    s_add_u32 m0, s3, 20480
    s_nop 0
    buffer_load_dwordx4 v16, s[48:51], s9 offen offset:0 lds
    s_waitcnt lgkmcnt(6)
    v_mfma_f32_32x32x16_bf16 v[160:175], a[168:171], a[96:99], v[160:175]
    ds_read_b128 a[108:111], v15 offset:32768
    ds_read_b64_tr_b16 a[188:189], v24 offset:46208
    ds_read_b64_tr_b16 a[190:191], v24 offset:47488
    v_mfma_f32_32x32x16_bf16 v[176:191], a[172:175], a[96:99], v[176:191]
    ds_read_b64_tr_b16 a[192:193], v24 offset:46272
    ds_read_b64_tr_b16 a[194:195], v24 offset:47552
    buffer_load_dwordx4 v17, s[48:51], s9 offen offset:1024 lds
    v_mfma_f32_32x32x16_bf16 v[192:207], a[176:179], a[96:99], v[192:207]
    ds_read_b64_tr_b16 a[196:197], v24 offset:46336
    ds_read_b64_tr_b16 a[198:199], v24 offset:47616
    s_waitcnt lgkmcnt(7)
    v_mfma_f32_32x32x16_bf16 v[128:143], a[180:183], a[100:103], v[128:143]
    ds_read_b64_tr_b16 a[160:161], v24 offset:51200
    s_add_u32 m0, s43, 98304
    ds_read_b64_tr_b16 a[162:163], v24 offset:52480
    buffer_load_dwordx4 v8, s[44:47], s84 offen offset:0 lds
    v_mfma_f32_32x32x16_bf16 v[144:159], a[184:187], a[100:103], v[144:159]
    ds_read_b64_tr_b16 a[164:165], v24 offset:51264
    ds_read_b64_tr_b16 a[166:167], v24 offset:52544
    buffer_load_dwordx4 v9, s[44:47], s84 offen offset:1024 lds
    s_waitcnt lgkmcnt(4)
    v_mfma_f32_32x32x16_bf16 v[160:175], a[188:191], a[100:103], v[160:175]
    ds_read_b64_tr_b16 a[168:169], v24 offset:51328
    ds_read_b64_tr_b16 a[170:171], v24 offset:52608
    buffer_load_dwordx4 v10, s[44:47], s84 offen offset:2048 lds
    v_mfma_f32_32x32x16_bf16 v[176:191], a[192:195], a[100:103], v[176:191]
    ds_read_b64_tr_b16 a[172:173], v24 offset:51392
    ds_read_b64_tr_b16 a[174:175], v24 offset:52672
    buffer_load_dwordx4 v11, s[44:47], s84 offen offset:3072 lds
    v_mfma_f32_32x32x16_bf16 v[192:207], a[196:199], a[100:103], v[192:207]
    ds_read_b64_tr_b16 a[176:177], v24 offset:51456
    ds_read_b64_tr_b16 a[178:179], v24 offset:52736
    ds_read_b64_tr_b16 v[108:109], v224 offset:0
    ds_read_b64_tr_b16 v[110:111], v224 offset:1280
    ds_read_b64_tr_b16 v[112:113], v224 offset:32
    ds_read_b64_tr_b16 v[114:115], v224 offset:1312
    ds_read_b64_tr_b16 v[116:117], v224 offset:64
    s_waitcnt lgkmcnt(14)
    ds_read_b64_tr_b16 v[118:119], v224 offset:1344
    s_waitcnt lgkmcnt(14)
    ds_read_b64_tr_b16 v[120:121], v224 offset:96
    s_waitcnt lgkmcnt(14)
    ds_read_b64_tr_b16 v[122:123], v224 offset:1376
    s_waitcnt lgkmcnt(14)
    ds_read_b64_tr_b16 v[124:125], v224 offset:128
    s_waitcnt lgkmcnt(14)
    ds_read_b64_tr_b16 v[126:127], v224 offset:1408
    v_mfma_f32_32x32x16_bf16 v[128:143], a[160:163], a[104:107], v[128:143]
    s_waitcnt lgkmcnt(14)
    ds_read_b64_tr_b16 a[180:181], v24 offset:56320
    s_add_u32 m0, s3, 20480
    s_waitcnt lgkmcnt(14)
    ds_read_b64_tr_b16 a[182:183], v24 offset:57600
    buffer_load_dwordx4 v18, s[48:51], s9 offen offset:2048 lds
    v_mfma_f32_32x32x16_bf16 v[144:159], a[164:167], a[104:107], v[144:159]
    s_waitcnt lgkmcnt(14)
    ds_read_b64_tr_b16 a[184:185], v24 offset:56384
    s_waitcnt lgkmcnt(14)
    ds_read_b64_tr_b16 a[186:187], v24 offset:57664
    s_waitcnt lgkmcnt(14)
    v_mfma_f32_32x32x16_bf16 v[160:175], a[168:171], a[104:107], v[160:175]
    ds_read_b64_tr_b16 a[188:189], v24 offset:56448
    s_waitcnt lgkmcnt(14)
    ds_read_b64_tr_b16 a[190:191], v24 offset:57728
    buffer_load_dwordx4 v19, s[48:51], s9 offen offset:3072 lds
    v_mfma_f32_32x32x16_bf16 v[176:191], a[172:175], a[104:107], v[176:191]
    s_waitcnt lgkmcnt(14)
    ds_read_b64_tr_b16 a[192:193], v24 offset:56512
    s_waitcnt lgkmcnt(14)
    ds_read_b64_tr_b16 a[194:195], v24 offset:57792
    v_mfma_f32_32x32x16_bf16 v[192:207], a[176:179], a[104:107], v[192:207]
    s_waitcnt lgkmcnt(14)
    ds_read_b64_tr_b16 a[196:197], v24 offset:56576
    s_add_u32 m0, s3, 24576
    s_waitcnt lgkmcnt(14)
    ds_read_b64_tr_b16 a[198:199], v24 offset:57856
    buffer_load_dwordx4 v20, s[48:51], s9 offen offset:0 lds
    s_waitcnt lgkmcnt(6)
    v_mfma_f32_32x32x16_bf16 v[128:143], a[180:183], a[108:111], v[128:143]
    s_waitcnt vmcnt(9)
    v_cmp_le_u32 vcc, v219, v37
    s_nop 1
    s_cmp_eq_u64 vcc, -1
    s_cbranch_scc1 L_f0_9_ok
    s_cmp_lg_u32 s38, 0
    s_cbranch_scc1 L_f0_9_ok
    s_mov_b32 s69, 0
L_f0_9_spin:
    buffer_load_dword v37, v218, s[60:63], 0 offen sc1
    s_waitcnt vmcnt(0)
    v_cmp_le_u32 vcc, v219, v37
    s_nop 1
    s_cmp_eq_u64 vcc, -1
    s_cbranch_scc1 L_f0_9_ok
    s_sleep 2
    s_add_u32 s69, s69, 1
    s_cmp_lt_u32 s69, 0x4000
    s_cbranch_scc1 L_f0_9_spin
L_f0_9_ok:
    s_waitcnt lgkmcnt(0)
    v_mfma_f32_32x32x16_bf16 v[144:159], a[184:187], a[108:111], v[144:159]
    s_barrier
    ds_read_b128 a[112:115], v12 offset:49152
    ds_read_b64_tr_b16 a[160:161], v24 offset:61440
    ds_read_b64_tr_b16 a[162:163], v24 offset:62720
    v_mfma_f32_32x32x16_bf16 v[160:175], a[188:191], a[108:111], v[160:175]
    ds_read_b64_tr_b16 a[164:165], v24 offset:61504
    ds_read_b64_tr_b16 a[166:167], v24 offset:62784
    ds_read_b64_tr_b16 a[168:169], v24 offset:61568
    s_lshl_b32 s64, s39, 2
    s_add_u32 s64, s64, s38
    s_lshl_b32 s64, s64, 8
    v_mfma_f32_32x32x16_bf16 v[176:191], a[192:195], a[108:111], v[176:191]
    ds_read_b64_tr_b16 a[170:171], v24 offset:62848
    ds_read_b64_tr_b16 a[172:173], v24 offset:61632
    ds_read_b64_tr_b16 a[174:175], v24 offset:62912
    s_add_u32 s64, s64, 69632
    v_lshlrev_b32 v30, 3, v2
    buffer_load_dwordx2 v[100:101], v30, s[60:63], s64 offen sc1
    v_mfma_f32_32x32x16_bf16 v[192:207], a[196:199], a[108:111], v[192:207]
    ds_read_b64_tr_b16 a[176:177], v24 offset:61696
    ds_read_b64_tr_b16 a[178:179], v24 offset:62976
    s_lshl_b32 s64, s40, 11
    s_add_u32 s64, s64, 86016
    v_lshlrev_b32 v30, 2, v1
    buffer_load_dword v102, v30, s[60:63], s64 offen offset:0 sc1
    s_waitcnt lgkmcnt(6)
    v_mfma_f32_32x32x16_bf16 v[128:143], a[160:163], a[112:115], v[128:143]
    ds_read_b128 a[116:119], v13 offset:49152
    ds_read_b64_tr_b16 a[180:181], v25 offset:1024
    ds_read_b64_tr_b16 a[182:183], v25 offset:2304
    buffer_load_dword v103, v30, s[60:63], s64 offen offset:256 sc1
    v_mfma_f32_32x32x16_bf16 v[144:159], a[164:167], a[112:115], v[144:159]
    ds_read_b128 a[120:123], v14 offset:49152
    ds_read_b64_tr_b16 a[184:185], v25 offset:1088
    ds_read_b64_tr_b16 a[186:187], v25 offset:2368
    buffer_load_dword v104, v30, s[60:63], s64 offen offset:512 sc1
    buffer_load_dword v105, v30, s[60:63], s64 offen offset:768 sc1
    s_waitcnt lgkmcnt(6)
    v_mfma_f32_32x32x16_bf16 v[160:175], a[168:171], a[112:115], v[160:175]
    ds_read_b128 a[124:127], v15 offset:49152
    ds_read_b64_tr_b16 a[188:189], v25 offset:1152
    ds_read_b64_tr_b16 a[190:191], v25 offset:2432
    v_mfma_f32_32x32x16_bf16 v[176:191], a[172:175], a[112:115], v[176:191]
    ds_read_b64_tr_b16 a[192:193], v25 offset:1216
    ds_read_b64_tr_b16 a[194:195], v25 offset:2496
    s_mul_i32 s8, s77, 1920
    s_add_u32 m0, s74, 131072
    s_nop 0
    buffer_load_dwordx4 v21, s[48:51], s8 offen offset:0 lds
    buffer_load_dwordx4 v22, s[48:51], s8 offen offset:1024 lds
    v_mfma_f32_32x32x16_bf16 v[192:207], a[176:179], a[112:115], v[192:207]
    ds_read_b64_tr_b16 a[196:197], v25 offset:1280
    ds_read_b64_tr_b16 a[198:199], v25 offset:2560
    s_lshl_b32 s64, s86, 7
    s_lshl_b32 s65, s38, 5
    s_add_u32 s64, s64, s65
    s_mul_i32 s64, s64, 1280
    s_mul_i32 s65, s87, 160
    s_add_u32 s64, s64, s65
    s_add_u32 s4, s16, s64
    s_addc_u32 s5, s17, 0
    s_mov_b32 s7, 0x00020000
    s_sub_u32 s6, 2621440, s64
    s_waitcnt lgkmcnt(7)
    v_mfma_f32_32x32x16_bf16 v[128:143], a[180:183], a[116:119], v[128:143]
    ds_read_b64_tr_b16 a[160:161], v25 offset:6144
    s_add_u32 m0, s43, 114688
    ds_read_b64_tr_b16 a[162:163], v25 offset:7424
    buffer_load_dwordx4 v8, s[44:47], s85 offen offset:0 lds
    v_mfma_f32_32x32x16_bf16 v[144:159], a[184:187], a[116:119], v[144:159]
    ds_read_b64_tr_b16 a[164:165], v25 offset:6208
    s_add_u32 m0, s74, 131072
    ds_read_b64_tr_b16 a[166:167], v25 offset:7488
    buffer_load_dwordx4 v23, s[48:51], s8 offen offset:2048 lds
    s_add_u32 m0, s43, 114688
    s_nop 0
    buffer_load_dwordx4 v9, s[44:47], s85 offen offset:1024 lds
    s_waitcnt lgkmcnt(4)
    v_mfma_f32_32x32x16_bf16 v[160:175], a[188:191], a[116:119], v[160:175]
    ds_read_b64_tr_b16 a[168:169], v25 offset:6272
    ds_read_b64_tr_b16 a[170:171], v25 offset:7552
    v_and_b32 v0, 15, v1
    buffer_load_dwordx4 v10, s[44:47], s85 offen offset:2048 lds
    v_mfma_f32_32x32x16_bf16 v[176:191], a[192:195], a[116:119], v[176:191]
    ds_read_b64_tr_b16 a[172:173], v25 offset:6336
    ds_read_b64_tr_b16 a[174:175], v25 offset:7616
    s_mul_i32 s8, s78, 1920
    s_add_u32 m0, s74, 143360
    s_nop 0
    buffer_load_dwordx4 v21, s[48:51], s8 offen offset:0 lds
    s_add_u32 m0, s43, 114688
    v_mul_u32_u24 v0, 1280, v0
    buffer_load_dwordx4 v11, s[44:47], s85 offen offset:3072 lds
    v_mfma_f32_32x32x16_bf16 v[192:207], a[196:199], a[116:119], v[192:207]
    ds_read_b64_tr_b16 a[176:177], v25 offset:6400
    ds_read_b64_tr_b16 a[178:179], v25 offset:7680
    s_add_u32 m0, s74, 143360
    v_lshrrev_b32 v31, 4, v1
    buffer_load_dwordx4 v22, s[48:51], s8 offen offset:1024 lds
    s_waitcnt lgkmcnt(6)
    v_mfma_f32_32x32x16_bf16 v[128:143], a[160:163], a[120:123], v[128:143]
    ds_read_b64_tr_b16 a[180:181], v25 offset:11264
    ds_read_b64_tr_b16 a[182:183], v25 offset:12544
    v_lshl_add_u32 v0, v31, 4, v0
    v_mfma_f32_32x32x16_bf16 v[144:159], a[164:167], a[120:123], v[144:159]
    ds_read_b64_tr_b16 a[184:185], v25 offset:11328
    ds_read_b64_tr_b16 a[186:187], v25 offset:12608
    v_add_u32 v31, 20480, v0
    s_waitcnt lgkmcnt(4)
    v_mfma_f32_32x32x16_bf16 v[160:175], a[168:171], a[120:123], v[160:175]
    ds_read_b64_tr_b16 a[188:189], v25 offset:11392
    ds_read_b64_tr_b16 a[190:191], v25 offset:12672
    v_mfma_f32_32x32x16_bf16 v[176:191], a[172:175], a[120:123], v[176:191]
    ds_read_b64_tr_b16 a[192:193], v25 offset:11456
    ds_read_b64_tr_b16 a[194:195], v25 offset:12736
    buffer_load_dwordx4 v23, s[48:51], s8 offen offset:2048 lds
    v_mfma_f32_32x32x16_bf16 v[192:207], a[176:179], a[120:123], v[192:207]
    ds_read_b64_tr_b16 a[196:197], v25 offset:11520
    ds_read_b64_tr_b16 a[198:199], v25 offset:12800
    s_waitcnt lgkmcnt(6)
    v_mfma_f32_32x32x16_bf16 v[128:143], a[180:183], a[124:127], v[128:143]
    s_waitcnt vmcnt(18) lgkmcnt(0)
    v_mfma_f32_32x32x16_bf16 v[144:159], a[184:187], a[124:127], v[144:159]
    s_barrier
    ds_read_b128 a[128:131], v12 offset:32768
    ds_read_b64_tr_b16 a[160:161], v24 offset:0
    ds_read_b64_tr_b16 a[162:163], v24 offset:1280
    v_mfma_f32_32x32x16_bf16 v[160:175], a[188:191], a[124:127], v[160:175]
    ds_read_b64_tr_b16 a[164:165], v24 offset:64
    ds_read_b64_tr_b16 a[166:167], v24 offset:1344
    ds_read_b64_tr_b16 a[168:169], v24 offset:128
    v_mfma_f32_32x32x16_bf16 v[176:191], a[192:195], a[124:127], v[176:191]
    ds_read_b64_tr_b16 a[170:171], v24 offset:1408
    ds_read_b64_tr_b16 a[172:173], v24 offset:192
    ds_read_b64_tr_b16 a[174:175], v24 offset:1472
    v_mfma_f32_32x32x16_bf16 v[192:207], a[196:199], a[124:127], v[192:207]
    ds_read_b64_tr_b16 a[176:177], v24 offset:256
    ds_read_b64_tr_b16 a[178:179], v24 offset:1536
    buffer_load_dwordx4 a[232:235], v0, s[4:7], 0 offen offset:0
    s_waitcnt lgkmcnt(6)
    v_mfma_f32_32x32x16_bf16 v[128:143], a[160:163], a[128:131], v[128:143]
    ds_read_b128 a[132:135], v13 offset:32768
    ds_read_b64_tr_b16 a[180:181], v24 offset:5120
    ds_read_b64_tr_b16 a[182:183], v24 offset:6400
    v_mfma_f32_32x32x16_bf16 v[144:159], a[164:167], a[128:131], v[144:159]
    ds_read_b128 a[136:139], v14 offset:32768
    ds_read_b64_tr_b16 a[184:185], v24 offset:5184
    ds_read_b64_tr_b16 a[186:187], v24 offset:6464
    s_waitcnt lgkmcnt(6)
    v_mfma_f32_32x32x16_bf16 v[160:175], a[168:171], a[128:131], v[160:175]
    ds_read_b128 a[140:143], v15 offset:32768
    ds_read_b64_tr_b16 a[188:189], v24 offset:5248
    ds_read_b64_tr_b16 a[190:191], v24 offset:6528
    s_mul_i32 s8, s79, 1920
    s_add_u32 m0, s74, 69632
    s_nop 0
    buffer_load_dwordx4 v21, s[48:51], s8 offen offset:0 lds
    v_mfma_f32_32x32x16_bf16 v[176:191], a[172:175], a[128:131], v[176:191]
    ds_read_b64_tr_b16 a[192:193], v24 offset:5312
    ds_read_b64_tr_b16 a[194:195], v24 offset:6592
    buffer_load_dwordx4 a[236:239], v31, s[4:7], 0 offen offset:0
    v_mfma_f32_32x32x16_bf16 v[192:207], a[176:179], a[128:131], v[192:207]
    ds_read_b64_tr_b16 a[196:197], v24 offset:5376
    ds_read_b64_tr_b16 a[198:199], v24 offset:6656
    buffer_load_dwordx4 v22, s[48:51], s8 offen offset:1024 lds
    s_waitcnt lgkmcnt(7)
    v_mfma_f32_32x32x16_bf16 v[128:143], a[180:183], a[132:135], v[128:143]
    ds_read_b64_tr_b16 a[160:161], v24 offset:10240
    ds_read_b64_tr_b16 a[162:163], v24 offset:11520
    buffer_load_dwordx4 v23, s[48:51], s8 offen offset:2048 lds
    v_mfma_f32_32x32x16_bf16 v[144:159], a[184:187], a[132:135], v[144:159]
    ds_read_b64_tr_b16 a[164:165], v24 offset:10304
    ds_read_b64_tr_b16 a[166:167], v24 offset:11584
    buffer_load_dwordx4 a[240:243], v0, s[4:7], 0 offen offset:64
    s_waitcnt lgkmcnt(4)
    v_mfma_f32_32x32x16_bf16 v[160:175], a[188:191], a[132:135], v[160:175]
    ds_read_b64_tr_b16 a[168:169], v24 offset:10368
    ds_read_b64_tr_b16 a[170:171], v24 offset:11648
    v_mfma_f32_32x32x16_bf16 v[176:191], a[192:195], a[132:135], v[176:191]
    ds_read_b64_tr_b16 a[172:173], v24 offset:10432
    ds_read_b64_tr_b16 a[174:175], v24 offset:11712
    buffer_load_dwordx4 a[244:247], v31, s[4:7], 0 offen offset:64
    v_mfma_f32_32x32x16_bf16 v[192:207], a[196:199], a[132:135], v[192:207]
    ds_read_b64_tr_b16 a[176:177], v24 offset:10496
    ds_read_b64_tr_b16 a[178:179], v24 offset:11776
    s_waitcnt lgkmcnt(6)
    v_mfma_f32_32x32x16_bf16 v[128:143], a[160:163], a[136:139], v[128:143]
    ds_read_b64_tr_b16 a[180:181], v24 offset:15360
    ds_read_b64_tr_b16 a[182:183], v24 offset:16640
    v_mfma_f32_32x32x16_bf16 v[144:159], a[164:167], a[136:139], v[144:159]
    ds_read_b64_tr_b16 a[184:185], v24 offset:15424
    ds_read_b64_tr_b16 a[186:187], v24 offset:16704
    buffer_load_dwordx4 a[248:251], v0, s[4:7], 0 offen offset:128
    s_waitcnt lgkmcnt(4)
    v_mfma_f32_32x32x16_bf16 v[160:175], a[168:171], a[136:139], v[160:175]
    ds_read_b64_tr_b16 a[188:189], v24 offset:15488
    ds_read_b64_tr_b16 a[190:191], v24 offset:16768
    v_mfma_f32_32x32x16_bf16 v[176:191], a[172:175], a[136:139], v[176:191]
    ds_read_b64_tr_b16 a[192:193], v24 offset:15552
    ds_read_b64_tr_b16 a[194:195], v24 offset:16832
    v_mfma_f32_32x32x16_bf16 v[192:207], a[176:179], a[136:139], v[192:207]
    ds_read_b64_tr_b16 a[196:197], v24 offset:15616
    ds_read_b64_tr_b16 a[198:199], v24 offset:16896
    s_waitcnt lgkmcnt(6)
    v_mfma_f32_32x32x16_bf16 v[128:143], a[180:183], a[140:143], v[128:143]
    buffer_load_dwordx4 a[252:255], v31, s[4:7], 0 offen offset:128
    s_waitcnt vmcnt(11) lgkmcnt(0)
    v_mfma_f32_32x32x16_bf16 v[144:159], a[184:187], a[140:143], v[144:159]
    s_barrier
    ds_read_b128 a[144:147], v12 offset:49152
    ds_read_b64_tr_b16 a[160:161], v24 offset:20480
    ds_read_b64_tr_b16 a[162:163], v24 offset:21760
    v_mfma_f32_32x32x16_bf16 v[160:175], a[188:191], a[140:143], v[160:175]
    ds_read_b64_tr_b16 a[164:165], v24 offset:20544
    ds_read_b64_tr_b16 a[166:167], v24 offset:21824
    ds_read_b64_tr_b16 a[168:169], v24 offset:20608
    v_mfma_f32_32x32x16_bf16 v[176:191], a[192:195], a[140:143], v[176:191]
    ds_read_b64_tr_b16 a[170:171], v24 offset:21888
    ds_read_b64_tr_b16 a[172:173], v24 offset:20672
    ds_read_b64_tr_b16 a[174:175], v24 offset:21952
    v_mfma_f32_32x32x16_bf16 v[192:207], a[196:199], a[140:143], v[192:207]
    ds_read_b64_tr_b16 a[176:177], v24 offset:20736
    ds_read_b64_tr_b16 a[178:179], v24 offset:22016
    s_waitcnt lgkmcnt(6)
    v_mfma_f32_32x32x16_bf16 v[128:143], a[160:163], a[144:147], v[128:143]
    ds_read_b128 a[148:151], v13 offset:49152
    ds_read_b64_tr_b16 a[180:181], v24 offset:25600
    ds_read_b64_tr_b16 a[182:183], v24 offset:26880
    v_mul_f32 v5, 0.0015625, v100
    v_mul_f32 v56, 0.0015625, v101
    v_fma_f32 v56, -v5, v5, v56
    v_max_f32 v56, 0, v56
    v_add_f32 v56, 0x3727c5ac, v56
    v_rsq_f32 v4, v56
    v_sub_f32 v56, 0, v5
    v_cvt_pk_bf16_f32 v32, v56, v56
    v_and_b32 v57, s11, v32
    v_sub_f32 v58, v56, v57
    v_cvt_pk_bf16_f32 v33, v58, v56
    v_lshlrev_b32 v57, 16, v33
    v_sub_f32 v56, v58, v57
    v_cvt_pk_bf16_f32 v34, v56, v58
    v_cmp_eq_u32 vcc, 0, v3
    v_mfma_f32_32x32x16_bf16 v[144:159], a[164:167], a[144:147], v[144:159]
    ds_read_b128 a[152:155], v14 offset:49152
    ds_read_b64_tr_b16 a[184:185], v24 offset:25664
    ds_read_b64_tr_b16 a[186:187], v24 offset:26944
    v_mov_b32 v35, 0
    v_mov_b32 v39, 0
    v_cndmask_b32 v36, v32, v35, vcc
    v_cndmask_b32 v37, v33, v35, vcc
    v_cndmask_b32 v38, v34, v35, vcc
    v_cndmask_b32 v32, v35, v32, vcc
    v_cndmask_b32 v33, v35, v33, vcc
    v_cndmask_b32 v34, v35, v34, vcc
    v_cvt_pk_bf16_f32 v56, v102, v102
    v_and_b32 v56, s11, v56
    v_sub_f32 v56, v102, v56
    v_cvt_pk_bf16_f32 v40, v102, v56
    v_and_b32 v57, s11, v40
    v_sub_f32 v56, v56, v57
    v_cvt_pk_bf16_f32 v41, v102, v56
    v_mov_b32 v42, v40
    v_mov_b32 v43, 0
    s_waitcnt lgkmcnt(6)
    v_mfma_f32_32x32x16_bf16 v[160:175], a[168:171], a[144:147], v[160:175]
    ds_read_b128 a[156:159], v15 offset:49152
    ds_read_b64_tr_b16 a[188:189], v24 offset:25728
    ds_read_b64_tr_b16 a[190:191], v24 offset:27008
    v_cvt_pk_bf16_f32 v56, v103, v103
    v_and_b32 v56, s11, v56
    v_sub_f32 v56, v103, v56
    v_cvt_pk_bf16_f32 v44, v103, v56
    v_and_b32 v57, s11, v44
    v_sub_f32 v56, v56, v57
    v_cvt_pk_bf16_f32 v45, v103, v56
    v_mov_b32 v46, v44
    v_mov_b32 v47, 0
    v_cvt_pk_bf16_f32 v56, v104, v104
    v_and_b32 v56, s11, v56
    v_sub_f32 v56, v104, v56
    v_cvt_pk_bf16_f32 v48, v104, v56
    v_and_b32 v57, s11, v48
    v_sub_f32 v56, v56, v57
    v_mfma_f32_32x32x16_bf16 v[176:191], a[172:175], a[144:147], v[176:191]
    ds_read_b64_tr_b16 a[192:193], v24 offset:25792
    ds_read_b64_tr_b16 a[194:195], v24 offset:27072
    v_cvt_pk_bf16_f32 v49, v104, v56
    v_mov_b32 v50, v48
    v_mov_b32 v51, 0
    v_cvt_pk_bf16_f32 v56, v105, v105
    v_and_b32 v56, s11, v56
    v_sub_f32 v56, v105, v56
    v_cvt_pk_bf16_f32 v52, v105, v56
    v_and_b32 v57, s11, v52
    v_sub_f32 v56, v56, v57
    v_cvt_pk_bf16_f32 v53, v105, v56
    v_mov_b32 v54, v52
    v_mov_b32 v55, 0
    v_mul_f32 v5, 0x3fb8aa3b, v4
    s_mul_i32 s8, s80, 1920
    s_add_u32 m0, s74, 94208
    s_nop 0
    buffer_load_dwordx4 v21, s[48:51], s8 offen offset:0 lds
    v_mfma_f32_32x32x16_bf16 v[192:207], a[176:179], a[144:147], v[192:207]
    ds_read_b64_tr_b16 a[196:197], v24 offset:25856
    ds_read_b64_tr_b16 a[198:199], v24 offset:27136
    buffer_load_dwordx4 v22, s[48:51], s8 offen offset:1024 lds
    s_waitcnt lgkmcnt(7)
    v_mfma_f32_32x32x16_bf16 v[128:143], a[180:183], a[148:151], v[128:143]
    ds_read_b64_tr_b16 a[160:161], v24 offset:30720
    ds_read_b64_tr_b16 a[162:163], v24 offset:32000
    v_mfma_f32_32x32x16_bf16 v[144:159], a[184:187], a[148:151], v[144:159]
    ds_read_b64_tr_b16 a[164:165], v24 offset:30784
    ds_read_b64_tr_b16 a[166:167], v24 offset:32064
    buffer_load_dwordx4 v23, s[48:51], s8 offen offset:2048 lds
    s_waitcnt lgkmcnt(4)
    v_mfma_f32_32x32x16_bf16 v[160:175], a[188:191], a[148:151], v[160:175]
    ds_read_b64_tr_b16 a[168:169], v24 offset:30848
    ds_read_b64_tr_b16 a[170:171], v24 offset:32128
    v_mfma_f32_32x32x16_bf16 v[176:191], a[192:195], a[148:151], v[176:191]
    ds_read_b64_tr_b16 a[172:173], v24 offset:30912
    ds_read_b64_tr_b16 a[174:175], v24 offset:32192
    v_mfma_f32_32x32x16_bf16 v[192:207], a[196:199], a[148:151], v[192:207]
    ds_read_b64_tr_b16 a[176:177], v24 offset:30976
    ds_read_b64_tr_b16 a[178:179], v24 offset:32256
    s_waitcnt lgkmcnt(6)
    v_mfma_f32_32x32x16_bf16 v[128:143], a[160:163], a[152:155], v[128:143]
    ds_read_b64_tr_b16 a[180:181], v24 offset:35840
    ds_read_b64_tr_b16 a[182:183], v24 offset:37120
    v_mfma_f32_32x32x16_bf16 v[144:159], a[164:167], a[152:155], v[144:159]
    ds_read_b64_tr_b16 a[184:185], v24 offset:35904
    ds_read_b64_tr_b16 a[186:187], v24 offset:37184
    s_waitcnt lgkmcnt(4)
    v_mfma_f32_32x32x16_bf16 v[160:175], a[168:171], a[152:155], v[160:175]
    ds_read_b64_tr_b16 a[188:189], v24 offset:35968
    ds_read_b64_tr_b16 a[190:191], v24 offset:37248
    v_mfma_f32_32x32x16_bf16 v[176:191], a[172:175], a[152:155], v[176:191]
    ds_read_b64_tr_b16 a[192:193], v24 offset:36032
    ds_read_b64_tr_b16 a[194:195], v24 offset:37312
    v_mfma_f32_32x32x16_bf16 v[192:207], a[176:179], a[152:155], v[192:207]
    ds_read_b64_tr_b16 a[196:197], v24 offset:36096
    ds_read_b64_tr_b16 a[198:199], v24 offset:37376
    s_waitcnt lgkmcnt(6)
    v_mfma_f32_32x32x16_bf16 v[128:143], a[180:183], a[156:159], v[128:143]
    v_mfma_f32_32x32x16_bf16 v[144:159], a[184:187], a[156:159], v[144:159]
    s_waitcnt lgkmcnt(0)
    v_mfma_f32_32x32x16_bf16 v[160:175], a[188:191], a[156:159], v[160:175]
    v_mfma_f32_32x32x16_bf16 v[176:191], a[192:195], a[156:159], v[176:191]
    v_mfma_f32_32x32x16_bf16 v[192:207], a[196:199], a[156:159], v[192:207]
    v_mfma_f32_32x32x16_bf16 v[128:143], v[40:43], v[32:35], v[128:143]
    v_mfma_f32_32x32x16_bf16 v[144:159], v[44:47], v[32:35], v[144:159]
    v_mfma_f32_32x32x16_bf16 v[160:175], v[48:51], v[32:35], v[160:175]
    v_mul_u32_u24 v60, 336, v2
    s_mul_i32 s41, s38, 10752
    v_add_u32 v60, s41, v60
    v_lshl_add_u32 v8, v3, 4, v60
    v_lshl_add_u32 v9, v3, 3, v60
    v_mul_u32_u24 v60, 208, v2
    s_mul_i32 s41, s38, 6656
    s_add_u32 s41, s41, 43008
    v_add_u32 v60, s41, v60
    v_lshl_add_u32 v10, v3, 3, v60
    v_lshl_add_u32 v11, v3, 4, v60
    v_cvt_pk_bf16_f32 v64, v128, v129
    v_cvt_pk_bf16_f32 v65, v130, v131
    v_cvt_pk_bf16_f32 v66, v132, v133
    v_cvt_pk_bf16_f32 v67, v134, v135
    v_cvt_pk_bf16_f32 v68, v136, v137
    v_cvt_pk_bf16_f32 v69, v138, v139
    v_cvt_pk_bf16_f32 v70, v140, v141
    v_cvt_pk_bf16_f32 v71, v142, v143
    v_mfma_f32_32x32x16_bf16 v[84:99], a[200:203], v[64:67], 0
    v_cvt_pk_bf16_f32 v72, v144, v145
    v_cvt_pk_bf16_f32 v73, v146, v147
    v_cvt_pk_bf16_f32 v74, v148, v149
    v_cvt_pk_bf16_f32 v75, v150, v151
    v_cvt_pk_bf16_f32 v76, v152, v153
    v_cvt_pk_bf16_f32 v77, v154, v155
    v_cvt_pk_bf16_f32 v78, v156, v157
    v_cvt_pk_bf16_f32 v79, v158, v159
    v_cvt_pk_bf16_f32 v80, v160, v161
    v_cvt_pk_bf16_f32 v81, v162, v163
    v_cvt_pk_bf16_f32 v82, v164, v165
    v_cvt_pk_bf16_f32 v83, v166, v167
    v_mfma_f32_32x32x16_bf16 v[176:191], v[52:55], v[32:35], v[176:191]
    v_mfma_f32_32x32x16_bf16 v[192:207], v[40:43], v[36:39], v[192:207]
    v_mfma_f32_32x32x16_bf16 v[84:99], a[204:207], v[68:71], v[84:99]
    v_lshlrev_b32 v62, 4, v1
    buffer_store_dwordx4 v[108:111], v62, s[12:15], 0 offen offset:0 sc1
    v_mfma_f32_32x32x16_bf16 v[208:223], v[44:47], v[36:39], 0
    v_mfma_f32_32x32x16_bf16 v[224:239], v[48:51], v[36:39], 0
    v_mfma_f32_32x32x16_bf16 v[240:255], v[52:55], v[36:39], 0
    buffer_store_dwordx4 v[112:115], v62, s[12:15], 0 offen offset:1024 sc1
    buffer_store_dwordx4 v[116:119], v62, s[12:15], 0 offen offset:2048 sc1
    buffer_store_dwordx4 v[120:123], v62, s[12:15], 0 offen offset:3072 sc1
    s_mov_b32 s69, 4096
    buffer_store_dwordx4 v[124:127], v62, s[12:15], s69 offen offset:0 sc1
    s_waitcnt lgkmcnt(0)
    s_barrier
    v_pk_mul_f32 v[168:169], v[168:169], v[4:5] op_sel_hi:[1,0]
    v_pk_mul_f32 v[170:171], v[170:171], v[4:5] op_sel_hi:[1,0]
    s_mul_i32 s8, s81, 1920
    s_add_u32 m0, s74, 106496
    s_nop 0
    buffer_load_dwordx4 v21, s[48:51], s8 offen offset:0 lds
    v_cvt_pk_bf16_f32 v56, v168, v169
    v_cvt_pk_bf16_f32 v57, v170, v171
    ds_write_b64 v10, v[56:57] offset:0
    v_pk_mul_f32 v[172:173], v[172:173], v[4:5] op_sel_hi:[1,0]
    v_pk_mul_f32 v[174:175], v[174:175], v[4:5] op_sel_hi:[1,0]
    buffer_load_dwordx4 v22, s[48:51], s8 offen offset:1024 lds
    v_cvt_pk_bf16_f32 v58, v172, v173
    v_cvt_pk_bf16_f32 v59, v174, v175
    ds_write_b64 v10, v[58:59] offset:16
    v_pk_mul_f32 v[176:177], v[176:177], v[4:5] op_sel_hi:[1,0]
    v_pk_mul_f32 v[178:179], v[178:179], v[4:5] op_sel_hi:[1,0]
    buffer_load_dwordx4 v23, s[48:51], s8 offen offset:2048 lds
    v_cvt_pk_bf16_f32 v56, v176, v177
    v_cvt_pk_bf16_f32 v57, v178, v179
    ds_write_b64 v11, v[56:57] offset:32
    v_pk_mul_f32 v[180:181], v[180:181], v[4:5] op_sel_hi:[1,0]
    v_pk_mul_f32 v[182:183], v[182:183], v[4:5] op_sel_hi:[1,0]
    s_mul_i32 s8, s82, 1920
    s_add_u32 m0, s74, 118784
    s_nop 0
    buffer_load_dwordx4 v21, s[48:51], s8 offen offset:0 lds
    v_cvt_pk_bf16_f32 v58, v180, v181
    v_cvt_pk_bf16_f32 v59, v182, v183
    ds_write_b64 v10, v[58:59] offset:56
    v_pk_mul_f32 v[184:185], v[184:185], v[4:5] op_sel_hi:[1,0]
    v_pk_mul_f32 v[186:187], v[186:187], v[4:5] op_sel_hi:[1,0]
    buffer_load_dwordx4 v22, s[48:51], s8 offen offset:1024 lds
    v_cvt_pk_bf16_f32 v56, v184, v185
    v_cvt_pk_bf16_f32 v57, v186, v187
    ds_write_b64 v10, v[56:57] offset:72
    v_pk_mul_f32 v[188:189], v[188:189], v[4:5] op_sel_hi:[1,0]
    v_pk_mul_f32 v[190:191], v[190:191], v[4:5] op_sel_hi:[1,0]
    buffer_load_dwordx4 v23, s[48:51], s8 offen offset:2048 lds
    v_cvt_pk_bf16_f32 v58, v188, v189
    v_cvt_pk_bf16_f32 v59, v190, v191
    ds_write_b64 v10, v[58:59] offset:96
    v_pk_mul_f32 v[192:193], v[192:193], v[4:5] op_sel_hi:[1,0]
    v_pk_mul_f32 v[194:195], v[194:195], v[4:5] op_sel_hi:[1,0]
    v_cvt_pk_bf16_f32 v56, v192, v193
    v_cvt_pk_bf16_f32 v57, v194, v195
    ds_write_b64 v10, v[56:57] offset:112
    v_pk_mul_f32 v[196:197], v[196:197], v[4:5] op_sel_hi:[1,0]
    v_pk_mul_f32 v[198:199], v[198:199], v[4:5] op_sel_hi:[1,0]
    v_cvt_pk_bf16_f32 v58, v196, v197
    v_cvt_pk_bf16_f32 v59, v198, v199
    ds_write_b64 v11, v[58:59] offset:128
    v_pk_mul_f32 v[200:201], v[200:201], v[4:5] op_sel_hi:[1,0]
    v_pk_mul_f32 v[202:203], v[202:203], v[4:5] op_sel_hi:[1,0]
    v_cvt_pk_bf16_f32 v56, v200, v201
    v_cvt_pk_bf16_f32 v57, v202, v203
    ds_write_b64 v10, v[56:57] offset:152
    v_pk_mul_f32 v[204:205], v[204:205], v[4:5] op_sel_hi:[1,0]
    v_pk_mul_f32 v[206:207], v[206:207], v[4:5] op_sel_hi:[1,0]
    v_cvt_pk_bf16_f32 v58, v204, v205
    v_cvt_pk_bf16_f32 v59, v206, v207
    ds_write_b64 v10, v[58:59] offset:168
    v_mov_b32 v60, 0x3f803f80
    v_mov_b32 v61, 0x3f803f80
    v_mul_u32_u24 v62, 88, v3
    v_add_u32 v62, v62, v10
    ds_write_b64 v62, v[60:61] offset:40
    ds_write_b64 v62, v[60:61] offset:88
    v_max3_f32 v94, v84, v85, v86
    v_max3_f32 v95, -v84, -v85, -v86
    v_max3_f32 v94, v94, v87, v88
    v_max3_f32 v95, v95, -v87, -v88
    v_max3_f32 v94, v94, v89, v90
    v_max3_f32 v95, v95, -v89, -v90
    v_mfma_f32_32x32x16_bf16 v[100:115], a[208:211], v[68:71], 0
    v_max3_f32 v94, v94, v91, v92
    v_max3_f32 v95, v95, -v91, -v92
    v_max_f32 v94, v94, v93
    v_max_f32_e64 v95, v95, -v93
    s_nop 1
    v_permlane32_swap_b32 v94, v95
    v_max_f32 v94, v94, v95
    v_mul_f32 v94, v5, v94
    v_mov_b32 v96, v94
    s_nop 1
    v_permlane32_swap_b32 v94, v96
    v_pk_fma_f32 v[116:117], v[84:85], v[4:5], v[94:95] op_sel:[0,1,0] op_sel_hi:[1,1,0] neg_lo:[0,0,1] neg_hi:[0,0,1]
    v_pk_fma_f32 v[84:85], v[84:85], v[4:5], v[96:97] op_sel:[0,1,0] op_sel_hi:[1,1,0] neg_lo:[1,0,1] neg_hi:[1,0,1]
    v_pk_fma_f32 v[118:119], v[86:87], v[4:5], v[94:95] op_sel:[0,1,0] op_sel_hi:[1,1,0] neg_lo:[0,0,1] neg_hi:[0,0,1]
    v_pk_fma_f32 v[86:87], v[86:87], v[4:5], v[96:97] op_sel:[0,1,0] op_sel_hi:[1,1,0] neg_lo:[1,0,1] neg_hi:[1,0,1]
    v_pk_fma_f32 v[120:121], v[88:89], v[4:5], v[94:95] op_sel:[0,1,0] op_sel_hi:[1,1,0] neg_lo:[0,0,1] neg_hi:[0,0,1]
    v_pk_fma_f32 v[88:89], v[88:89], v[4:5], v[96:97] op_sel:[0,1,0] op_sel_hi:[1,1,0] neg_lo:[1,0,1] neg_hi:[1,0,1]
    v_pk_fma_f32 v[122:123], v[90:91], v[4:5], v[94:95] op_sel:[0,1,0] op_sel_hi:[1,1,0] neg_lo:[0,0,1] neg_hi:[0,0,1]
    v_pk_fma_f32 v[90:91], v[90:91], v[4:5], v[96:97] op_sel:[0,1,0] op_sel_hi:[1,1,0] neg_lo:[1,0,1] neg_hi:[1,0,1]
    v_pk_fma_f32 v[124:125], v[92:93], v[4:5], v[94:95] op_sel:[0,1,0] op_sel_hi:[1,1,0] neg_lo:[0,0,1] neg_hi:[0,0,1]
    v_mfma_f32_32x32x16_bf16 v[100:115], a[212:215], v[72:75], v[100:115]
    v_pk_fma_f32 v[92:93], v[92:93], v[4:5], v[96:97] op_sel:[0,1,0] op_sel_hi:[1,1,0] neg_lo:[1,0,1] neg_hi:[1,0,1]
    v_exp_f32 v116, v116
    v_exp_f32 v84, v84
    v_exp_f32 v117, v117
    v_exp_f32 v85, v85
    v_exp_f32 v118, v118
    v_exp_f32 v86, v86
    v_exp_f32 v119, v119
    v_exp_f32 v87, v87
    v_exp_f32 v120, v120
    v_exp_f32 v88, v88
    v_exp_f32 v121, v121
    v_exp_f32 v89, v89
    v_exp_f32 v122, v122
    v_exp_f32 v90, v90
    v_exp_f32 v123, v123
    v_exp_f32 v91, v91
    v_exp_f32 v124, v124
    v_exp_f32 v92, v92
    v_exp_f32 v125, v125
    v_exp_f32 v93, v93
    v_pk_add_f32 v[94:95], v[116:117], v[118:119]
    v_pk_add_f32 v[96:97], v[84:85], v[86:87]
    v_pk_add_f32 v[94:95], v[94:95], v[120:121]
    v_pk_add_f32 v[96:97], v[96:97], v[88:89]
    v_pk_add_f32 v[94:95], v[94:95], v[122:123]
    v_pk_add_f32 v[96:97], v[96:97], v[90:91]
    v_pk_add_f32 v[94:95], v[94:95], v[124:125]
    v_pk_add_f32 v[96:97], v[96:97], v[92:93]
    v_add_f32 v94, v94, v95
    v_add_f32 v96, v96, v97
    s_nop 1
    v_permlane32_swap_b32 v94, v96
    v_add_f32 v94, v94, v96
    v_rcp_f32 v94, v94
    s_nop 0
    v_mov_b32 v96, v94
    s_nop 1
    v_permlane32_swap_b32 v94, v96
    v_pk_mul_f32 v[116:117], v[116:117], v[94:95] op_sel_hi:[1,0]
    v_pk_mul_f32 v[84:85], v[84:85], v[96:97] op_sel_hi:[1,0]
    v_pk_mul_f32 v[118:119], v[118:119], v[94:95] op_sel_hi:[1,0]
    v_pk_mul_f32 v[86:87], v[86:87], v[96:97] op_sel_hi:[1,0]
    v_pk_mul_f32 v[120:121], v[120:121], v[94:95] op_sel_hi:[1,0]
    v_pk_mul_f32 v[88:89], v[88:89], v[96:97] op_sel_hi:[1,0]
    v_pk_mul_f32 v[122:123], v[122:123], v[94:95] op_sel_hi:[1,0]
    v_pk_mul_f32 v[90:91], v[90:91], v[96:97] op_sel_hi:[1,0]
    v_pk_mul_f32 v[124:125], v[124:125], v[94:95] op_sel_hi:[1,0]
    v_pk_mul_f32 v[92:93], v[92:93], v[96:97] op_sel_hi:[1,0]
    v_cvt_pk_bf16_f32 v44, v116, v117
    v_cvt_pk_bf16_f32 v45, v118, v119
    v_cvt_pk_bf16_f32 v46, v120, v121
    v_cvt_pk_bf16_f32 v47, v122, v123
    v_cvt_pk_bf16_f32 v48, v124, v125
    v_cvt_pk_bf16_f32 v49, v84, v85
    v_cvt_pk_bf16_f32 v50, v86, v87
    v_cvt_pk_bf16_f32 v51, v88, v89
    v_cvt_pk_bf16_f32 v52, v90, v91
    v_cvt_pk_bf16_f32 v53, v92, v93
    ds_write_b128 v8, v[44:47] offset:0
    ds_write_b128 v8, v[48:51] offset:32
    ds_write_b64 v9, v[52:53] offset:64
    v_max3_f32 v110, v100, v101, v102
    v_max3_f32 v111, -v100, -v101, -v102
    v_max3_f32 v110, v110, v103, v104
    v_max3_f32 v111, v111, -v103, -v104
    v_max3_f32 v110, v110, v105, v106
    v_max3_f32 v111, v111, -v105, -v106
    v_mfma_f32_32x32x16_bf16 v[84:99], a[216:219], v[72:75], 0
    v_max3_f32 v110, v110, v107, v108
    v_max3_f32 v111, v111, -v107, -v108
    v_max_f32 v110, v110, v109
    v_max_f32_e64 v111, v111, -v109
    s_nop 1
    v_permlane32_swap_b32 v110, v111
    v_max_f32 v110, v110, v111
    v_mul_f32 v110, v5, v110
    v_mov_b32 v112, v110
    s_nop 1
    v_permlane32_swap_b32 v110, v112
    v_pk_fma_f32 v[116:117], v[100:101], v[4:5], v[110:111] op_sel:[0,1,0] op_sel_hi:[1,1,0] neg_lo:[0,0,1] neg_hi:[0,0,1]
    v_pk_fma_f32 v[100:101], v[100:101], v[4:5], v[112:113] op_sel:[0,1,0] op_sel_hi:[1,1,0] neg_lo:[1,0,1] neg_hi:[1,0,1]
    v_pk_fma_f32 v[118:119], v[102:103], v[4:5], v[110:111] op_sel:[0,1,0] op_sel_hi:[1,1,0] neg_lo:[0,0,1] neg_hi:[0,0,1]
    v_pk_fma_f32 v[102:103], v[102:103], v[4:5], v[112:113] op_sel:[0,1,0] op_sel_hi:[1,1,0] neg_lo:[1,0,1] neg_hi:[1,0,1]
    v_pk_fma_f32 v[120:121], v[104:105], v[4:5], v[110:111] op_sel:[0,1,0] op_sel_hi:[1,1,0] neg_lo:[0,0,1] neg_hi:[0,0,1]
    v_pk_fma_f32 v[104:105], v[104:105], v[4:5], v[112:113] op_sel:[0,1,0] op_sel_hi:[1,1,0] neg_lo:[1,0,1] neg_hi:[1,0,1]
    v_pk_fma_f32 v[122:123], v[106:107], v[4:5], v[110:111] op_sel:[0,1,0] op_sel_hi:[1,1,0] neg_lo:[0,0,1] neg_hi:[0,0,1]
    v_pk_fma_f32 v[106:107], v[106:107], v[4:5], v[112:113] op_sel:[0,1,0] op_sel_hi:[1,1,0] neg_lo:[1,0,1] neg_hi:[1,0,1]
    v_pk_fma_f32 v[124:125], v[108:109], v[4:5], v[110:111] op_sel:[0,1,0] op_sel_hi:[1,1,0] neg_lo:[0,0,1] neg_hi:[0,0,1]
    v_mfma_f32_32x32x16_bf16 v[84:99], a[220:223], v[76:79], v[84:99]
    v_pk_fma_f32 v[108:109], v[108:109], v[4:5], v[112:113] op_sel:[0,1,0] op_sel_hi:[1,1,0] neg_lo:[1,0,1] neg_hi:[1,0,1]
    v_exp_f32 v116, v116
    v_exp_f32 v100, v100
    v_exp_f32 v117, v117
    v_exp_f32 v101, v101
    v_exp_f32 v118, v118
    v_exp_f32 v102, v102
    v_exp_f32 v119, v119
    v_exp_f32 v103, v103
    v_exp_f32 v120, v120
    v_exp_f32 v104, v104
    v_exp_f32 v121, v121
    v_exp_f32 v105, v105
    v_exp_f32 v122, v122
    v_exp_f32 v106, v106
    v_exp_f32 v123, v123
    v_exp_f32 v107, v107
    v_exp_f32 v124, v124
    v_exp_f32 v108, v108
    v_exp_f32 v125, v125
    v_exp_f32 v109, v109
    v_pk_add_f32 v[110:111], v[116:117], v[118:119]
    v_pk_add_f32 v[112:113], v[100:101], v[102:103]
    v_pk_add_f32 v[110:111], v[110:111], v[120:121]
    v_pk_add_f32 v[112:113], v[112:113], v[104:105]
    v_pk_add_f32 v[110:111], v[110:111], v[122:123]
    v_pk_add_f32 v[112:113], v[112:113], v[106:107]
    v_pk_add_f32 v[110:111], v[110:111], v[124:125]
    v_pk_add_f32 v[112:113], v[112:113], v[108:109]
    v_add_f32 v110, v110, v111
    v_add_f32 v112, v112, v113
    s_nop 1
    v_permlane32_swap_b32 v110, v112
    v_add_f32 v110, v110, v112
    v_rcp_f32 v110, v110
    s_nop 0
    v_mov_b32 v112, v110
    s_nop 1
    v_permlane32_swap_b32 v110, v112
    v_pk_mul_f32 v[116:117], v[116:117], v[110:111] op_sel_hi:[1,0]
    v_pk_mul_f32 v[100:101], v[100:101], v[112:113] op_sel_hi:[1,0]
    v_pk_mul_f32 v[118:119], v[118:119], v[110:111] op_sel_hi:[1,0]
    v_pk_mul_f32 v[102:103], v[102:103], v[112:113] op_sel_hi:[1,0]
    v_pk_mul_f32 v[120:121], v[120:121], v[110:111] op_sel_hi:[1,0]
    v_pk_mul_f32 v[104:105], v[104:105], v[112:113] op_sel_hi:[1,0]
    v_pk_mul_f32 v[122:123], v[122:123], v[110:111] op_sel_hi:[1,0]
    v_pk_mul_f32 v[106:107], v[106:107], v[112:113] op_sel_hi:[1,0]
    v_pk_mul_f32 v[124:125], v[124:125], v[110:111] op_sel_hi:[1,0]
    v_pk_mul_f32 v[108:109], v[108:109], v[112:113] op_sel_hi:[1,0]
    v_cvt_pk_bf16_f32 v44, v116, v117
    v_cvt_pk_bf16_f32 v45, v118, v119
    v_cvt_pk_bf16_f32 v46, v120, v121
    v_cvt_pk_bf16_f32 v47, v122, v123
    v_cvt_pk_bf16_f32 v48, v124, v125
    v_cvt_pk_bf16_f32 v49, v100, v101
    v_cvt_pk_bf16_f32 v50, v102, v103
    v_cvt_pk_bf16_f32 v51, v104, v105
    v_cvt_pk_bf16_f32 v52, v106, v107
    v_cvt_pk_bf16_f32 v53, v108, v109
    s_waitcnt lgkmcnt(14)
    ds_write_b128 v8, v[44:47] offset:80
    s_waitcnt lgkmcnt(14)
    ds_write_b128 v8, v[48:51] offset:112
    s_waitcnt lgkmcnt(14)
    ds_write_b64 v9, v[52:53] offset:144
    v_max3_f32 v94, v84, v85, v86
    v_max3_f32 v95, -v84, -v85, -v86
    v_max3_f32 v94, v94, v87, v88
    v_max3_f32 v95, v95, -v87, -v88
    v_max3_f32 v94, v94, v89, v90
    v_max3_f32 v95, v95, -v89, -v90
    v_mfma_f32_32x32x16_bf16 v[100:115], a[224:227], v[76:79], 0
    v_max3_f32 v94, v94, v91, v92
    v_max3_f32 v95, v95, -v91, -v92
    v_max_f32 v94, v94, v93
    v_max_f32_e64 v95, v95, -v93
    s_nop 1
    v_permlane32_swap_b32 v94, v95
    v_max_f32 v94, v94, v95
    v_mul_f32 v94, v5, v94
    v_mov_b32 v96, v94
    s_nop 1
    v_permlane32_swap_b32 v94, v96
    v_pk_fma_f32 v[116:117], v[84:85], v[4:5], v[94:95] op_sel:[0,1,0] op_sel_hi:[1,1,0] neg_lo:[0,0,1] neg_hi:[0,0,1]
    v_pk_fma_f32 v[84:85], v[84:85], v[4:5], v[96:97] op_sel:[0,1,0] op_sel_hi:[1,1,0] neg_lo:[1,0,1] neg_hi:[1,0,1]
    v_pk_fma_f32 v[118:119], v[86:87], v[4:5], v[94:95] op_sel:[0,1,0] op_sel_hi:[1,1,0] neg_lo:[0,0,1] neg_hi:[0,0,1]
    v_pk_fma_f32 v[86:87], v[86:87], v[4:5], v[96:97] op_sel:[0,1,0] op_sel_hi:[1,1,0] neg_lo:[1,0,1] neg_hi:[1,0,1]
    v_pk_fma_f32 v[120:121], v[88:89], v[4:5], v[94:95] op_sel:[0,1,0] op_sel_hi:[1,1,0] neg_lo:[0,0,1] neg_hi:[0,0,1]
    v_pk_fma_f32 v[88:89], v[88:89], v[4:5], v[96:97] op_sel:[0,1,0] op_sel_hi:[1,1,0] neg_lo:[1,0,1] neg_hi:[1,0,1]
    v_pk_fma_f32 v[122:123], v[90:91], v[4:5], v[94:95] op_sel:[0,1,0] op_sel_hi:[1,1,0] neg_lo:[0,0,1] neg_hi:[0,0,1]
    v_pk_fma_f32 v[90:91], v[90:91], v[4:5], v[96:97] op_sel:[0,1,0] op_sel_hi:[1,1,0] neg_lo:[1,0,1] neg_hi:[1,0,1]
    v_pk_fma_f32 v[124:125], v[92:93], v[4:5], v[94:95] op_sel:[0,1,0] op_sel_hi:[1,1,0] neg_lo:[0,0,1] neg_hi:[0,0,1]
    v_mfma_f32_32x32x16_bf16 v[100:115], a[228:231], v[80:83], v[100:115]
    v_pk_fma_f32 v[92:93], v[92:93], v[4:5], v[96:97] op_sel:[0,1,0] op_sel_hi:[1,1,0] neg_lo:[1,0,1] neg_hi:[1,0,1]
    v_exp_f32 v116, v116
    v_exp_f32 v84, v84
    v_exp_f32 v117, v117
    v_exp_f32 v85, v85
    v_exp_f32 v118, v118
    v_exp_f32 v86, v86
    v_exp_f32 v119, v119
    v_exp_f32 v87, v87
    v_exp_f32 v120, v120
    v_exp_f32 v88, v88
    v_exp_f32 v121, v121
    v_exp_f32 v89, v89
    v_exp_f32 v122, v122
    v_exp_f32 v90, v90
    v_exp_f32 v123, v123
    v_exp_f32 v91, v91
    v_exp_f32 v124, v124
    v_exp_f32 v92, v92
    v_exp_f32 v125, v125
    v_exp_f32 v93, v93
    v_pk_add_f32 v[94:95], v[116:117], v[118:119]
    v_pk_add_f32 v[96:97], v[84:85], v[86:87]
    v_pk_add_f32 v[94:95], v[94:95], v[120:121]
    v_pk_add_f32 v[96:97], v[96:97], v[88:89]
    v_pk_add_f32 v[94:95], v[94:95], v[122:123]
    v_pk_add_f32 v[96:97], v[96:97], v[90:91]
    v_pk_add_f32 v[94:95], v[94:95], v[124:125]
    v_pk_add_f32 v[96:97], v[96:97], v[92:93]
    v_add_f32 v94, v94, v95
    v_add_f32 v96, v96, v97
    s_nop 1
    v_permlane32_swap_b32 v94, v96
    v_add_f32 v94, v94, v96
    v_rcp_f32 v94, v94
    s_nop 0
    v_mov_b32 v96, v94
    s_nop 1
    v_permlane32_swap_b32 v94, v96
    v_pk_mul_f32 v[116:117], v[116:117], v[94:95] op_sel_hi:[1,0]
    v_pk_mul_f32 v[84:85], v[84:85], v[96:97] op_sel_hi:[1,0]
    v_pk_mul_f32 v[118:119], v[118:119], v[94:95] op_sel_hi:[1,0]
    v_pk_mul_f32 v[86:87], v[86:87], v[96:97] op_sel_hi:[1,0]
    v_pk_mul_f32 v[120:121], v[120:121], v[94:95] op_sel_hi:[1,0]
    v_pk_mul_f32 v[88:89], v[88:89], v[96:97] op_sel_hi:[1,0]
    v_pk_mul_f32 v[122:123], v[122:123], v[94:95] op_sel_hi:[1,0]
    v_pk_mul_f32 v[90:91], v[90:91], v[96:97] op_sel_hi:[1,0]
    v_pk_mul_f32 v[124:125], v[124:125], v[94:95] op_sel_hi:[1,0]
    v_pk_mul_f32 v[92:93], v[92:93], v[96:97] op_sel_hi:[1,0]
    v_cvt_pk_bf16_f32 v44, v116, v117
    v_cvt_pk_bf16_f32 v45, v118, v119
    v_cvt_pk_bf16_f32 v46, v120, v121
    v_cvt_pk_bf16_f32 v47, v122, v123
    v_cvt_pk_bf16_f32 v48, v124, v125
    v_cvt_pk_bf16_f32 v49, v84, v85
    v_cvt_pk_bf16_f32 v50, v86, v87
    v_cvt_pk_bf16_f32 v51, v88, v89
    v_cvt_pk_bf16_f32 v52, v90, v91
    v_cvt_pk_bf16_f32 v53, v92, v93
    s_waitcnt lgkmcnt(14)
    ds_write_b128 v8, v[44:47] offset:160
    s_waitcnt lgkmcnt(14)
    ds_write_b128 v8, v[48:51] offset:192
    s_waitcnt lgkmcnt(14)
    ds_write_b64 v9, v[52:53] offset:224
    v_max3_f32 v110, v100, v101, v102
    v_max3_f32 v111, -v100, -v101, -v102
    v_max3_f32 v110, v110, v103, v104
    v_max3_f32 v111, v111, -v103, -v104
    v_max3_f32 v110, v110, v105, v106
    v_max3_f32 v111, v111, -v105, -v106
    v_max3_f32 v110, v110, v107, v108
    v_max3_f32 v111, v111, -v107, -v108
    v_max_f32 v110, v110, v109
    v_max_f32_e64 v111, v111, -v109
    s_nop 1
    v_permlane32_swap_b32 v110, v111
    v_max_f32 v110, v110, v111
    v_mul_f32 v110, v5, v110
    v_mov_b32 v112, v110
    s_nop 1
    v_permlane32_swap_b32 v110, v112
    v_pk_fma_f32 v[116:117], v[100:101], v[4:5], v[110:111] op_sel:[0,1,0] op_sel_hi:[1,1,0] neg_lo:[0,0,1] neg_hi:[0,0,1]
    v_pk_fma_f32 v[100:101], v[100:101], v[4:5], v[112:113] op_sel:[0,1,0] op_sel_hi:[1,1,0] neg_lo:[1,0,1] neg_hi:[1,0,1]
    v_pk_fma_f32 v[118:119], v[102:103], v[4:5], v[110:111] op_sel:[0,1,0] op_sel_hi:[1,1,0] neg_lo:[0,0,1] neg_hi:[0,0,1]
    v_pk_fma_f32 v[102:103], v[102:103], v[4:5], v[112:113] op_sel:[0,1,0] op_sel_hi:[1,1,0] neg_lo:[1,0,1] neg_hi:[1,0,1]
    v_pk_fma_f32 v[120:121], v[104:105], v[4:5], v[110:111] op_sel:[0,1,0] op_sel_hi:[1,1,0] neg_lo:[0,0,1] neg_hi:[0,0,1]
    v_pk_fma_f32 v[104:105], v[104:105], v[4:5], v[112:113] op_sel:[0,1,0] op_sel_hi:[1,1,0] neg_lo:[1,0,1] neg_hi:[1,0,1]
    v_pk_fma_f32 v[122:123], v[106:107], v[4:5], v[110:111] op_sel:[0,1,0] op_sel_hi:[1,1,0] neg_lo:[0,0,1] neg_hi:[0,0,1]
    v_pk_fma_f32 v[106:107], v[106:107], v[4:5], v[112:113] op_sel:[0,1,0] op_sel_hi:[1,1,0] neg_lo:[1,0,1] neg_hi:[1,0,1]
    v_pk_fma_f32 v[124:125], v[108:109], v[4:5], v[110:111] op_sel:[0,1,0] op_sel_hi:[1,1,0] neg_lo:[0,0,1] neg_hi:[0,0,1]
    v_pk_fma_f32 v[108:109], v[108:109], v[4:5], v[112:113] op_sel:[0,1,0] op_sel_hi:[1,1,0] neg_lo:[1,0,1] neg_hi:[1,0,1]
    v_exp_f32 v116, v116
    v_exp_f32 v100, v100
    v_exp_f32 v117, v117
    v_exp_f32 v101, v101
    v_exp_f32 v118, v118
    v_exp_f32 v102, v102
    v_exp_f32 v119, v119
    v_exp_f32 v103, v103
    v_exp_f32 v120, v120
    v_exp_f32 v104, v104
    v_exp_f32 v121, v121
    v_exp_f32 v105, v105
    v_exp_f32 v122, v122
    v_exp_f32 v106, v106
    v_exp_f32 v123, v123
    v_exp_f32 v107, v107
    v_exp_f32 v124, v124
    v_exp_f32 v108, v108
    v_exp_f32 v125, v125
    v_exp_f32 v109, v109
    v_pk_add_f32 v[110:111], v[116:117], v[118:119]
    v_pk_add_f32 v[112:113], v[100:101], v[102:103]
    v_pk_add_f32 v[110:111], v[110:111], v[120:121]
    v_pk_add_f32 v[112:113], v[112:113], v[104:105]
    v_pk_add_f32 v[110:111], v[110:111], v[122:123]
    v_pk_add_f32 v[112:113], v[112:113], v[106:107]
    v_pk_add_f32 v[110:111], v[110:111], v[124:125]
    v_pk_add_f32 v[112:113], v[112:113], v[108:109]
    v_add_f32 v110, v110, v111
    v_add_f32 v112, v112, v113
    s_nop 1
    v_permlane32_swap_b32 v110, v112
    v_add_f32 v110, v110, v112
    v_rcp_f32 v110, v110
    s_nop 0
    v_mov_b32 v112, v110
    s_nop 1
    v_permlane32_swap_b32 v110, v112
    v_pk_mul_f32 v[116:117], v[116:117], v[110:111] op_sel_hi:[1,0]
    v_pk_mul_f32 v[100:101], v[100:101], v[112:113] op_sel_hi:[1,0]
    v_pk_mul_f32 v[118:119], v[118:119], v[110:111] op_sel_hi:[1,0]
    v_pk_mul_f32 v[102:103], v[102:103], v[112:113] op_sel_hi:[1,0]
    v_pk_mul_f32 v[120:121], v[120:121], v[110:111] op_sel_hi:[1,0]
    v_pk_mul_f32 v[104:105], v[104:105], v[112:113] op_sel_hi:[1,0]
    v_pk_mul_f32 v[122:123], v[122:123], v[110:111] op_sel_hi:[1,0]
    v_pk_mul_f32 v[106:107], v[106:107], v[112:113] op_sel_hi:[1,0]
    v_pk_mul_f32 v[124:125], v[124:125], v[110:111] op_sel_hi:[1,0]
    v_pk_mul_f32 v[108:109], v[108:109], v[112:113] op_sel_hi:[1,0]
    v_cvt_pk_bf16_f32 v44, v116, v117
    v_cvt_pk_bf16_f32 v45, v118, v119
    v_cvt_pk_bf16_f32 v46, v120, v121
    v_cvt_pk_bf16_f32 v47, v122, v123
    v_cvt_pk_bf16_f32 v48, v124, v125
    v_cvt_pk_bf16_f32 v49, v100, v101
    v_cvt_pk_bf16_f32 v50, v102, v103
    v_cvt_pk_bf16_f32 v51, v104, v105
    v_cvt_pk_bf16_f32 v52, v106, v107
    v_cvt_pk_bf16_f32 v53, v108, v109
    s_waitcnt lgkmcnt(14)
    ds_write_b128 v8, v[44:47] offset:240
    s_waitcnt lgkmcnt(14)
    ds_write_b128 v8, v[48:51] offset:272
    s_waitcnt lgkmcnt(14)
    ds_write_b64 v9, v[52:53] offset:304
    v_bfe_u32 v32, v1, 2, 2
    v_lshl_add_u32 v32, v3, 3, v32
    v_and_b32 v33, 3, v1
    v_bfe_u32 v34, v1, 4, 1
    v_mul_u32_u24 v35, 336, v32
    s_mul_i32 s41, s38, 80
    v_add_u32 v35, s41, v35
    v_lshl_add_u32 v35, v33, 3, v35
    v_lshl_add_u32 v36, v34, 5, v35
    v_add_u32 v37, 64, v35
    v_mul_u32_u24 v35, 208, v32
    s_mul_i32 s41, s38, 48
    s_add_u32 s41, s41, 43008
    v_add_u32 v35, s41, v35
    v_lshlrev_b32 v38, 3, v33
    v_min_u32 v39, 1, v33
    v_lshlrev_b32 v39, 3, v39
    v_add_u32 v39, 32, v39
    v_cmp_eq_u32 vcc, 0, v34
    s_nop 1
    v_cndmask_b32 v38, v39, v38, vcc
    v_add_u32 v38, v35, v38
    s_waitcnt vmcnt(6) lgkmcnt(0)
    s_barrier
    v_mov_b32 v0, 1
    buffer_atomic_add v0, v29, s[60:63], 0 offen
    ds_read_b64_tr_b16 v[64:65], v36 offset:0
    ds_read_b64_tr_b16 v[68:69], v37 offset:0
    ds_read_b64_tr_b16 v[72:73], v38 offset:0
    ds_read_b64_tr_b16 v[66:67], v36 offset:1344
    ds_read_b64_tr_b16 v[70:71], v37 offset:1344
    ds_read_b64_tr_b16 v[74:75], v38 offset:832
    ds_read_b64_tr_b16 v[76:77], v36 offset:5376
    ds_read_b64_tr_b16 v[80:81], v37 offset:5376
    ds_read_b64_tr_b16 v[84:85], v38 offset:3328
    ds_read_b64_tr_b16 v[78:79], v36 offset:6720
    ds_read_b64_tr_b16 v[82:83], v37 offset:6720
    ds_read_b64_tr_b16 v[86:87], v38 offset:4160
    s_waitcnt lgkmcnt(6)
    v_mfma_f32_32x32x16_bf16 v[96:111], v[64:67], v[72:75], 0
    v_mfma_f32_32x32x16_bf16 v[112:127], v[68:71], v[72:75], 0
    ds_read_b64_tr_b16 v[64:65], v36 offset:10752
    ds_read_b64_tr_b16 v[68:69], v37 offset:10752
    ds_read_b64_tr_b16 v[72:73], v38 offset:6656
    ds_read_b64_tr_b16 v[66:67], v36 offset:12096
    ds_read_b64_tr_b16 v[70:71], v37 offset:12096
    ds_read_b64_tr_b16 v[74:75], v38 offset:7488
    s_waitcnt lgkmcnt(6)
    v_mfma_f32_32x32x16_bf16 v[96:111], v[76:79], v[84:87], v[96:111]
    v_mfma_f32_32x32x16_bf16 v[112:127], v[80:83], v[84:87], v[112:127]
    ds_read_b64_tr_b16 v[76:77], v36 offset:16128
    ds_read_b64_tr_b16 v[80:81], v37 offset:16128
    ds_read_b64_tr_b16 v[84:85], v38 offset:9984
    ds_read_b64_tr_b16 v[78:79], v36 offset:17472
    ds_read_b64_tr_b16 v[82:83], v37 offset:17472
    ds_read_b64_tr_b16 v[86:87], v38 offset:10816
    s_waitcnt lgkmcnt(6)
    v_mfma_f32_32x32x16_bf16 v[96:111], v[64:67], v[72:75], v[96:111]
    v_mfma_f32_32x32x16_bf16 v[112:127], v[68:71], v[72:75], v[112:127]
    ds_read_b64_tr_b16 v[64:65], v36 offset:21504
    ds_read_b64_tr_b16 v[68:69], v37 offset:21504
    ds_read_b64_tr_b16 v[72:73], v38 offset:13312
    ds_read_b64_tr_b16 v[66:67], v36 offset:22848
    ds_read_b64_tr_b16 v[70:71], v37 offset:22848
    ds_read_b64_tr_b16 v[74:75], v38 offset:14144
    s_waitcnt lgkmcnt(6)
    v_mfma_f32_32x32x16_bf16 v[96:111], v[76:79], v[84:87], v[96:111]
    v_mfma_f32_32x32x16_bf16 v[112:127], v[80:83], v[84:87], v[112:127]
    ds_read_b64_tr_b16 v[76:77], v36 offset:26880
    ds_read_b64_tr_b16 v[80:81], v37 offset:26880
    ds_read_b64_tr_b16 v[84:85], v38 offset:16640
    ds_read_b64_tr_b16 v[78:79], v36 offset:28224
    ds_read_b64_tr_b16 v[82:83], v37 offset:28224
    ds_read_b64_tr_b16 v[86:87], v38 offset:17472
    s_waitcnt lgkmcnt(6)
    v_mfma_f32_32x32x16_bf16 v[96:111], v[64:67], v[72:75], v[96:111]
    v_mfma_f32_32x32x16_bf16 v[112:127], v[68:71], v[72:75], v[112:127]
    ds_read_b64_tr_b16 v[64:65], v36 offset:32256
    ds_read_b64_tr_b16 v[68:69], v37 offset:32256
    ds_read_b64_tr_b16 v[72:73], v38 offset:19968
    ds_read_b64_tr_b16 v[66:67], v36 offset:33600
    ds_read_b64_tr_b16 v[70:71], v37 offset:33600
    ds_read_b64_tr_b16 v[74:75], v38 offset:20800
    s_waitcnt lgkmcnt(6)
    v_mfma_f32_32x32x16_bf16 v[96:111], v[76:79], v[84:87], v[96:111]
    v_mfma_f32_32x32x16_bf16 v[112:127], v[80:83], v[84:87], v[112:127]
    ds_read_b64_tr_b16 v[76:77], v36 offset:37632
    ds_read_b64_tr_b16 v[80:81], v37 offset:37632
    ds_read_b64_tr_b16 v[84:85], v38 offset:23296
    ds_read_b64_tr_b16 v[78:79], v36 offset:38976
    ds_read_b64_tr_b16 v[82:83], v37 offset:38976
    ds_read_b64_tr_b16 v[86:87], v38 offset:24128
    s_waitcnt lgkmcnt(6)
    v_mfma_f32_32x32x16_bf16 v[96:111], v[64:67], v[72:75], v[96:111]
    v_mfma_f32_32x32x16_bf16 v[112:127], v[68:71], v[72:75], v[112:127]
    s_waitcnt lgkmcnt(0)
    v_mfma_f32_32x32x16_bf16 v[96:111], v[76:79], v[84:87], v[96:111]
    v_mfma_f32_32x32x16_bf16 v[112:127], v[80:83], v[84:87], v[112:127]
    s_waitcnt vmcnt(1)
    s_barrier
    ds_read_b64_tr_b16 a[160:161], v27 offset:16384
    ds_read_b64_tr_b16 a[162:163], v27 offset:17152
    ds_read_b64_tr_b16 a[164:165], v27 offset:16448
    ds_read_b64_tr_b16 a[166:167], v27 offset:17216
    ds_read_b64_tr_b16 a[168:169], v27 offset:16512
    ds_read_b64_tr_b16 a[170:171], v27 offset:17280
    ds_read_b64_tr_b16 a[172:173], v27 offset:19456
    ds_read_b64_tr_b16 a[174:175], v27 offset:20224
    ds_read_b64_tr_b16 a[176:177], v27 offset:19520
    ds_read_b64_tr_b16 a[178:179], v27 offset:20288
    ds_read_b64_tr_b16 a[180:181], v27 offset:19584
    ds_read_b64_tr_b16 a[182:183], v27 offset:20352
    v_lshlrev_b32 v40, 2, v2
    v_lshl_add_u32 v40, v3, 9, v40
    s_mul_i32 s41, s38, 5120
    v_add_u32 v40, s41, v40
    v_cmp_ge_u32 vcc, 20, v2
    v_mov_b32 v41, 0x40000000
    s_nop 0
    v_cndmask_b32 v40, v41, v40, vcc
    v_add_u32 v41, 4096, v40
    s_waitcnt lgkmcnt(6)
    v_mfma_f32_32x32x16_bf16 v[208:223], a[160:163], a[0:3], v[208:223]
    ds_read_b64_tr_b16 a[184:185], v27 offset:22528
    ds_read_b64_tr_b16 a[186:187], v27 offset:23296
    v_mfma_f32_32x32x16_bf16 v[224:239], a[164:167], a[0:3], v[224:239]
    ds_read_b64_tr_b16 a[188:189], v27 offset:22592
    ds_read_b64_tr_b16 a[190:191], v27 offset:23360
    s_mul_i32 s8, s83, 1920
    s_add_u32 m0, s74, 0
    s_nop 0
    buffer_load_dwordx4 v21, s[48:51], s8 offen offset:0 lds
    v_mfma_f32_32x32x16_bf16 v[240:255], a[168:171], a[0:3], v[240:255]
    ds_read_b64_tr_b16 a[192:193], v27 offset:22656
    ds_read_b64_tr_b16 a[194:195], v27 offset:23424
    buffer_load_dwordx4 v22, s[48:51], s8 offen offset:1024 lds
    s_waitcnt lgkmcnt(6)
    v_mfma_f32_32x32x16_bf16 v[208:223], a[172:175], a[4:7], v[208:223]
    ds_read_b64_tr_b16 a[160:161], v27 offset:25600
    ds_read_b64_tr_b16 a[162:163], v27 offset:26368
    buffer_load_dwordx4 v23, s[48:51], s8 offen offset:2048 lds
    v_mfma_f32_32x32x16_bf16 v[224:239], a[176:179], a[4:7], v[224:239]
    ds_read_b64_tr_b16 a[164:165], v27 offset:25664
    ds_read_b64_tr_b16 a[166:167], v27 offset:26432
    s_mul_i32 s8, s84, 1920
    s_add_u32 m0, s74, 12288
    s_nop 0
    buffer_load_dwordx4 v21, s[48:51], s8 offen offset:0 lds
    v_mfma_f32_32x32x16_bf16 v[240:255], a[180:183], a[4:7], v[240:255]
    ds_read_b64_tr_b16 a[168:169], v27 offset:25728
    ds_read_b64_tr_b16 a[170:171], v27 offset:26496
    buffer_load_dwordx4 v22, s[48:51], s8 offen offset:1024 lds
    s_waitcnt lgkmcnt(6)
    v_mfma_f32_32x32x16_bf16 v[208:223], a[184:187], a[8:11], v[208:223]
    ds_read_b64_tr_b16 a[172:173], v28 offset:0
    ds_read_b64_tr_b16 a[174:175], v28 offset:768
    buffer_load_dwordx4 v23, s[48:51], s8 offen offset:2048 lds
    v_mfma_f32_32x32x16_bf16 v[224:239], a[188:191], a[8:11], v[224:239]
    ds_read_b64_tr_b16 a[176:177], v28 offset:64
    ds_read_b64_tr_b16 a[178:179], v28 offset:832
    s_mul_i32 s8, s85, 1920
    s_add_u32 m0, s74, 24576
    s_nop 0
    buffer_load_dwordx4 v21, s[48:51], s8 offen offset:0 lds
    v_mfma_f32_32x32x16_bf16 v[240:255], a[192:195], a[8:11], v[240:255]
    ds_read_b64_tr_b16 a[180:181], v28 offset:128
    ds_read_b64_tr_b16 a[182:183], v28 offset:896
    buffer_load_dwordx4 v22, s[48:51], s8 offen offset:1024 lds
    s_waitcnt lgkmcnt(6)
    v_mfma_f32_32x32x16_bf16 v[208:223], a[160:163], a[12:15], v[208:223]
    ds_read_b64_tr_b16 a[184:185], v28 offset:3072
    ds_read_b64_tr_b16 a[186:187], v28 offset:3840
    buffer_load_dwordx4 v23, s[48:51], s8 offen offset:2048 lds
    s_lshl_b32 s64, s86, 12
    s_add_u32 s64, s64, 2304
    v_mfma_f32_32x32x16_bf16 v[224:239], a[164:167], a[12:15], v[224:239]
    ds_read_b64_tr_b16 a[188:189], v28 offset:3136
    ds_read_b64_tr_b16 a[190:191], v28 offset:3904
    v_min_u32 v31, 7, v1
    v_lshl_add_u32 v30, v31, 7, s64
    v_lshrrev_b32 v31, 2, v31
    v_mul_u32_u24 v31, v31, v31
    v_sub_u32 v31, 14, v31
    buffer_load_dword v63, v30, s[60:63], s73 offen sc1
    v_mfma_f32_32x32x16_bf16 v[240:255], a[168:171], a[12:15], v[240:255]
    ds_read_b64_tr_b16 a[192:193], v28 offset:3200
    ds_read_b64_tr_b16 a[194:195], v28 offset:3968
    buffer_atomic_add_f32 v96, v40, s[24:27], 0 offen offset:0
    s_waitcnt lgkmcnt(6)
    v_mfma_f32_32x32x16_bf16 v[208:223], a[172:175], a[16:19], v[208:223]
    ds_read_b64_tr_b16 a[160:161], v28 offset:6144
    ds_read_b64_tr_b16 a[162:163], v28 offset:6912
    v_mfma_f32_32x32x16_bf16 v[224:239], a[176:179], a[16:19], v[224:239]
    ds_read_b64_tr_b16 a[164:165], v28 offset:6208
    ds_read_b64_tr_b16 a[166:167], v28 offset:6976
    buffer_atomic_add_f32 v97, v40, s[24:27], 0 offen offset:128
    v_mfma_f32_32x32x16_bf16 v[240:255], a[180:183], a[16:19], v[240:255]
    ds_read_b64_tr_b16 a[168:169], v28 offset:6272
    ds_read_b64_tr_b16 a[170:171], v28 offset:7040
    buffer_atomic_add_f32 v98, v40, s[24:27], 0 offen offset:256
    s_waitcnt lgkmcnt(6)
    v_mfma_f32_32x32x16_bf16 v[208:223], a[184:187], a[20:23], v[208:223]
    ds_read_b64_tr_b16 a[172:173], v28 offset:9216
    ds_read_b64_tr_b16 a[174:175], v28 offset:9984
    v_mfma_f32_32x32x16_bf16 v[224:239], a[188:191], a[20:23], v[224:239]
    ds_read_b64_tr_b16 a[176:177], v28 offset:9280
    ds_read_b64_tr_b16 a[178:179], v28 offset:10048
    buffer_atomic_add_f32 v99, v40, s[24:27], 0 offen offset:384
    v_mfma_f32_32x32x16_bf16 v[240:255], a[192:195], a[20:23], v[240:255]
    ds_read_b64_tr_b16 a[180:181], v28 offset:9344
    ds_read_b64_tr_b16 a[182:183], v28 offset:10112
    buffer_atomic_add_f32 v100, v40, s[24:27], 0 offen offset:1024
    s_waitcnt lgkmcnt(6)
    v_mfma_f32_32x32x16_bf16 v[208:223], a[160:163], a[24:27], v[208:223]
    ds_read_b64_tr_b16 a[184:185], v28 offset:12288
    ds_read_b64_tr_b16 a[186:187], v28 offset:13056
    buffer_atomic_add_f32 v101, v40, s[24:27], 0 offen offset:1152
    v_mfma_f32_32x32x16_bf16 v[224:239], a[164:167], a[24:27], v[224:239]
    ds_read_b64_tr_b16 a[188:189], v28 offset:12352
    ds_read_b64_tr_b16 a[190:191], v28 offset:13120
    buffer_atomic_add_f32 v102, v40, s[24:27], 0 offen offset:1280
    v_mfma_f32_32x32x16_bf16 v[240:255], a[168:171], a[24:27], v[240:255]
    ds_read_b64_tr_b16 a[192:193], v28 offset:12416
    ds_read_b64_tr_b16 a[194:195], v28 offset:13184
    buffer_atomic_add_f32 v103, v40, s[24:27], 0 offen offset:1408
    s_waitcnt lgkmcnt(6)
    v_mfma_f32_32x32x16_bf16 v[208:223], a[172:175], a[28:31], v[208:223]
    ds_read_b64_tr_b16 a[160:161], v28 offset:15360
    ds_read_b64_tr_b16 a[162:163], v28 offset:16128
    buffer_atomic_add_f32 v104, v40, s[24:27], 0 offen offset:2048
    v_mfma_f32_32x32x16_bf16 v[224:239], a[176:179], a[28:31], v[224:239]
    ds_read_b64_tr_b16 a[164:165], v28 offset:15424
    ds_read_b64_tr_b16 a[166:167], v28 offset:16192
    buffer_atomic_add_f32 v105, v40, s[24:27], 0 offen offset:2176
    v_mfma_f32_32x32x16_bf16 v[240:255], a[180:183], a[28:31], v[240:255]
    ds_read_b64_tr_b16 a[168:169], v28 offset:15488
    ds_read_b64_tr_b16 a[170:171], v28 offset:16256
    buffer_atomic_add_f32 v106, v40, s[24:27], 0 offen offset:2304
    s_waitcnt lgkmcnt(6)
    v_mfma_f32_32x32x16_bf16 v[208:223], a[184:187], a[32:35], v[208:223]
    ds_read_b64_tr_b16 a[172:173], v28 offset:18432
    ds_read_b64_tr_b16 a[174:175], v28 offset:19200
    buffer_atomic_add_f32 v107, v40, s[24:27], 0 offen offset:2432
    v_mfma_f32_32x32x16_bf16 v[224:239], a[188:191], a[32:35], v[224:239]
    ds_read_b64_tr_b16 a[176:177], v28 offset:18496
    ds_read_b64_tr_b16 a[178:179], v28 offset:19264
    buffer_atomic_add_f32 v108, v40, s[24:27], 0 offen offset:3072
    v_mfma_f32_32x32x16_bf16 v[240:255], a[192:195], a[32:35], v[240:255]
    ds_read_b64_tr_b16 a[180:181], v28 offset:18560
    ds_read_b64_tr_b16 a[182:183], v28 offset:19328
    buffer_atomic_add_f32 v109, v40, s[24:27], 0 offen offset:3200
    s_waitcnt lgkmcnt(6)
    v_mfma_f32_32x32x16_bf16 v[208:223], a[160:163], a[36:39], v[208:223]
    ds_read_b64_tr_b16 a[184:185], v28 offset:21504
    ds_read_b64_tr_b16 a[186:187], v28 offset:22272
    buffer_atomic_add_f32 v110, v40, s[24:27], 0 offen offset:3328
    v_mfma_f32_32x32x16_bf16 v[224:239], a[164:167], a[36:39], v[224:239]
    ds_read_b64_tr_b16 a[188:189], v28 offset:21568
    ds_read_b64_tr_b16 a[190:191], v28 offset:22336
    buffer_atomic_add_f32 v111, v40, s[24:27], 0 offen offset:3456
    v_mfma_f32_32x32x16_bf16 v[240:255], a[168:171], a[36:39], v[240:255]
    ds_read_b64_tr_b16 a[192:193], v28 offset:21632
    ds_read_b64_tr_b16 a[194:195], v28 offset:22400
    buffer_atomic_add_f32 v112, v41, s[24:27], 0 offen offset:0
    s_waitcnt lgkmcnt(6)
    v_mfma_f32_32x32x16_bf16 v[208:223], a[172:175], a[40:43], v[208:223]
    ds_read_b64_tr_b16 a[160:161], v27 offset:4096
    ds_read_b64_tr_b16 a[162:163], v27 offset:4864
    buffer_atomic_add_f32 v113, v41, s[24:27], 0 offen offset:128
    v_mfma_f32_32x32x16_bf16 v[224:239], a[176:179], a[40:43], v[224:239]
    ds_read_b64_tr_b16 a[164:165], v27 offset:4160
    ds_read_b64_tr_b16 a[166:167], v27 offset:4928
    buffer_atomic_add_f32 v114, v41, s[24:27], 0 offen offset:256
    v_mfma_f32_32x32x16_bf16 v[240:255], a[180:183], a[40:43], v[240:255]
    ds_read_b64_tr_b16 a[168:169], v27 offset:4224
    ds_read_b64_tr_b16 a[170:171], v27 offset:4992
    buffer_atomic_add_f32 v115, v41, s[24:27], 0 offen offset:384
    s_waitcnt lgkmcnt(6)
    v_mfma_f32_32x32x16_bf16 v[208:223], a[184:187], a[44:47], v[208:223]
    ds_read_b64_tr_b16 a[172:173], v27 offset:7168
    ds_read_b64_tr_b16 a[174:175], v27 offset:7936
    v_mfma_f32_32x32x16_bf16 v[224:239], a[188:191], a[44:47], v[224:239]
    ds_read_b64_tr_b16 a[176:177], v27 offset:7232
    ds_read_b64_tr_b16 a[178:179], v27 offset:8000
    v_lshlrev_b32 v12, 4, v1
    v_mfma_f32_32x32x16_bf16 v[240:255], a[192:195], a[44:47], v[240:255]
    ds_read_b64_tr_b16 a[180:181], v27 offset:7296
    ds_read_b64_tr_b16 a[182:183], v27 offset:8064
    v_add_u32 v13, 0x10000, v12
    s_waitcnt lgkmcnt(6)
    v_mfma_f32_32x32x16_bf16 v[208:223], a[160:163], a[48:51], v[208:223]
    ds_read_b64_tr_b16 a[184:185], v27 offset:10240
    ds_read_b64_tr_b16 a[186:187], v27 offset:11008
    v_mfma_f32_32x32x16_bf16 v[224:239], a[164:167], a[48:51], v[224:239]
    ds_read_b64_tr_b16 a[188:189], v27 offset:10304
    ds_read_b64_tr_b16 a[190:191], v27 offset:11072
    v_add_u32 v14, 0x20000, v12
    v_mfma_f32_32x32x16_bf16 v[240:255], a[168:171], a[48:51], v[240:255]
    ds_read_b64_tr_b16 a[192:193], v27 offset:10368
    ds_read_b64_tr_b16 a[194:195], v27 offset:11136
    v_add_u32 v15, 75776, v12
    s_waitcnt lgkmcnt(6)
    v_mfma_f32_32x32x16_bf16 v[208:223], a[172:175], a[52:55], v[208:223]
    ds_read_b64_tr_b16 a[160:161], v27 offset:13312
    ds_read_b64_tr_b16 a[162:163], v27 offset:14080
    v_mfma_f32_32x32x16_bf16 v[224:239], a[176:179], a[52:55], v[224:239]
    ds_read_b64_tr_b16 a[164:165], v27 offset:13376
    ds_read_b64_tr_b16 a[166:167], v27 offset:14144
    s_mul_i32 s64, s87, 378880
    v_mfma_f32_32x32x16_bf16 v[240:255], a[180:183], a[52:55], v[240:255]
    ds_read_b64_tr_b16 a[168:169], v27 offset:13440
    ds_read_b64_tr_b16 a[170:171], v27 offset:14208
    s_add_u32 s64, s64, 10485760
    s_waitcnt lgkmcnt(6)
    v_mfma_f32_32x32x16_bf16 v[208:223], a[184:187], a[56:59], v[208:223]
    ds_read_b64_tr_b16 a[172:173], v27 offset:28672
    ds_read_b64_tr_b16 a[174:175], v27 offset:29440
    v_mfma_f32_32x32x16_bf16 v[224:239], a[188:191], a[56:59], v[224:239]
    ds_read_b64_tr_b16 a[176:177], v27 offset:28736
    ds_read_b64_tr_b16 a[178:179], v27 offset:29504
    s_add_u32 s44, s36, s64
    s_addc_u32 s45, s37, 0
    v_mfma_f32_32x32x16_bf16 v[240:255], a[192:195], a[56:59], v[240:255]
    ds_read_b64_tr_b16 a[180:181], v27 offset:28800
    ds_read_b64_tr_b16 a[182:183], v27 offset:29568
    s_mov_b32 s46, 378880
    s_waitcnt lgkmcnt(6)
    v_mfma_f32_32x32x16_bf16 v[208:223], a[160:163], a[60:63], v[208:223]
    ds_read_b64_tr_b16 a[184:185], v27 offset:31744
    ds_read_b64_tr_b16 a[186:187], v27 offset:32512
    v_mfma_f32_32x32x16_bf16 v[224:239], a[164:167], a[60:63], v[224:239]
    ds_read_b64_tr_b16 a[188:189], v27 offset:31808
    ds_read_b64_tr_b16 a[190:191], v27 offset:32576
    s_mov_b32 s47, 0x00020000
    v_mfma_f32_32x32x16_bf16 v[240:255], a[168:171], a[60:63], v[240:255]
    ds_read_b64_tr_b16 a[192:193], v27 offset:31872
    ds_read_b64_tr_b16 a[194:195], v27 offset:32640
    s_lshl_b32 s64, s86, 2
    s_waitcnt lgkmcnt(6)
    v_mfma_f32_32x32x16_bf16 v[208:223], a[172:175], a[64:67], v[208:223]
    ds_read_b64_tr_b16 a[160:161], v27 offset:34816
    ds_read_b64_tr_b16 a[162:163], v27 offset:35584
    v_mfma_f32_32x32x16_bf16 v[224:239], a[176:179], a[64:67], v[224:239]
    ds_read_b64_tr_b16 a[164:165], v27 offset:34880
    ds_read_b64_tr_b16 a[166:167], v27 offset:35648
    s_add_u32 s64, s64, s38
    v_mfma_f32_32x32x16_bf16 v[240:255], a[180:183], a[64:67], v[240:255]
    ds_read_b64_tr_b16 a[168:169], v27 offset:34944
    ds_read_b64_tr_b16 a[170:171], v27 offset:35712
    s_mul_i32 s64, s64, 151552
    s_waitcnt lgkmcnt(6)
    v_mfma_f32_32x32x16_bf16 v[208:223], a[184:187], a[68:71], v[208:223]
    ds_read_b64_tr_b16 a[172:173], v27 offset:37888
    ds_read_b64_tr_b16 a[174:175], v27 offset:38656
    v_mfma_f32_32x32x16_bf16 v[224:239], a[188:191], a[68:71], v[224:239]
    ds_read_b64_tr_b16 a[176:177], v27 offset:37952
    ds_read_b64_tr_b16 a[178:179], v27 offset:38720
    s_add_u32 s52, s36, s64
    s_addc_u32 s53, s37, 0
    v_mfma_f32_32x32x16_bf16 v[240:255], a[192:195], a[68:71], v[240:255]
    ds_read_b64_tr_b16 a[180:181], v27 offset:38016
    ds_read_b64_tr_b16 a[182:183], v27 offset:38784
    s_mov_b32 s54, 151552
    s_waitcnt lgkmcnt(6)
    v_mfma_f32_32x32x16_bf16 v[208:223], a[160:163], a[72:75], v[208:223]
    ds_read_b64_tr_b16 a[184:185], v27 offset:40960
    ds_read_b64_tr_b16 a[186:187], v27 offset:41728
    v_mfma_f32_32x32x16_bf16 v[224:239], a[164:167], a[72:75], v[224:239]
    ds_read_b64_tr_b16 a[188:189], v27 offset:41024
    ds_read_b64_tr_b16 a[190:191], v27 offset:41792
    s_mov_b32 s55, 0x00020000
    v_mfma_f32_32x32x16_bf16 v[240:255], a[168:171], a[72:75], v[240:255]
    ds_read_b64_tr_b16 a[192:193], v27 offset:41088
    ds_read_b64_tr_b16 a[194:195], v27 offset:41856
    s_add_u32 s88, s87, s86
    s_waitcnt lgkmcnt(6)
    v_mfma_f32_32x32x16_bf16 v[208:223], a[172:175], a[76:79], v[208:223]
    ds_read_b64_tr_b16 a[160:161], v27 offset:44032
    ds_read_b64_tr_b16 a[162:163], v27 offset:44800
    v_mfma_f32_32x32x16_bf16 v[224:239], a[176:179], a[76:79], v[224:239]
    ds_read_b64_tr_b16 a[164:165], v27 offset:44096
    ds_read_b64_tr_b16 a[166:167], v27 offset:44864
    s_mul_i32 s69, s88, 86
    v_mfma_f32_32x32x16_bf16 v[240:255], a[180:183], a[76:79], v[240:255]
    ds_read_b64_tr_b16 a[168:169], v27 offset:44160
    ds_read_b64_tr_b16 a[170:171], v27 offset:44928
    s_lshr_b32 s69, s69, 8
    s_waitcnt lgkmcnt(6)
    v_mfma_f32_32x32x16_bf16 v[208:223], a[184:187], a[80:83], v[208:223]
    ds_read_b64_tr_b16 a[172:173], v27 offset:47104
    ds_read_b64_tr_b16 a[174:175], v27 offset:47872
    v_mfma_f32_32x32x16_bf16 v[224:239], a[188:191], a[80:83], v[224:239]
    ds_read_b64_tr_b16 a[176:177], v27 offset:47168
    ds_read_b64_tr_b16 a[178:179], v27 offset:47936
    s_mul_i32 s69, s69, 3
    v_mfma_f32_32x32x16_bf16 v[240:255], a[192:195], a[80:83], v[240:255]
    ds_read_b64_tr_b16 a[180:181], v27 offset:47232
    ds_read_b64_tr_b16 a[182:183], v27 offset:48000
    s_sub_u32 s88, s88, s69
    s_waitcnt lgkmcnt(6)
    v_mfma_f32_32x32x16_bf16 v[208:223], a[160:163], a[84:87], v[208:223]
    ds_read_b64_tr_b16 a[184:185], v27 offset:50176
    ds_read_b64_tr_b16 a[186:187], v27 offset:50944
    v_mfma_f32_32x32x16_bf16 v[224:239], a[164:167], a[84:87], v[224:239]
    ds_read_b64_tr_b16 a[188:189], v27 offset:50240
    ds_read_b64_tr_b16 a[190:191], v27 offset:51008
    s_add_u32 s75, s87, s86
    v_mfma_f32_32x32x16_bf16 v[240:255], a[168:171], a[84:87], v[240:255]
    ds_read_b64_tr_b16 a[192:193], v27 offset:50304
    ds_read_b64_tr_b16 a[194:195], v27 offset:51072
    s_mul_i32 s69, s75, 52
    s_waitcnt lgkmcnt(6)
    v_mfma_f32_32x32x16_bf16 v[208:223], a[172:175], a[88:91], v[208:223]
    ds_read_b64_tr_b16 a[160:161], v27 offset:53248
    ds_read_b64_tr_b16 a[162:163], v27 offset:54016
    v_mfma_f32_32x32x16_bf16 v[224:239], a[176:179], a[88:91], v[224:239]
    ds_read_b64_tr_b16 a[164:165], v27 offset:53312
    ds_read_b64_tr_b16 a[166:167], v27 offset:54080
    s_lshr_b32 s69, s69, 8
    s_mul_i32 s69, s69, 5
    v_mfma_f32_32x32x16_bf16 v[240:255], a[180:183], a[88:91], v[240:255]
    ds_read_b64_tr_b16 a[168:169], v27 offset:53376
    ds_read_b64_tr_b16 a[170:171], v27 offset:54144
    s_sub_u32 s75, s75, s69
    s_waitcnt lgkmcnt(6)
    v_mfma_f32_32x32x16_bf16 v[208:223], a[184:187], a[92:95], v[208:223]
    ds_read_b64_tr_b16 a[172:173], v27 offset:56320
    ds_read_b64_tr_b16 a[174:175], v27 offset:57088
    v_mfma_f32_32x32x16_bf16 v[224:239], a[188:191], a[92:95], v[224:239]
    ds_read_b64_tr_b16 a[176:177], v27 offset:56384
    ds_read_b64_tr_b16 a[178:179], v27 offset:57152
    v_mfma_f32_32x32x16_bf16 v[240:255], a[192:195], a[92:95], v[240:255]
    ds_read_b64_tr_b16 a[180:181], v27 offset:56448
    ds_read_b64_tr_b16 a[182:183], v27 offset:57216
    s_waitcnt lgkmcnt(6)
    v_mfma_f32_32x32x16_bf16 v[208:223], a[160:163], a[96:99], v[208:223]
    ds_read_b64_tr_b16 a[184:185], v27 offset:59392
    ds_read_b64_tr_b16 a[186:187], v27 offset:60160
    v_mfma_f32_32x32x16_bf16 v[224:239], a[164:167], a[96:99], v[224:239]
    ds_read_b64_tr_b16 a[188:189], v27 offset:59456
    ds_read_b64_tr_b16 a[190:191], v27 offset:60224
    v_mfma_f32_32x32x16_bf16 v[240:255], a[168:171], a[96:99], v[240:255]
    ds_read_b64_tr_b16 a[192:193], v27 offset:59520
    ds_read_b64_tr_b16 a[194:195], v27 offset:60288
    s_waitcnt lgkmcnt(6)
    v_mfma_f32_32x32x16_bf16 v[208:223], a[172:175], a[100:103], v[208:223]
    ds_read_b64_tr_b16 a[160:161], v27 offset:62464
    ds_read_b64_tr_b16 a[162:163], v27 offset:63232
    v_mfma_f32_32x32x16_bf16 v[224:239], a[176:179], a[100:103], v[224:239]
    ds_read_b64_tr_b16 a[164:165], v27 offset:62528
    ds_read_b64_tr_b16 a[166:167], v27 offset:63296
    v_mfma_f32_32x32x16_bf16 v[240:255], a[180:183], a[100:103], v[240:255]
    ds_read_b64_tr_b16 a[168:169], v27 offset:62592
    ds_read_b64_tr_b16 a[170:171], v27 offset:63360
    s_waitcnt vmcnt(20)
    v_cmp_le_u32 vcc, v31, v63
    s_nop 1
    s_cmp_eq_u64 vcc, -1
    s_cbranch_scc1 L_wd_10_ok
    s_cmp_lg_u32 s38, 0
    s_cbranch_scc1 L_wd_10_ok
    s_mov_b32 s69, 0
L_wd_10_spin:
    buffer_load_dword v63, v30, s[60:63], 0 offen sc1
    s_waitcnt vmcnt(0)
    v_cmp_le_u32 vcc, v31, v63
    s_nop 1
    s_cmp_eq_u64 vcc, -1
    s_cbranch_scc1 L_wd_10_ok
    s_sleep 2
    s_add_u32 s69, s69, 1
    s_cmp_lt_u32 s69, 0x4000
    s_cbranch_scc1 L_wd_10_spin
L_wd_10_ok:
    s_waitcnt lgkmcnt(0)
    v_mfma_f32_32x32x16_bf16 v[208:223], a[184:187], a[104:107], v[208:223]
    s_barrier
    ds_read_b64_tr_b16 a[172:173], v26 offset:0
    ds_read_b64_tr_b16 a[174:175], v26 offset:768
    v_mfma_f32_32x32x16_bf16 v[224:239], a[188:191], a[104:107], v[224:239]
    ds_read_b64_tr_b16 a[176:177], v26 offset:64
    ds_read_b64_tr_b16 a[178:179], v26 offset:832
    v_mfma_f32_32x32x16_bf16 v[240:255], a[192:195], a[104:107], v[240:255]
    ds_read_b64_tr_b16 a[180:181], v26 offset:128
    ds_read_b64_tr_b16 a[182:183], v26 offset:896
    v_mfma_f32_32x32x16_bf16 v[208:223], a[160:163], a[108:111], v[208:223]
    ds_read_b64_tr_b16 a[184:185], v26 offset:3072
    ds_read_b64_tr_b16 a[186:187], v26 offset:3840
    s_add_u32 s72, s88, 0
    s_cmp_ge_u32 s72, 3
    s_cselect_b32 s69, 3, 0
    s_sub_u32 s72, s72, s69
    s_mul_i32 s72, s72, 20480
    s_add_u32 m0, s3, 81920
    s_add_u32 s72, s72, s3
    buffer_load_dwordx4 v12, s[44:47], s72 offen offset:0 sc1 lds
    v_mfma_f32_32x32x16_bf16 v[224:239], a[164:167], a[108:111], v[224:239]
    ds_read_b64_tr_b16 a[188:189], v26 offset:3136
    ds_read_b64_tr_b16 a[190:191], v26 offset:3904
    v_mfma_f32_32x32x16_bf16 v[240:255], a[168:171], a[108:111], v[240:255]
    ds_read_b64_tr_b16 a[192:193], v26 offset:3200
    ds_read_b64_tr_b16 a[194:195], v26 offset:3968
    buffer_load_dwordx4 v12, s[44:47], s72 offen offset:1024 sc1 lds
    s_waitcnt lgkmcnt(6)
    v_mfma_f32_32x32x16_bf16 v[208:223], a[172:175], a[112:115], v[208:223]
    ds_read_b64_tr_b16 a[160:161], v26 offset:6144
    ds_read_b64_tr_b16 a[162:163], v26 offset:6912
    buffer_load_dwordx4 v12, s[44:47], s72 offen offset:2048 sc1 lds
    v_mfma_f32_32x32x16_bf16 v[224:239], a[176:179], a[112:115], v[224:239]
    ds_read_b64_tr_b16 a[164:165], v26 offset:6208
    ds_read_b64_tr_b16 a[166:167], v26 offset:6976
    v_mfma_f32_32x32x16_bf16 v[240:255], a[180:183], a[112:115], v[240:255]
    ds_read_b64_tr_b16 a[168:169], v26 offset:6272
    ds_read_b64_tr_b16 a[170:171], v26 offset:7040
    buffer_load_dwordx4 v12, s[44:47], s72 offen offset:3072 sc1 lds
    s_waitcnt lgkmcnt(6)
    v_mfma_f32_32x32x16_bf16 v[208:223], a[184:187], a[116:119], v[208:223]
    ds_read_b64_tr_b16 a[172:173], v26 offset:9216
    ds_read_b64_tr_b16 a[174:175], v26 offset:9984
    s_add_u32 m0, s3, 86016
    s_add_u32 s72, s72, 4096
    buffer_load_dwordx4 v12, s[44:47], s72 offen offset:0 sc1 lds
    v_mfma_f32_32x32x16_bf16 v[224:239], a[188:191], a[116:119], v[224:239]
    ds_read_b64_tr_b16 a[176:177], v26 offset:9280
    ds_read_b64_tr_b16 a[178:179], v26 offset:10048
    v_mfma_f32_32x32x16_bf16 v[240:255], a[192:195], a[116:119], v[240:255]
    ds_read_b64_tr_b16 a[180:181], v26 offset:9344
    ds_read_b64_tr_b16 a[182:183], v26 offset:10112
    s_add_u32 s72, s88, 1
    s_cmp_ge_u32 s72, 3
    s_cselect_b32 s69, 3, 0
    s_sub_u32 s72, s72, s69
    s_mul_i32 s72, s72, 20480
    s_add_u32 m0, s3, 102400
    s_add_u32 s72, s72, s3
    buffer_load_dwordx4 v12, s[44:47], s72 offen offset:0 sc1 lds
    s_waitcnt lgkmcnt(6)
    v_mfma_f32_32x32x16_bf16 v[208:223], a[160:163], a[120:123], v[208:223]
    ds_read_b64_tr_b16 a[184:185], v26 offset:12288
    ds_read_b64_tr_b16 a[186:187], v26 offset:13056
    buffer_load_dwordx4 v12, s[44:47], s72 offen offset:1024 sc1 lds
    v_mfma_f32_32x32x16_bf16 v[224:239], a[164:167], a[120:123], v[224:239]
    ds_read_b64_tr_b16 a[188:189], v26 offset:12352
    ds_read_b64_tr_b16 a[190:191], v26 offset:13120
    v_mfma_f32_32x32x16_bf16 v[240:255], a[168:171], a[120:123], v[240:255]
    ds_read_b64_tr_b16 a[192:193], v26 offset:12416
    ds_read_b64_tr_b16 a[194:195], v26 offset:13184
    buffer_load_dwordx4 v12, s[44:47], s72 offen offset:2048 sc1 lds
    s_waitcnt lgkmcnt(6)
    v_mfma_f32_32x32x16_bf16 v[208:223], a[172:175], a[124:127], v[208:223]
    ds_read_b64_tr_b16 a[160:161], v26 offset:15360
    ds_read_b64_tr_b16 a[162:163], v26 offset:16128
    buffer_load_dwordx4 v12, s[44:47], s72 offen offset:3072 sc1 lds
    v_mfma_f32_32x32x16_bf16 v[224:239], a[176:179], a[124:127], v[224:239]
    ds_read_b64_tr_b16 a[164:165], v26 offset:15424
    ds_read_b64_tr_b16 a[166:167], v26 offset:16192
    v_mfma_f32_32x32x16_bf16 v[240:255], a[180:183], a[124:127], v[240:255]
    ds_read_b64_tr_b16 a[168:169], v26 offset:15488
    ds_read_b64_tr_b16 a[170:171], v26 offset:16256
    s_add_u32 m0, s3, 106496
    s_add_u32 s72, s72, 4096
    buffer_load_dwordx4 v12, s[44:47], s72 offen offset:0 sc1 lds
    s_waitcnt lgkmcnt(6)
    v_mfma_f32_32x32x16_bf16 v[208:223], a[184:187], a[128:131], v[208:223]
    ds_read_b64_tr_b16 a[172:173], v26 offset:18432
    ds_read_b64_tr_b16 a[174:175], v26 offset:19200
    s_add_u32 s72, s88, 2
    s_cmp_ge_u32 s72, 3
    s_cselect_b32 s69, 3, 0
    s_sub_u32 s72, s72, s69
    s_mul_i32 s72, s72, 20480
    s_add_u32 m0, s3, 122880
    s_add_u32 s72, s72, s3
    buffer_load_dwordx4 v12, s[44:47], s72 offen offset:0 sc1 lds
    v_mfma_f32_32x32x16_bf16 v[224:239], a[188:191], a[128:131], v[224:239]
    ds_read_b64_tr_b16 a[176:177], v26 offset:18496
    ds_read_b64_tr_b16 a[178:179], v26 offset:19264
    v_mfma_f32_32x32x16_bf16 v[240:255], a[192:195], a[128:131], v[240:255]
    ds_read_b64_tr_b16 a[180:181], v26 offset:18560
    ds_read_b64_tr_b16 a[182:183], v26 offset:19328
    buffer_load_dwordx4 v12, s[44:47], s72 offen offset:1024 sc1 lds
    s_waitcnt lgkmcnt(6)
    v_mfma_f32_32x32x16_bf16 v[208:223], a[160:163], a[132:135], v[208:223]
    ds_read_b64_tr_b16 a[184:185], v26 offset:21504
    ds_read_b64_tr_b16 a[186:187], v26 offset:22272
    buffer_load_dwordx4 v12, s[44:47], s72 offen offset:2048 sc1 lds
    v_mfma_f32_32x32x16_bf16 v[224:239], a[164:167], a[132:135], v[224:239]
    ds_read_b64_tr_b16 a[188:189], v26 offset:21568
    ds_read_b64_tr_b16 a[190:191], v26 offset:22336
    v_mfma_f32_32x32x16_bf16 v[240:255], a[168:171], a[132:135], v[240:255]
    ds_read_b64_tr_b16 a[192:193], v26 offset:21632
    ds_read_b64_tr_b16 a[194:195], v26 offset:22400
    buffer_load_dwordx4 v12, s[44:47], s72 offen offset:3072 sc1 lds
    s_waitcnt lgkmcnt(6)
    v_mfma_f32_32x32x16_bf16 v[208:223], a[172:175], a[136:139], v[208:223]
    ds_read_b64_tr_b16 a[160:161], v26 offset:24576
    ds_read_b64_tr_b16 a[162:163], v26 offset:25344
    s_add_u32 m0, s3, 126976
    s_add_u32 s72, s72, 4096
    buffer_load_dwordx4 v12, s[44:47], s72 offen offset:0 sc1 lds
    v_mfma_f32_32x32x16_bf16 v[224:239], a[176:179], a[136:139], v[224:239]
    ds_read_b64_tr_b16 a[164:165], v26 offset:24640
    ds_read_b64_tr_b16 a[166:167], v26 offset:25408
    v_mfma_f32_32x32x16_bf16 v[240:255], a[180:183], a[136:139], v[240:255]
    ds_read_b64_tr_b16 a[168:169], v26 offset:24704
    ds_read_b64_tr_b16 a[170:171], v26 offset:25472
    s_waitcnt lgkmcnt(6)
    v_mfma_f32_32x32x16_bf16 v[208:223], a[184:187], a[140:143], v[208:223]
    ds_read_b64_tr_b16 a[172:173], v26 offset:27648
    ds_read_b64_tr_b16 a[174:175], v26 offset:28416
    v_mfma_f32_32x32x16_bf16 v[224:239], a[188:191], a[140:143], v[224:239]
    ds_read_b64_tr_b16 a[176:177], v26 offset:27712
    ds_read_b64_tr_b16 a[178:179], v26 offset:28480
    v_mfma_f32_32x32x16_bf16 v[240:255], a[192:195], a[140:143], v[240:255]
    ds_read_b64_tr_b16 a[180:181], v26 offset:27776
    ds_read_b64_tr_b16 a[182:183], v26 offset:28544
    s_waitcnt lgkmcnt(6)
    v_mfma_f32_32x32x16_bf16 v[208:223], a[160:163], a[144:147], v[208:223]
    ds_read_b64_tr_b16 a[184:185], v26 offset:30720
    ds_read_b64_tr_b16 a[186:187], v26 offset:31488
    v_mfma_f32_32x32x16_bf16 v[224:239], a[164:167], a[144:147], v[224:239]
    ds_read_b64_tr_b16 a[188:189], v26 offset:30784
    ds_read_b64_tr_b16 a[190:191], v26 offset:31552
    v_mfma_f32_32x32x16_bf16 v[240:255], a[168:171], a[144:147], v[240:255]
    ds_read_b64_tr_b16 a[192:193], v26 offset:30848
    ds_read_b64_tr_b16 a[194:195], v26 offset:31616
    s_waitcnt lgkmcnt(6)
    v_mfma_f32_32x32x16_bf16 v[208:223], a[172:175], a[148:151], v[208:223]
    ds_read_b64_tr_b16 a[160:161], v26 offset:33792
    ds_read_b64_tr_b16 a[162:163], v26 offset:34560
    v_mfma_f32_32x32x16_bf16 v[224:239], a[176:179], a[148:151], v[224:239]
    ds_read_b64_tr_b16 a[164:165], v26 offset:33856
    ds_read_b64_tr_b16 a[166:167], v26 offset:34624
    v_mfma_f32_32x32x16_bf16 v[240:255], a[180:183], a[148:151], v[240:255]
    ds_read_b64_tr_b16 a[168:169], v26 offset:33920
    ds_read_b64_tr_b16 a[170:171], v26 offset:34688
    s_waitcnt lgkmcnt(6)
    v_mfma_f32_32x32x16_bf16 v[208:223], a[184:187], a[152:155], v[208:223]
    v_mfma_f32_32x32x16_bf16 v[224:239], a[188:191], a[152:155], v[224:239]
    v_mfma_f32_32x32x16_bf16 v[240:255], a[192:195], a[152:155], v[240:255]
    s_waitcnt lgkmcnt(0)
    v_mfma_f32_32x32x16_bf16 v[208:223], a[160:163], a[156:159], v[208:223]
    v_mfma_f32_32x32x16_bf16 v[224:239], a[164:167], a[156:159], v[224:239]
    v_mfma_f32_32x32x16_bf16 v[240:255], a[168:171], a[156:159], v[240:255]
    s_nop 9
    v_cvt_pk_bf16_f32 v64, v208, v209
    v_cvt_pk_bf16_f32 v65, v210, v211
    v_cvt_pk_bf16_f32 v66, v212, v213
    v_cvt_pk_bf16_f32 v67, v214, v215
    v_cvt_pk_bf16_f32 v68, v216, v217
    v_cvt_pk_bf16_f32 v69, v218, v219
    v_cvt_pk_bf16_f32 v70, v220, v221
    v_cvt_pk_bf16_f32 v71, v222, v223
    v_mfma_f32_32x32x16_bf16 v[84:99], a[200:203], v[64:67], 0
    v_cvt_pk_bf16_f32 v72, v224, v225
    v_cvt_pk_bf16_f32 v73, v226, v227
    v_cvt_pk_bf16_f32 v74, v228, v229
    v_cvt_pk_bf16_f32 v75, v230, v231
    v_cvt_pk_bf16_f32 v76, v232, v233
    v_cvt_pk_bf16_f32 v77, v234, v235
    v_cvt_pk_bf16_f32 v78, v236, v237
    v_cvt_pk_bf16_f32 v79, v238, v239
    v_cvt_pk_bf16_f32 v80, v240, v241
    v_cvt_pk_bf16_f32 v81, v242, v243
    v_cvt_pk_bf16_f32 v82, v244, v245
    v_cvt_pk_bf16_f32 v83, v246, v247
    v_mfma_f32_32x32x16_bf16 v[84:99], a[204:207], v[68:71], v[84:99]
    s_lshl_b32 s64, s40, 8
    s_add_u32 s64, s64, 65664
    s_cmp_eq_u32 s38, 0
    s_cselect_b32 s64, s64, 0x40000000
    v_mov_b32 v42, 0x40000000
    v_writelane_b32 v42, s64, 0
    s_waitcnt vmcnt(15)
    s_barrier
    v_mov_b32 v43, 1
    buffer_atomic_add v43, v42, s[60:63], 0 offen
    v_mov_b32 v138, 0
    v_mov_b32 v139, 0
    v_mov_b32 v150, 0
    v_mov_b32 v151, 0
    v_mov_b32 v162, 0
    v_mov_b32 v163, 0
    v_mov_b32 v174, 0
    v_mov_b32 v175, 0
    v_max3_f32 v94, v84, v85, v86
    v_max3_f32 v95, -v84, -v85, -v86
    v_max3_f32 v94, v94, v87, v88
    v_max3_f32 v95, v95, -v87, -v88
    v_max3_f32 v94, v94, v89, v90
    v_max3_f32 v95, v95, -v89, -v90
    v_mfma_f32_32x32x16_bf16 v[100:115], a[208:211], v[68:71], 0
    v_max3_f32 v94, v94, v91, v92
    v_max3_f32 v95, v95, -v91, -v92
    v_max_f32 v94, v94, v93
    v_max_f32_e64 v95, v95, -v93
    s_nop 1
    v_permlane32_swap_b32 v94, v95
    v_max_f32 v94, v94, v95
    v_mul_f32 v94, v5, v94
    v_mov_b32 v96, v94
    s_nop 1
    v_permlane32_swap_b32 v94, v96
    v_pk_fma_f32 v[116:117], v[84:85], v[4:5], v[94:95] op_sel:[0,1,0] op_sel_hi:[1,1,0] neg_lo:[0,0,1] neg_hi:[0,0,1]
    v_pk_fma_f32 v[84:85], v[84:85], v[4:5], v[96:97] op_sel:[0,1,0] op_sel_hi:[1,1,0] neg_lo:[1,0,1] neg_hi:[1,0,1]
    v_pk_fma_f32 v[118:119], v[86:87], v[4:5], v[94:95] op_sel:[0,1,0] op_sel_hi:[1,1,0] neg_lo:[0,0,1] neg_hi:[0,0,1]
    v_pk_fma_f32 v[86:87], v[86:87], v[4:5], v[96:97] op_sel:[0,1,0] op_sel_hi:[1,1,0] neg_lo:[1,0,1] neg_hi:[1,0,1]
    v_pk_fma_f32 v[120:121], v[88:89], v[4:5], v[94:95] op_sel:[0,1,0] op_sel_hi:[1,1,0] neg_lo:[0,0,1] neg_hi:[0,0,1]
    v_pk_fma_f32 v[88:89], v[88:89], v[4:5], v[96:97] op_sel:[0,1,0] op_sel_hi:[1,1,0] neg_lo:[1,0,1] neg_hi:[1,0,1]
    v_pk_fma_f32 v[122:123], v[90:91], v[4:5], v[94:95] op_sel:[0,1,0] op_sel_hi:[1,1,0] neg_lo:[0,0,1] neg_hi:[0,0,1]
    v_pk_fma_f32 v[90:91], v[90:91], v[4:5], v[96:97] op_sel:[0,1,0] op_sel_hi:[1,1,0] neg_lo:[1,0,1] neg_hi:[1,0,1]
    v_pk_fma_f32 v[124:125], v[92:93], v[4:5], v[94:95] op_sel:[0,1,0] op_sel_hi:[1,1,0] neg_lo:[0,0,1] neg_hi:[0,0,1]
    v_mfma_f32_32x32x16_bf16 v[100:115], a[212:215], v[72:75], v[100:115]
    v_pk_fma_f32 v[92:93], v[92:93], v[4:5], v[96:97] op_sel:[0,1,0] op_sel_hi:[1,1,0] neg_lo:[1,0,1] neg_hi:[1,0,1]
    v_exp_f32 v116, v116
    v_exp_f32 v84, v84
    v_exp_f32 v117, v117
    v_exp_f32 v85, v85
    v_exp_f32 v118, v118
    v_exp_f32 v86, v86
    v_exp_f32 v119, v119
    v_exp_f32 v87, v87
    v_exp_f32 v120, v120
    v_exp_f32 v88, v88
    v_exp_f32 v121, v121
    v_exp_f32 v89, v89
    v_exp_f32 v122, v122
    v_exp_f32 v90, v90
    v_exp_f32 v123, v123
    v_exp_f32 v91, v91
    v_exp_f32 v124, v124
    v_exp_f32 v92, v92
    v_exp_f32 v125, v125
    v_exp_f32 v93, v93
    v_pk_add_f32 v[94:95], v[116:117], v[118:119]
    v_pk_add_f32 v[96:97], v[84:85], v[86:87]
    v_pk_add_f32 v[94:95], v[94:95], v[120:121]
    v_pk_add_f32 v[96:97], v[96:97], v[88:89]
    v_pk_add_f32 v[94:95], v[94:95], v[122:123]
    v_pk_add_f32 v[96:97], v[96:97], v[90:91]
    v_pk_add_f32 v[94:95], v[94:95], v[124:125]
    v_pk_add_f32 v[96:97], v[96:97], v[92:93]
    v_add_f32 v94, v94, v95
    v_add_f32 v96, v96, v97
    s_nop 1
    v_permlane32_swap_b32 v94, v96
    v_add_f32 v94, v94, v96
    v_rcp_f32 v94, v94
    s_nop 0
    v_mov_b32 v96, v94
    s_nop 1
    v_permlane32_swap_b32 v94, v96
    v_pk_mul_f32 v[116:117], v[116:117], v[94:95] op_sel_hi:[1,0]
    v_pk_mul_f32 v[84:85], v[84:85], v[96:97] op_sel_hi:[1,0]
    v_pk_mul_f32 v[118:119], v[118:119], v[94:95] op_sel_hi:[1,0]
    v_pk_mul_f32 v[86:87], v[86:87], v[96:97] op_sel_hi:[1,0]
    v_pk_mul_f32 v[120:121], v[120:121], v[94:95] op_sel_hi:[1,0]
    v_pk_mul_f32 v[88:89], v[88:89], v[96:97] op_sel_hi:[1,0]
    v_pk_mul_f32 v[122:123], v[122:123], v[94:95] op_sel_hi:[1,0]
    v_pk_mul_f32 v[90:91], v[90:91], v[96:97] op_sel_hi:[1,0]
    v_pk_mul_f32 v[124:125], v[124:125], v[94:95] op_sel_hi:[1,0]
    v_pk_mul_f32 v[92:93], v[92:93], v[96:97] op_sel_hi:[1,0]
    v_cvt_pk_bf16_f32 v128, v116, v117
    v_cvt_pk_bf16_f32 v129, v118, v119
    v_cvt_pk_bf16_f32 v130, v120, v121
    v_cvt_pk_bf16_f32 v131, v122, v123
    v_cvt_pk_bf16_f32 v132, v124, v125
    v_cvt_pk_bf16_f32 v133, v84, v85
    v_cvt_pk_bf16_f32 v134, v86, v87
    v_cvt_pk_bf16_f32 v135, v88, v89
    v_cvt_pk_bf16_f32 v136, v90, v91
    v_cvt_pk_bf16_f32 v137, v92, v93
    v_max3_f32 v110, v100, v101, v102
    v_max3_f32 v111, -v100, -v101, -v102
    v_max3_f32 v110, v110, v103, v104
    v_max3_f32 v111, v111, -v103, -v104
    v_max3_f32 v110, v110, v105, v106
    v_max3_f32 v111, v111, -v105, -v106
    v_mfma_f32_32x32x16_bf16 v[84:99], a[216:219], v[72:75], 0
    v_max3_f32 v110, v110, v107, v108
    v_max3_f32 v111, v111, -v107, -v108
    v_max_f32 v110, v110, v109
    v_max_f32_e64 v111, v111, -v109
    s_nop 1
    v_permlane32_swap_b32 v110, v111
    v_max_f32 v110, v110, v111
    v_mul_f32 v110, v5, v110
    v_mov_b32 v112, v110
    s_nop 1
    v_permlane32_swap_b32 v110, v112
    v_pk_fma_f32 v[116:117], v[100:101], v[4:5], v[110:111] op_sel:[0,1,0] op_sel_hi:[1,1,0] neg_lo:[0,0,1] neg_hi:[0,0,1]
    v_pk_fma_f32 v[100:101], v[100:101], v[4:5], v[112:113] op_sel:[0,1,0] op_sel_hi:[1,1,0] neg_lo:[1,0,1] neg_hi:[1,0,1]
    v_pk_fma_f32 v[118:119], v[102:103], v[4:5], v[110:111] op_sel:[0,1,0] op_sel_hi:[1,1,0] neg_lo:[0,0,1] neg_hi:[0,0,1]
    v_pk_fma_f32 v[102:103], v[102:103], v[4:5], v[112:113] op_sel:[0,1,0] op_sel_hi:[1,1,0] neg_lo:[1,0,1] neg_hi:[1,0,1]
    v_pk_fma_f32 v[120:121], v[104:105], v[4:5], v[110:111] op_sel:[0,1,0] op_sel_hi:[1,1,0] neg_lo:[0,0,1] neg_hi:[0,0,1]
    v_pk_fma_f32 v[104:105], v[104:105], v[4:5], v[112:113] op_sel:[0,1,0] op_sel_hi:[1,1,0] neg_lo:[1,0,1] neg_hi:[1,0,1]
    v_pk_fma_f32 v[122:123], v[106:107], v[4:5], v[110:111] op_sel:[0,1,0] op_sel_hi:[1,1,0] neg_lo:[0,0,1] neg_hi:[0,0,1]
    v_pk_fma_f32 v[106:107], v[106:107], v[4:5], v[112:113] op_sel:[0,1,0] op_sel_hi:[1,1,0] neg_lo:[1,0,1] neg_hi:[1,0,1]
    v_pk_fma_f32 v[124:125], v[108:109], v[4:5], v[110:111] op_sel:[0,1,0] op_sel_hi:[1,1,0] neg_lo:[0,0,1] neg_hi:[0,0,1]
    v_mfma_f32_32x32x16_bf16 v[84:99], a[220:223], v[76:79], v[84:99]
    v_pk_fma_f32 v[108:109], v[108:109], v[4:5], v[112:113] op_sel:[0,1,0] op_sel_hi:[1,1,0] neg_lo:[1,0,1] neg_hi:[1,0,1]
    v_exp_f32 v116, v116
    v_exp_f32 v100, v100
    v_exp_f32 v117, v117
    v_exp_f32 v101, v101
    v_exp_f32 v118, v118
    v_exp_f32 v102, v102
    v_exp_f32 v119, v119
    v_exp_f32 v103, v103
    v_exp_f32 v120, v120
    v_exp_f32 v104, v104
    v_exp_f32 v121, v121
    v_exp_f32 v105, v105
    v_exp_f32 v122, v122
    v_exp_f32 v106, v106
    v_exp_f32 v123, v123
    v_exp_f32 v107, v107
    v_exp_f32 v124, v124
    v_exp_f32 v108, v108
    v_exp_f32 v125, v125
    v_exp_f32 v109, v109
    v_pk_add_f32 v[110:111], v[116:117], v[118:119]
    v_pk_add_f32 v[112:113], v[100:101], v[102:103]
    v_pk_add_f32 v[110:111], v[110:111], v[120:121]
    v_pk_add_f32 v[112:113], v[112:113], v[104:105]
    v_pk_add_f32 v[110:111], v[110:111], v[122:123]
    v_pk_add_f32 v[112:113], v[112:113], v[106:107]
    v_pk_add_f32 v[110:111], v[110:111], v[124:125]
    v_pk_add_f32 v[112:113], v[112:113], v[108:109]
    v_add_f32 v110, v110, v111
    v_add_f32 v112, v112, v113
    s_nop 1
    v_permlane32_swap_b32 v110, v112
    v_add_f32 v110, v110, v112
    v_rcp_f32 v110, v110
    s_nop 0
    v_mov_b32 v112, v110
    s_nop 1
    v_permlane32_swap_b32 v110, v112
    v_pk_mul_f32 v[116:117], v[116:117], v[110:111] op_sel_hi:[1,0]
    v_pk_mul_f32 v[100:101], v[100:101], v[112:113] op_sel_hi:[1,0]
    v_pk_mul_f32 v[118:119], v[118:119], v[110:111] op_sel_hi:[1,0]
    v_pk_mul_f32 v[102:103], v[102:103], v[112:113] op_sel_hi:[1,0]
    v_pk_mul_f32 v[120:121], v[120:121], v[110:111] op_sel_hi:[1,0]
    v_pk_mul_f32 v[104:105], v[104:105], v[112:113] op_sel_hi:[1,0]
    v_pk_mul_f32 v[122:123], v[122:123], v[110:111] op_sel_hi:[1,0]
    v_pk_mul_f32 v[106:107], v[106:107], v[112:113] op_sel_hi:[1,0]
    v_pk_mul_f32 v[124:125], v[124:125], v[110:111] op_sel_hi:[1,0]
    v_pk_mul_f32 v[108:109], v[108:109], v[112:113] op_sel_hi:[1,0]
    v_cvt_pk_bf16_f32 v140, v116, v117
    v_cvt_pk_bf16_f32 v141, v118, v119
    v_cvt_pk_bf16_f32 v142, v120, v121
    v_cvt_pk_bf16_f32 v143, v122, v123
    v_cvt_pk_bf16_f32 v144, v124, v125
    v_cvt_pk_bf16_f32 v145, v100, v101
    s_lshl_b32 s64, s86, 12
    s_add_u32 s64, s64, 3328
    v_min_u32 v30, 3, v1
    v_lshl_add_u32 v30, v30, 7, s64
    v_mov_b32 v31, 10
    s_lshl_b32 s65, s86, 12
    s_add_u32 s65, s65, 128
    v_cmp_lt_u32 vcc, 3, v1
    v_mov_b32 v45, s65
    v_mov_b32 v46, 8
    v_cndmask_b32 v30, v30, v45, vcc
    v_cndmask_b32 v31, v31, v46, vcc
    s_lshl_b32 s64, s40, 8
    s_add_u32 s64, s64, 65664
    v_writelane_b32 v30, s64, 4
    v_writelane_b32 v31, 16, 4
    buffer_load_dword v44, v30, s[60:63], s73 offen sc1
    v_cvt_pk_bf16_f32 v146, v102, v103
    v_cvt_pk_bf16_f32 v147, v104, v105
    v_cvt_pk_bf16_f32 v148, v106, v107
    v_cvt_pk_bf16_f32 v149, v108, v109
    v_max3_f32 v94, v84, v85, v86
    v_max3_f32 v95, -v84, -v85, -v86
    v_max3_f32 v94, v94, v87, v88
    v_max3_f32 v95, v95, -v87, -v88
    v_max3_f32 v94, v94, v89, v90
    v_max3_f32 v95, v95, -v89, -v90
    v_mfma_f32_32x32x16_bf16 v[100:115], a[224:227], v[76:79], 0
    v_max3_f32 v94, v94, v91, v92
    v_max3_f32 v95, v95, -v91, -v92
    v_max_f32 v94, v94, v93
    v_max_f32_e64 v95, v95, -v93
    s_nop 1
    v_permlane32_swap_b32 v94, v95
    v_max_f32 v94, v94, v95
    v_mul_f32 v94, v5, v94
    v_mov_b32 v96, v94
    s_nop 1
    v_permlane32_swap_b32 v94, v96
    v_pk_fma_f32 v[116:117], v[84:85], v[4:5], v[94:95] op_sel:[0,1,0] op_sel_hi:[1,1,0] neg_lo:[0,0,1] neg_hi:[0,0,1]
    v_pk_fma_f32 v[84:85], v[84:85], v[4:5], v[96:97] op_sel:[0,1,0] op_sel_hi:[1,1,0] neg_lo:[1,0,1] neg_hi:[1,0,1]
    v_pk_fma_f32 v[118:119], v[86:87], v[4:5], v[94:95] op_sel:[0,1,0] op_sel_hi:[1,1,0] neg_lo:[0,0,1] neg_hi:[0,0,1]
    v_pk_fma_f32 v[86:87], v[86:87], v[4:5], v[96:97] op_sel:[0,1,0] op_sel_hi:[1,1,0] neg_lo:[1,0,1] neg_hi:[1,0,1]
    v_pk_fma_f32 v[120:121], v[88:89], v[4:5], v[94:95] op_sel:[0,1,0] op_sel_hi:[1,1,0] neg_lo:[0,0,1] neg_hi:[0,0,1]
    v_pk_fma_f32 v[88:89], v[88:89], v[4:5], v[96:97] op_sel:[0,1,0] op_sel_hi:[1,1,0] neg_lo:[1,0,1] neg_hi:[1,0,1]
    v_pk_fma_f32 v[122:123], v[90:91], v[4:5], v[94:95] op_sel:[0,1,0] op_sel_hi:[1,1,0] neg_lo:[0,0,1] neg_hi:[0,0,1]
    v_pk_fma_f32 v[90:91], v[90:91], v[4:5], v[96:97] op_sel:[0,1,0] op_sel_hi:[1,1,0] neg_lo:[1,0,1] neg_hi:[1,0,1]
    v_pk_fma_f32 v[124:125], v[92:93], v[4:5], v[94:95] op_sel:[0,1,0] op_sel_hi:[1,1,0] neg_lo:[0,0,1] neg_hi:[0,0,1]
    v_mfma_f32_32x32x16_bf16 v[100:115], a[228:231], v[80:83], v[100:115]
    v_pk_fma_f32 v[92:93], v[92:93], v[4:5], v[96:97] op_sel:[0,1,0] op_sel_hi:[1,1,0] neg_lo:[1,0,1] neg_hi:[1,0,1]
    v_exp_f32 v116, v116
    v_exp_f32 v84, v84
    v_exp_f32 v117, v117
    v_exp_f32 v85, v85
    v_exp_f32 v118, v118
    v_exp_f32 v86, v86
    v_exp_f32 v119, v119
    v_exp_f32 v87, v87
    v_exp_f32 v120, v120
    v_exp_f32 v88, v88
    v_exp_f32 v121, v121
    v_exp_f32 v89, v89
    v_exp_f32 v122, v122
    v_exp_f32 v90, v90
    v_exp_f32 v123, v123
    v_exp_f32 v91, v91
    v_exp_f32 v124, v124
    v_exp_f32 v92, v92
    v_exp_f32 v125, v125
    v_exp_f32 v93, v93
    v_pk_add_f32 v[94:95], v[116:117], v[118:119]
    v_pk_add_f32 v[96:97], v[84:85], v[86:87]
    v_pk_add_f32 v[94:95], v[94:95], v[120:121]
    v_pk_add_f32 v[96:97], v[96:97], v[88:89]
    v_pk_add_f32 v[94:95], v[94:95], v[122:123]
    v_pk_add_f32 v[96:97], v[96:97], v[90:91]
    v_pk_add_f32 v[94:95], v[94:95], v[124:125]
    v_pk_add_f32 v[96:97], v[96:97], v[92:93]
    v_add_f32 v94, v94, v95
    v_add_f32 v96, v96, v97
    s_nop 1
    v_permlane32_swap_b32 v94, v96
    v_add_f32 v94, v94, v96
    v_rcp_f32 v94, v94
    s_nop 0
    v_mov_b32 v96, v94
    s_nop 1
    v_permlane32_swap_b32 v94, v96
    v_pk_mul_f32 v[116:117], v[116:117], v[94:95] op_sel_hi:[1,0]
    v_pk_mul_f32 v[84:85], v[84:85], v[96:97] op_sel_hi:[1,0]
    v_pk_mul_f32 v[118:119], v[118:119], v[94:95] op_sel_hi:[1,0]
    v_pk_mul_f32 v[86:87], v[86:87], v[96:97] op_sel_hi:[1,0]
    v_pk_mul_f32 v[120:121], v[120:121], v[94:95] op_sel_hi:[1,0]
    v_pk_mul_f32 v[88:89], v[88:89], v[96:97] op_sel_hi:[1,0]
    v_pk_mul_f32 v[122:123], v[122:123], v[94:95] op_sel_hi:[1,0]
    v_pk_mul_f32 v[90:91], v[90:91], v[96:97] op_sel_hi:[1,0]
    v_pk_mul_f32 v[124:125], v[124:125], v[94:95] op_sel_hi:[1,0]
    v_pk_mul_f32 v[92:93], v[92:93], v[96:97] op_sel_hi:[1,0]
    v_cvt_pk_bf16_f32 v152, v116, v117
    v_cvt_pk_bf16_f32 v153, v118, v119
    v_cvt_pk_bf16_f32 v154, v120, v121
    v_cvt_pk_bf16_f32 v155, v122, v123
    v_cvt_pk_bf16_f32 v156, v124, v125
    v_cvt_pk_bf16_f32 v157, v84, v85
    v_cvt_pk_bf16_f32 v158, v86, v87
    v_cvt_pk_bf16_f32 v159, v88, v89
    v_cvt_pk_bf16_f32 v160, v90, v91
    v_cvt_pk_bf16_f32 v161, v92, v93
    v_max3_f32 v110, v100, v101, v102
    v_max3_f32 v111, -v100, -v101, -v102
    v_max3_f32 v110, v110, v103, v104
    v_max3_f32 v111, v111, -v103, -v104
    v_max3_f32 v110, v110, v105, v106
    v_max3_f32 v111, v111, -v105, -v106
    v_max3_f32 v110, v110, v107, v108
    v_max3_f32 v111, v111, -v107, -v108
    v_max_f32 v110, v110, v109
    v_max_f32_e64 v111, v111, -v109
    s_nop 1
    v_permlane32_swap_b32 v110, v111
    v_max_f32 v110, v110, v111
    v_mul_f32 v110, v5, v110
    v_mov_b32 v112, v110
    s_waitcnt vmcnt(0)
    v_cmp_le_u32 vcc, v31, v44
    s_nop 1
    s_cmp_eq_u64 vcc, -1
    s_cbranch_scc1 L_kv_11_ok
    s_cmp_lg_u32 s38, 0
    s_cbranch_scc1 L_kv_11_ok
    s_mov_b32 s69, 0
L_kv_11_spin:
    buffer_load_dword v44, v30, s[60:63], 0 offen sc1
    s_waitcnt vmcnt(0)
    v_cmp_le_u32 vcc, v31, v44
    s_nop 1
    s_cmp_eq_u64 vcc, -1
    s_cbranch_scc1 L_kv_11_ok
    s_sleep 2
    s_add_u32 s69, s69, 1
    s_cmp_lt_u32 s69, 0x4000
    s_cbranch_scc1 L_kv_11_spin
L_kv_11_ok:
    s_barrier
    v_min_u32 v32, 20, v2
    v_lshlrev_b32 v32, 2, v32
    s_mul_i32 s41, s38, 5120
    v_add_u32 v32, s41, v32
    v_lshl_add_u32 v33, v3, 10, v32
    v_lshl_add_u32 v34, v3, 9, v32
    v_add_u32 v34, 4096, v34
    buffer_load_dword v176, v33, s[24:27], 0 offen offset:0 sc1
    buffer_load_dword v177, v33, s[24:27], 0 offen offset:128 sc1
    buffer_load_dword v178, v33, s[24:27], 0 offen offset:256 sc1
    buffer_load_dword v179, v33, s[24:27], 0 offen offset:384 sc1
    buffer_load_dword v180, v33, s[24:27], 0 offen offset:512 sc1
    buffer_load_dword v181, v33, s[24:27], 0 offen offset:640 sc1
    buffer_load_dword v182, v33, s[24:27], 0 offen offset:768 sc1
    buffer_load_dword v183, v33, s[24:27], 0 offen offset:896 sc1
    buffer_load_dword v184, v33, s[24:27], 0 offen offset:2048 sc1
    buffer_load_dword v185, v33, s[24:27], 0 offen offset:2176 sc1
    buffer_load_dword v186, v33, s[24:27], 0 offen offset:2304 sc1
    buffer_load_dword v187, v33, s[24:27], 0 offen offset:2432 sc1
    buffer_load_dword v188, v33, s[24:27], 0 offen offset:2560 sc1
    buffer_load_dword v189, v33, s[24:27], 0 offen offset:2688 sc1
    buffer_load_dword v190, v33, s[24:27], 0 offen offset:2816 sc1
    buffer_load_dword v191, v33, s[24:27], 0 offen offset:2944 sc1
    buffer_load_dword v192, v34, s[24:27], 0 offen offset:0 sc1
    buffer_load_dword v193, v34, s[24:27], 0 offen offset:128 sc1
    buffer_load_dword v194, v34, s[24:27], 0 offen offset:256 sc1
    buffer_load_dword v195, v34, s[24:27], 0 offen offset:384 sc1
    s_add_u32 s70, s88, 0
    s_cmp_ge_u32 s70, 3
    s_cselect_b32 s69, 3, 0
    s_sub_u32 s70, s70, s69
    s_mul_i32 s70, s70, 4096
    buffer_load_dwordx4 a[0:3], v12, s[52:55], s70 offen offset:0 sc1
    buffer_load_dwordx4 a[4:7], v15, s[52:55], s70 offen offset:0 sc1
    buffer_load_dwordx4 a[8:11], v12, s[52:55], s70 offen offset:1024 sc1
    buffer_load_dwordx4 a[12:15], v15, s[52:55], s70 offen offset:1024 sc1
    buffer_load_dwordx4 a[16:19], v12, s[52:55], s70 offen offset:2048 sc1
    buffer_load_dwordx4 a[20:23], v15, s[52:55], s70 offen offset:2048 sc1
    buffer_load_dwordx4 a[24:27], v12, s[52:55], s70 offen offset:3072 sc1
    buffer_load_dwordx4 a[28:31], v15, s[52:55], s70 offen offset:3072 sc1
    v_permlane32_swap_b32 v110, v112
    v_pk_fma_f32 v[116:117], v[100:101], v[4:5], v[110:111] op_sel:[0,1,0] op_sel_hi:[1,1,0] neg_lo:[0,0,1] neg_hi:[0,0,1]
    v_pk_fma_f32 v[100:101], v[100:101], v[4:5], v[112:113] op_sel:[0,1,0] op_sel_hi:[1,1,0] neg_lo:[1,0,1] neg_hi:[1,0,1]
    v_pk_fma_f32 v[118:119], v[102:103], v[4:5], v[110:111] op_sel:[0,1,0] op_sel_hi:[1,1,0] neg_lo:[0,0,1] neg_hi:[0,0,1]
    v_pk_fma_f32 v[102:103], v[102:103], v[4:5], v[112:113] op_sel:[0,1,0] op_sel_hi:[1,1,0] neg_lo:[1,0,1] neg_hi:[1,0,1]
    v_pk_fma_f32 v[120:121], v[104:105], v[4:5], v[110:111] op_sel:[0,1,0] op_sel_hi:[1,1,0] neg_lo:[0,0,1] neg_hi:[0,0,1]
    v_pk_fma_f32 v[104:105], v[104:105], v[4:5], v[112:113] op_sel:[0,1,0] op_sel_hi:[1,1,0] neg_lo:[1,0,1] neg_hi:[1,0,1]
    v_pk_fma_f32 v[122:123], v[106:107], v[4:5], v[110:111] op_sel:[0,1,0] op_sel_hi:[1,1,0] neg_lo:[0,0,1] neg_hi:[0,0,1]
    v_pk_fma_f32 v[106:107], v[106:107], v[4:5], v[112:113] op_sel:[0,1,0] op_sel_hi:[1,1,0] neg_lo:[1,0,1] neg_hi:[1,0,1]
    v_pk_fma_f32 v[124:125], v[108:109], v[4:5], v[110:111] op_sel:[0,1,0] op_sel_hi:[1,1,0] neg_lo:[0,0,1] neg_hi:[0,0,1]
    v_pk_fma_f32 v[108:109], v[108:109], v[4:5], v[112:113] op_sel:[0,1,0] op_sel_hi:[1,1,0] neg_lo:[1,0,1] neg_hi:[1,0,1]
    v_exp_f32 v116, v116
    v_exp_f32 v100, v100
    v_exp_f32 v117, v117
    v_exp_f32 v101, v101
    v_exp_f32 v118, v118
    v_exp_f32 v102, v102
    v_exp_f32 v119, v119
    v_exp_f32 v103, v103
    v_exp_f32 v120, v120
    v_exp_f32 v104, v104
    v_exp_f32 v121, v121
    v_exp_f32 v105, v105
    v_exp_f32 v122, v122
    v_exp_f32 v106, v106
    v_exp_f32 v123, v123
    v_exp_f32 v107, v107
    v_exp_f32 v124, v124
    v_exp_f32 v108, v108
    v_exp_f32 v125, v125
    v_exp_f32 v109, v109
    v_pk_add_f32 v[110:111], v[116:117], v[118:119]
    v_pk_add_f32 v[112:113], v[100:101], v[102:103]
    v_pk_add_f32 v[110:111], v[110:111], v[120:121]
    v_pk_add_f32 v[112:113], v[112:113], v[104:105]
    v_pk_add_f32 v[110:111], v[110:111], v[122:123]
    v_pk_add_f32 v[112:113], v[112:113], v[106:107]
    v_pk_add_f32 v[110:111], v[110:111], v[124:125]
    v_pk_add_f32 v[112:113], v[112:113], v[108:109]
    v_add_f32 v110, v110, v111
    v_add_f32 v112, v112, v113
    s_nop 1
    v_permlane32_swap_b32 v110, v112
    v_add_f32 v110, v110, v112
    v_rcp_f32 v110, v110
    s_nop 0
    v_mov_b32 v112, v110
    s_nop 1
    v_permlane32_swap_b32 v110, v112
    v_pk_mul_f32 v[116:117], v[116:117], v[110:111] op_sel_hi:[1,0]
    v_pk_mul_f32 v[100:101], v[100:101], v[112:113] op_sel_hi:[1,0]
    v_pk_mul_f32 v[118:119], v[118:119], v[110:111] op_sel_hi:[1,0]
    v_pk_mul_f32 v[102:103], v[102:103], v[112:113] op_sel_hi:[1,0]
    v_pk_mul_f32 v[120:121], v[120:121], v[110:111] op_sel_hi:[1,0]
    v_pk_mul_f32 v[104:105], v[104:105], v[112:113] op_sel_hi:[1,0]
    v_pk_mul_f32 v[122:123], v[122:123], v[110:111] op_sel_hi:[1,0]
    v_pk_mul_f32 v[106:107], v[106:107], v[112:113] op_sel_hi:[1,0]
    v_pk_mul_f32 v[124:125], v[124:125], v[110:111] op_sel_hi:[1,0]
    v_pk_mul_f32 v[108:109], v[108:109], v[112:113] op_sel_hi:[1,0]
    v_cvt_pk_bf16_f32 v164, v116, v117
    v_cvt_pk_bf16_f32 v165, v118, v119
    v_cvt_pk_bf16_f32 v166, v120, v121
    v_cvt_pk_bf16_f32 v167, v122, v123
    v_cvt_pk_bf16_f32 v168, v124, v125
    v_cvt_pk_bf16_f32 v169, v100, v101
    v_cvt_pk_bf16_f32 v170, v102, v103
    v_cvt_pk_bf16_f32 v171, v104, v105
    v_cvt_pk_bf16_f32 v172, v106, v107
    v_cvt_pk_bf16_f32 v173, v108, v109
    s_waitcnt vmcnt(26)
    v_cvt_pk_bf16_f32 v196, v176, v177
    s_waitcnt vmcnt(24)
    v_cvt_pk_bf16_f32 v197, v178, v179
    s_waitcnt vmcnt(22)
    v_cvt_pk_bf16_f32 v198, v180, v181
    s_waitcnt vmcnt(20)
    v_cvt_pk_bf16_f32 v199, v182, v183
    s_waitcnt vmcnt(18)
    v_cvt_pk_bf16_f32 v200, v184, v185
    s_waitcnt vmcnt(16)
    v_cvt_pk_bf16_f32 v201, v186, v187
    s_waitcnt vmcnt(14)
    v_cvt_pk_bf16_f32 v202, v188, v189
    s_waitcnt vmcnt(12)
    v_cvt_pk_bf16_f32 v203, v190, v191
    s_waitcnt vmcnt(10)
    v_cvt_pk_bf16_f32 v204, v192, v193
    s_waitcnt vmcnt(8)
    v_cvt_pk_bf16_f32 v205, v194, v195
    v_mov_b32 v206, 0
    v_mov_b32 v207, 0
    s_mul_i32 s41, s38, 3072
    s_add_u32 s41, s41, 4096
    v_add_u32 v120, s41, v13
    v_add_u32 v121, 4096, v13
    ds_write_b128 v120, v[196:199] offset:0
    ds_write_b128 v120, v[200:203] offset:1024
    ds_write_b128 v120, v[204:207] offset:2048
    s_waitcnt lgkmcnt(0)
    s_barrier
    ds_read_b128 v[32:35], v121 offset:0
    ds_read_b128 v[44:47], v121 offset:3072
    ds_read_b128 v[56:59], v121 offset:6144
    ds_read_b128 v[68:71], v121 offset:9216
    ds_read_b128 v[36:39], v121 offset:1024
    ds_read_b128 v[48:51], v121 offset:4096
    ds_read_b128 v[60:63], v121 offset:7168
    ds_read_b128 v[72:75], v121 offset:10240
    ds_read_b128 v[40:43], v121 offset:2048
    ds_read_b128 v[52:55], v121 offset:5120
    ds_read_b128 v[64:67], v121 offset:8192
    ds_read_b128 v[76:79], v121 offset:11264
    s_add_u32 s71, s88, 1
    s_cmp_ge_u32 s71, 3
    s_cselect_b32 s69, 3, 0
    s_sub_u32 s71, s71, s69
    s_mul_i32 s71, s71, 4096
    buffer_load_dwordx4 a[32:35], v12, s[52:55], s71 offen offset:0 sc1
    buffer_load_dwordx4 a[36:39], v15, s[52:55], s71 offen offset:0 sc1
    buffer_load_dwordx4 a[40:43], v12, s[52:55], s71 offen offset:1024 sc1
    buffer_load_dwordx4 a[44:47], v15, s[52:55], s71 offen offset:1024 sc1
    buffer_load_dwordx4 a[48:51], v12, s[52:55], s71 offen offset:2048 sc1
    buffer_load_dwordx4 a[52:55], v15, s[52:55], s71 offen offset:2048 sc1
    buffer_load_dwordx4 a[56:59], v12, s[52:55], s71 offen offset:3072 sc1
    buffer_load_dwordx4 a[60:63], v15, s[52:55], s71 offen offset:3072 sc1
    s_waitcnt lgkmcnt(11)
    v_mfma_f32_32x32x16_bf16 v[176:191], v[32:35], v[128:131], 0
    s_waitcnt lgkmcnt(10)
    v_mfma_f32_32x32x16_bf16 v[192:207], v[44:47], v[140:143], 0
    s_waitcnt lgkmcnt(9)
    v_mfma_f32_32x32x16_bf16 v[208:223], v[56:59], v[152:155], 0
    s_waitcnt lgkmcnt(8)
    v_mfma_f32_32x32x16_bf16 v[224:239], v[68:71], v[164:167], 0
    s_waitcnt lgkmcnt(7)
    v_mfma_f32_32x32x16_bf16 v[176:191], v[36:39], v[132:135], v[176:191]
    s_waitcnt lgkmcnt(6)
    v_mfma_f32_32x32x16_bf16 v[192:207], v[48:51], v[144:147], v[192:207]
    s_waitcnt lgkmcnt(5)
    v_mfma_f32_32x32x16_bf16 v[208:223], v[60:63], v[156:159], v[208:223]
    s_waitcnt lgkmcnt(4)
    v_mfma_f32_32x32x16_bf16 v[224:239], v[72:75], v[168:171], v[224:239]
    s_waitcnt lgkmcnt(3)
    v_mfma_f32_32x32x16_bf16 v[176:191], v[40:43], v[136:139], v[176:191]
    s_waitcnt lgkmcnt(2)
    v_mfma_f32_32x32x16_bf16 v[192:207], v[52:55], v[148:151], v[192:207]
    s_waitcnt lgkmcnt(1)
    v_mfma_f32_32x32x16_bf16 v[208:223], v[64:67], v[160:163], v[208:223]
    s_waitcnt lgkmcnt(0)
    v_mfma_f32_32x32x16_bf16 v[224:239], v[76:79], v[172:175], v[224:239]
    s_nop 5
    v_add_f32 v122, 0x358637bd, v188
    v_rcp_f32 v122, v122
    s_nop 0
    v_pk_mul_f32 v[176:177], v[176:177], v[122:123] op_sel_hi:[1,0]
    v_pk_mul_f32 v[178:179], v[178:179], v[122:123] op_sel_hi:[1,0]
    v_pk_mul_f32 v[180:181], v[180:181], v[122:123] op_sel_hi:[1,0]
    v_pk_mul_f32 v[182:183], v[182:183], v[122:123] op_sel_hi:[1,0]
    v_pk_mul_f32 v[184:185], v[184:185], v[122:123] op_sel_hi:[1,0]
    v_pk_mul_f32 v[186:187], v[186:187], v[122:123] op_sel_hi:[1,0]
    v_cvt_pk_bf16_f32 v240, v176, v177
    v_cvt_pk_bf16_f32 v241, v178, v179
    v_cvt_pk_bf16_f32 v242, v180, v181
    v_cvt_pk_bf16_f32 v243, v182, v183
    v_cvt_pk_bf16_f32 v80, v184, v185
    v_cvt_pk_bf16_f32 v81, v186, v187
    v_add_f32 v122, 0x358637bd, v204
    v_rcp_f32 v122, v122
    s_nop 0
    v_pk_mul_f32 v[192:193], v[192:193], v[122:123] op_sel_hi:[1,0]
    v_pk_mul_f32 v[194:195], v[194:195], v[122:123] op_sel_hi:[1,0]
    v_pk_mul_f32 v[196:197], v[196:197], v[122:123] op_sel_hi:[1,0]
    v_pk_mul_f32 v[198:199], v[198:199], v[122:123] op_sel_hi:[1,0]
    v_pk_mul_f32 v[200:201], v[200:201], v[122:123] op_sel_hi:[1,0]
    v_pk_mul_f32 v[202:203], v[202:203], v[122:123] op_sel_hi:[1,0]
    v_cvt_pk_bf16_f32 v244, v192, v193
    v_cvt_pk_bf16_f32 v245, v194, v195
    v_cvt_pk_bf16_f32 v246, v196, v197
    v_cvt_pk_bf16_f32 v247, v198, v199
    v_cvt_pk_bf16_f32 v82, v200, v201
    v_cvt_pk_bf16_f32 v83, v202, v203
    v_add_f32 v122, 0x358637bd, v220
    v_rcp_f32 v122, v122
    s_nop 0
    v_pk_mul_f32 v[208:209], v[208:209], v[122:123] op_sel_hi:[1,0]
    v_pk_mul_f32 v[210:211], v[210:211], v[122:123] op_sel_hi:[1,0]
    v_pk_mul_f32 v[212:213], v[212:213], v[122:123] op_sel_hi:[1,0]
    v_pk_mul_f32 v[214:215], v[214:215], v[122:123] op_sel_hi:[1,0]
    v_pk_mul_f32 v[216:217], v[216:217], v[122:123] op_sel_hi:[1,0]
    v_pk_mul_f32 v[218:219], v[218:219], v[122:123] op_sel_hi:[1,0]
    v_cvt_pk_bf16_f32 v248, v208, v209
    v_cvt_pk_bf16_f32 v249, v210, v211
    v_cvt_pk_bf16_f32 v250, v212, v213
    v_cvt_pk_bf16_f32 v251, v214, v215
    v_cvt_pk_bf16_f32 v84, v216, v217
    v_cvt_pk_bf16_f32 v85, v218, v219
    v_add_f32 v122, 0x358637bd, v236
    v_rcp_f32 v122, v122
    s_nop 0
    v_pk_mul_f32 v[224:225], v[224:225], v[122:123] op_sel_hi:[1,0]
    v_pk_mul_f32 v[226:227], v[226:227], v[122:123] op_sel_hi:[1,0]
    v_pk_mul_f32 v[228:229], v[228:229], v[122:123] op_sel_hi:[1,0]
    v_pk_mul_f32 v[230:231], v[230:231], v[122:123] op_sel_hi:[1,0]
    v_pk_mul_f32 v[232:233], v[232:233], v[122:123] op_sel_hi:[1,0]
    v_pk_mul_f32 v[234:235], v[234:235], v[122:123] op_sel_hi:[1,0]
    v_cvt_pk_bf16_f32 v252, v224, v225
    v_cvt_pk_bf16_f32 v253, v226, v227
    v_cvt_pk_bf16_f32 v254, v228, v229
    v_cvt_pk_bf16_f32 v255, v230, v231
    v_cvt_pk_bf16_f32 v86, v232, v233
    v_cvt_pk_bf16_f32 v87, v234, v235
    s_mul_i32 s41, s10, 2560
    s_add_u32 s41, s41, 55296
    buffer_store_dwordx4 v[240:243], v6, s[56:59], s41 offen offset:0 sc1
    buffer_store_dwordx4 v[244:247], v6, s[56:59], s41 offen offset:512 sc1
    buffer_store_dwordx4 v[248:251], v6, s[56:59], s41 offen offset:1024 sc1
    buffer_store_dwordx4 v[252:255], v6, s[56:59], s41 offen offset:1536 sc1
    v_cmp_eq_u32 vcc, 0, v3
    v_mov_b32 v122, 0x40000000
    s_nop 0
    v_cndmask_b32 v122, v122, v6, vcc
    buffer_store_dwordx4 v[80:83], v122, s[56:59], s41 offen offset:2048 sc1
    buffer_store_dwordx4 v[84:87], v122, s[56:59], s41 offen offset:2304 sc1
    s_barrier
    ds_read_b128 a[96:99], v13 offset:16384
    ds_read_b128 a[100:103], v13 offset:17408
    ds_read_b128 a[104:107], v13 offset:18432
    ds_read_b128 a[108:111], v13 offset:19456
    ds_read_b128 a[112:115], v13 offset:20480
    s_waitcnt lgkmcnt(0)
    s_waitcnt vmcnt(20)
    v_mfma_f32_16x16x32_bf16 v[128:131], a[96:99], a[0:3], 0
    ds_read_b128 a[116:119], v13 offset:21504
    v_mfma_f32_16x16x32_bf16 v[132:135], a[96:99], a[4:7], 0
    ds_read_b128 a[120:123], v13 offset:22528
    v_mfma_f32_16x16x32_bf16 v[136:139], a[100:103], a[0:3], 0
    ds_read_b128 a[124:127], v13 offset:23552
    s_lshl_b32 s64, s39, 12
    s_add_u32 s64, s64, 768
    s_lshl_b32 s65, s38, 7
    s_add_u32 s64, s64, s65
    v_mfma_f32_16x16x32_bf16 v[140:143], a[100:103], a[4:7], 0
    ds_read_b128 a[128:131], v13 offset:24576
    v_mov_b32 v42, 0x40000000
    v_writelane_b32 v42, s64, 0
    v_mfma_f32_16x16x32_bf16 v[144:147], a[104:107], a[0:3], 0
    ds_read_b128 a[132:135], v13 offset:25600
    v_mfma_f32_16x16x32_bf16 v[148:151], a[104:107], a[4:7], 0
    s_add_u32 s72, s75, 0
    s_cmp_ge_u32 s72, 5
    s_cselect_b32 s69, 5, 0
    s_sub_u32 s72, s72, s69
    s_mul_i32 s72, s72, 4
    s_add_u32 s72, s72, 54
    s_mul_i32 s72, s72, 5120
    s_add_u32 m0, s3, 143360
    s_add_u32 s72, s72, s3
    buffer_load_dwordx4 v12, s[44:47], s72 offen offset:0 sc1 lds
    v_mfma_f32_16x16x32_bf16 v[152:155], a[108:111], a[0:3], 0
    v_mfma_f32_16x16x32_bf16 v[156:159], a[108:111], a[4:7], 0
    buffer_load_dwordx4 v12, s[44:47], s72 offen offset:1024 sc1 lds
    v_mfma_f32_16x16x32_bf16 v[160:163], a[112:115], a[0:3], 0
    v_mfma_f32_16x16x32_bf16 v[164:167], a[112:115], a[4:7], 0
    s_add_u32 s70, s88, 2
    s_cmp_ge_u32 s70, 3
    s_cselect_b32 s69, 3, 0
    s_sub_u32 s70, s70, s69
    s_mul_i32 s70, s70, 4096
    buffer_load_dwordx4 a[64:67], v12, s[52:55], s70 offen offset:0 sc1
    buffer_load_dwordx4 a[68:71], v15, s[52:55], s70 offen offset:0 sc1
    buffer_load_dwordx4 a[72:75], v12, s[52:55], s70 offen offset:1024 sc1
    buffer_load_dwordx4 a[76:79], v15, s[52:55], s70 offen offset:1024 sc1
    buffer_load_dwordx4 a[80:83], v12, s[52:55], s70 offen offset:2048 sc1
    buffer_load_dwordx4 a[84:87], v15, s[52:55], s70 offen offset:2048 sc1
    buffer_load_dwordx4 a[88:91], v12, s[52:55], s70 offen offset:3072 sc1
    buffer_load_dwordx4 a[92:95], v15, s[52:55], s70 offen offset:3072 sc1
    s_waitcnt lgkmcnt(0)
    s_waitcnt vmcnt(28)
    v_mfma_f32_16x16x32_bf16 v[128:131], a[116:119], a[8:11], v[128:131]
    ds_read_b128 a[96:99], v13 offset:26624
    v_mfma_f32_16x16x32_bf16 v[132:135], a[116:119], a[12:15], v[132:135]
    ds_read_b128 a[100:103], v13 offset:27648
    v_mfma_f32_16x16x32_bf16 v[136:139], a[120:123], a[8:11], v[136:139]
    ds_read_b128 a[104:107], v13 offset:28672
    v_mfma_f32_16x16x32_bf16 v[140:143], a[120:123], a[12:15], v[140:143]
    ds_read_b128 a[108:111], v13 offset:29696
    v_mfma_f32_16x16x32_bf16 v[144:147], a[124:127], a[8:11], v[144:147]
    ds_read_b128 a[112:115], v13 offset:30720
    v_mfma_f32_16x16x32_bf16 v[148:151], a[124:127], a[12:15], v[148:151]
    buffer_load_dwordx4 v12, s[44:47], s72 offen offset:2048 sc1 lds
    v_mfma_f32_16x16x32_bf16 v[152:155], a[128:131], a[8:11], v[152:155]
    s_waitcnt vmcnt(11)
    v_mov_b32 v43, 1
    buffer_atomic_add v43, v42, s[60:63], 0 offen
    v_mfma_f32_16x16x32_bf16 v[156:159], a[128:131], a[12:15], v[156:159]
    buffer_load_dwordx4 v12, s[44:47], s72 offen offset:3072 sc1 lds
    v_mfma_f32_16x16x32_bf16 v[160:163], a[132:135], a[8:11], v[160:163]
    v_mfma_f32_16x16x32_bf16 v[164:167], a[132:135], a[12:15], v[164:167]
    s_waitcnt lgkmcnt(0)
    v_mfma_f32_16x16x32_bf16 v[128:131], a[96:99], a[16:19], v[128:131]
    ds_read_b128 a[116:119], v13 offset:31744
    v_mfma_f32_16x16x32_bf16 v[132:135], a[96:99], a[20:23], v[132:135]
    ds_read_b128 a[120:123], v13 offset:32768
    v_mfma_f32_16x16x32_bf16 v[136:139], a[100:103], a[16:19], v[136:139]
    ds_read_b128 a[124:127], v13 offset:33792
    v_mfma_f32_16x16x32_bf16 v[140:143], a[100:103], a[20:23], v[140:143]
    ds_read_b128 a[128:131], v13 offset:34816
    v_mfma_f32_16x16x32_bf16 v[144:147], a[104:107], a[16:19], v[144:147]
    ds_read_b128 a[132:135], v13 offset:35840
    v_mfma_f32_16x16x32_bf16 v[148:151], a[104:107], a[20:23], v[148:151]
    s_add_u32 m0, s3, 147456
    s_add_u32 s72, s72, 4096
    buffer_load_dwordx4 v12, s[44:47], s72 offen offset:0 sc1 lds
    v_mfma_f32_16x16x32_bf16 v[152:155], a[108:111], a[16:19], v[152:155]
    v_mfma_f32_16x16x32_bf16 v[156:159], a[108:111], a[20:23], v[156:159]
    s_add_u32 s72, s75, 1
    s_cmp_ge_u32 s72, 5
    s_cselect_b32 s69, 5, 0
    s_sub_u32 s72, s72, s69
    s_mul_i32 s72, s72, 4
    s_add_u32 s72, s72, 54
    s_mul_i32 s72, s72, 5120
    s_add_u32 m0, s3, 0
    s_add_u32 s72, s72, s3
    buffer_load_dwordx4 v12, s[44:47], s72 offen offset:0 sc1 lds
    v_mfma_f32_16x16x32_bf16 v[160:163], a[112:115], a[16:19], v[160:163]
    v_mfma_f32_16x16x32_bf16 v[164:167], a[112:115], a[20:23], v[164:167]
    s_waitcnt lgkmcnt(0)
    v_mfma_f32_16x16x32_bf16 v[128:131], a[116:119], a[24:27], v[128:131]
    s_barrier
    ds_read_b128 a[96:99], v13 offset:36864
    v_mfma_f32_16x16x32_bf16 v[132:135], a[116:119], a[28:31], v[132:135]
    ds_read_b128 a[100:103], v13 offset:37888
    s_lshl_b32 s64, s86, 7
    v_mfma_f32_16x16x32_bf16 v[136:139], a[120:123], a[24:27], v[136:139]
    ds_read_b128 a[104:107], v13 offset:38912
    s_lshl_b32 s65, s38, 5
    v_mfma_f32_16x16x32_bf16 v[140:143], a[120:123], a[28:31], v[140:143]
    ds_read_b128 a[108:111], v13 offset:39936
    s_add_u32 s64, s64, s65
    v_mfma_f32_16x16x32_bf16 v[144:147], a[124:127], a[24:27], v[144:147]
    ds_read_b128 a[112:115], v13 offset:40960
    v_mfma_f32_16x16x32_bf16 v[148:151], a[124:127], a[28:31], v[148:151]
    buffer_load_dwordx4 v12, s[44:47], s72 offen offset:1024 sc1 lds
    v_mfma_f32_16x16x32_bf16 v[152:155], a[128:131], a[24:27], v[152:155]
    s_mul_i32 s64, s64, 1280
    s_mul_i32 s65, s87, 160
    v_mfma_f32_16x16x32_bf16 v[156:159], a[128:131], a[28:31], v[156:159]
    buffer_load_dwordx4 v12, s[44:47], s72 offen offset:2048 sc1 lds
    v_mfma_f32_16x16x32_bf16 v[160:163], a[132:135], a[24:27], v[160:163]
    s_add_u32 s64, s64, s65
    v_mfma_f32_16x16x32_bf16 v[164:167], a[132:135], a[28:31], v[164:167]
    s_waitcnt lgkmcnt(0)
    v_mfma_f32_16x16x32_bf16 v[128:131], a[96:99], a[32:35], v[128:131]
    ds_read_b128 a[116:119], v13 offset:41984
    v_mfma_f32_16x16x32_bf16 v[132:135], a[96:99], a[36:39], v[132:135]
    ds_read_b128 a[120:123], v13 offset:43008
    s_add_u32 s12, s32, s64
    s_addc_u32 s13, s33, 0
    v_mfma_f32_16x16x32_bf16 v[136:139], a[100:103], a[32:35], v[136:139]
    ds_read_b128 a[124:127], v13 offset:44032
    s_mov_b32 s15, 0x00020000
    v_mfma_f32_16x16x32_bf16 v[140:143], a[100:103], a[36:39], v[140:143]
    ds_read_b128 a[128:131], v13 offset:45056
    s_sub_u32 s14, 2621440, s64
    v_mfma_f32_16x16x32_bf16 v[144:147], a[104:107], a[32:35], v[144:147]
    ds_read_b128 a[132:135], v13 offset:46080
    v_mfma_f32_16x16x32_bf16 v[148:151], a[104:107], a[36:39], v[148:151]
    buffer_load_dwordx4 v12, s[44:47], s72 offen offset:3072 sc1 lds
    v_mfma_f32_16x16x32_bf16 v[152:155], a[108:111], a[32:35], v[152:155]
    v_and_b32 v45, 15, v1
    v_mfma_f32_16x16x32_bf16 v[156:159], a[108:111], a[36:39], v[156:159]
    s_add_u32 m0, s3, 4096
    s_add_u32 s72, s72, 4096
    buffer_load_dwordx4 v12, s[44:47], s72 offen offset:0 sc1 lds
    v_mfma_f32_16x16x32_bf16 v[160:163], a[112:115], a[32:35], v[160:163]
    v_mul_u32_u24 v45, 1280, v45
    v_lshrrev_b32 v46, 4, v1
    v_mfma_f32_16x16x32_bf16 v[164:167], a[112:115], a[36:39], v[164:167]
    s_waitcnt lgkmcnt(0)
    v_mfma_f32_16x16x32_bf16 v[128:131], a[116:119], a[40:43], v[128:131]
    ds_read_b128 a[96:99], v13 offset:47104
    v_mfma_f32_16x16x32_bf16 v[132:135], a[116:119], a[44:47], v[132:135]
    ds_read_b128 a[100:103], v13 offset:48128
    v_lshl_add_u32 v45, v46, 3, v45
    v_mfma_f32_16x16x32_bf16 v[136:139], a[120:123], a[40:43], v[136:139]
    ds_read_b128 a[104:107], v13 offset:49152
    v_add_u32 v46, 20480, v45
    v_mfma_f32_16x16x32_bf16 v[140:143], a[120:123], a[44:47], v[140:143]
    ds_read_b128 a[108:111], v13 offset:50176
    v_mfma_f32_16x16x32_bf16 v[144:147], a[124:127], a[40:43], v[144:147]
    ds_read_b128 a[112:115], v13 offset:51200
    v_mfma_f32_16x16x32_bf16 v[148:151], a[124:127], a[44:47], v[148:151]
    s_add_u32 s72, s75, 2
    s_cmp_ge_u32 s72, 5
    s_cselect_b32 s69, 5, 0
    s_sub_u32 s72, s72, s69
    s_mul_i32 s72, s72, 4
    s_add_u32 s72, s72, 54
    s_mul_i32 s72, s72, 5120
    s_add_u32 m0, s3, 20480
    s_add_u32 s72, s72, s3
    buffer_load_dwordx4 v12, s[44:47], s72 offen offset:0 sc1 lds
    v_mfma_f32_16x16x32_bf16 v[152:155], a[128:131], a[40:43], v[152:155]
    v_and_b32 v240, 15, v1
    v_mfma_f32_16x16x32_bf16 v[156:159], a[128:131], a[44:47], v[156:159]
    buffer_load_dwordx4 v12, s[44:47], s72 offen offset:1024 sc1 lds
    v_mfma_f32_16x16x32_bf16 v[160:163], a[132:135], a[40:43], v[160:163]
    v_lshrrev_b32 v241, 4, v1
    v_lshlrev_b32 v241, 3, v241
    v_mfma_f32_16x16x32_bf16 v[164:167], a[132:135], a[44:47], v[164:167]
    v_sub_u32 v240, v240, v241
    s_waitcnt lgkmcnt(0)
    v_mfma_f32_16x16x32_bf16 v[128:131], a[96:99], a[48:51], v[128:131]
    ds_read_b128 a[116:119], v13 offset:52224
    v_mov_b32 v242, 0x3f80
    v_mfma_f32_16x16x32_bf16 v[132:135], a[96:99], a[52:55], v[132:135]
    ds_read_b128 a[120:123], v13 offset:53248
    v_mov_b32 v243, 0x3f800000
    v_mfma_f32_16x16x32_bf16 v[136:139], a[100:103], a[48:51], v[136:139]
    ds_read_b128 a[124:127], v13 offset:54272
    v_mov_b32 v244, 0
    v_mfma_f32_16x16x32_bf16 v[140:143], a[100:103], a[52:55], v[140:143]
    ds_read_b128 a[128:131], v13 offset:55296
    v_add_u32 v241, 16, v240
    v_mfma_f32_16x16x32_bf16 v[144:147], a[104:107], a[48:51], v[144:147]
    ds_read_b128 a[132:135], v13 offset:56320
    v_cmp_eq_u32 vcc, 0, v240
    s_nop 1
    v_cndmask_b32 v232, v244, v242, vcc
    v_mfma_f32_16x16x32_bf16 v[148:151], a[104:107], a[52:55], v[148:151]
    buffer_load_dwordx4 v12, s[44:47], s72 offen offset:2048 sc1 lds
    v_mfma_f32_16x16x32_bf16 v[152:155], a[108:111], a[48:51], v[152:155]
    v_cmp_eq_u32 vcc, 1, v240
    s_nop 1
    v_cndmask_b32 v232, v232, v243, vcc
    v_cmp_eq_u32 vcc, 2, v240
    s_nop 1
    v_cndmask_b32 v233, v244, v242, vcc
    v_mfma_f32_16x16x32_bf16 v[156:159], a[108:111], a[52:55], v[156:159]
    buffer_load_dwordx4 v12, s[44:47], s72 offen offset:3072 sc1 lds
    v_mfma_f32_16x16x32_bf16 v[160:163], a[112:115], a[48:51], v[160:163]
    v_cmp_eq_u32 vcc, 3, v240
    s_nop 1
    v_cndmask_b32 v233, v233, v243, vcc
    v_cmp_eq_u32 vcc, 4, v240
    s_nop 1
    v_cndmask_b32 v234, v244, v242, vcc
    v_mfma_f32_16x16x32_bf16 v[164:167], a[112:115], a[52:55], v[164:167]
    v_cmp_eq_u32 vcc, 5, v240
    s_nop 1
    v_cndmask_b32 v234, v234, v243, vcc
    s_waitcnt lgkmcnt(0)
    v_mfma_f32_16x16x32_bf16 v[128:131], a[116:119], a[56:59], v[128:131]
    s_barrier
    ds_read_b128 a[96:99], v13 offset:57344
    v_mfma_f32_16x16x32_bf16 v[132:135], a[116:119], a[60:63], v[132:135]
    ds_read_b128 a[100:103], v13 offset:58368
    v_cmp_eq_u32 vcc, 6, v240
    s_nop 1
    v_cndmask_b32 v235, v244, v242, vcc
    v_mfma_f32_16x16x32_bf16 v[136:139], a[120:123], a[56:59], v[136:139]
    ds_read_b128 a[104:107], v13 offset:59392
    v_cmp_eq_u32 vcc, 7, v240
    s_nop 1
    v_cndmask_b32 v235, v235, v243, vcc
    v_mfma_f32_16x16x32_bf16 v[140:143], a[120:123], a[60:63], v[140:143]
    ds_read_b128 a[108:111], v13 offset:60416
    v_cmp_eq_u32 vcc, 0, v241
    s_nop 1
    v_cndmask_b32 v236, v244, v242, vcc
    v_cmp_eq_u32 vcc, 1, v241
    s_nop 1
    v_cndmask_b32 v236, v236, v243, vcc
    v_mfma_f32_16x16x32_bf16 v[144:147], a[124:127], a[56:59], v[144:147]
    ds_read_b128 a[112:115], v13 offset:61440
    v_cmp_eq_u32 vcc, 2, v241
    s_nop 1
    v_cndmask_b32 v237, v244, v242, vcc
    v_mfma_f32_16x16x32_bf16 v[148:151], a[124:127], a[60:63], v[148:151]
    s_add_u32 m0, s3, 24576
    s_add_u32 s72, s72, 4096
    buffer_load_dwordx4 v12, s[44:47], s72 offen offset:0 sc1 lds
    v_mfma_f32_16x16x32_bf16 v[152:155], a[128:131], a[56:59], v[152:155]
    s_lshl_b32 s64, s86, 12
    s_add_u32 s64, s64, 768
    v_min_u32 v30, 3, v1
    v_lshl_add_u32 v30, v30, 7, s64
    v_mfma_f32_16x16x32_bf16 v[156:159], a[128:131], a[60:63], v[156:159]
    s_add_u32 s72, s75, 3
    s_cmp_ge_u32 s72, 5
    s_cselect_b32 s69, 5, 0
    s_sub_u32 s72, s72, s69
    s_mul_i32 s72, s72, 4
    s_add_u32 s72, s72, 54
    s_mul_i32 s72, s72, 5120
    s_add_u32 m0, s3, 40960
    s_add_u32 s72, s72, s3
    buffer_load_dwordx4 v12, s[44:47], s72 offen offset:0 sc1 lds
    v_mfma_f32_16x16x32_bf16 v[160:163], a[132:135], a[56:59], v[160:163]
    v_mov_b32 v31, 8
    buffer_load_dword v44, v30, s[60:63], s73 offen sc1
    v_mfma_f32_16x16x32_bf16 v[164:167], a[132:135], a[60:63], v[164:167]
    v_cmp_eq_u32 vcc, 3, v241
    s_nop 1
    v_cndmask_b32 v237, v237, v243, vcc
    s_waitcnt lgkmcnt(0)
    s_waitcnt vmcnt(22)
    v_mfma_f32_16x16x32_bf16 v[128:131], a[96:99], a[64:67], v[128:131]
    ds_read_b128 a[116:119], v13 offset:62464
    v_mfma_f32_16x16x32_bf16 v[132:135], a[96:99], a[68:71], v[132:135]
    ds_read_b128 a[120:123], v13 offset:63488
    v_cmp_eq_u32 vcc, 4, v241
    s_nop 1
    v_cndmask_b32 v238, v244, v242, vcc
    v_mfma_f32_16x16x32_bf16 v[136:139], a[100:103], a[64:67], v[136:139]
    ds_read_b128 a[124:127], v13 offset:64512
    v_cmp_eq_u32 vcc, 5, v241
    s_nop 1
    v_cndmask_b32 v238, v238, v243, vcc
    v_mfma_f32_16x16x32_bf16 v[140:143], a[100:103], a[68:71], v[140:143]
    ds_read_b128 a[128:131], v14 offset:0
    v_cmp_eq_u32 vcc, 6, v241
    s_nop 1
    v_cndmask_b32 v239, v244, v242, vcc
    v_mfma_f32_16x16x32_bf16 v[144:147], a[104:107], a[64:67], v[144:147]
    ds_read_b128 a[132:135], v14 offset:1024
    v_cmp_eq_u32 vcc, 7, v241
    s_nop 1
    v_cndmask_b32 v239, v239, v243, vcc
    v_mfma_f32_16x16x32_bf16 v[148:151], a[104:107], a[68:71], v[148:151]
    buffer_load_dwordx4 v12, s[44:47], s72 offen offset:1024 sc1 lds
    v_mfma_f32_16x16x32_bf16 v[152:155], a[108:111], a[64:67], v[152:155]
    v_and_b32 v52, 15, v1
    v_bfe_u32 v53, v1, 4, 1
    v_lshlrev_b32 v53, 2, v53
    v_mfma_f32_16x16x32_bf16 v[156:159], a[108:111], a[68:71], v[156:159]
    buffer_load_dwordx4 v12, s[44:47], s72 offen offset:2048 sc1 lds
    v_mfma_f32_16x16x32_bf16 v[160:163], a[112:115], a[64:67], v[160:163]
    v_sub_u32 v52, v52, v53
    v_and_b32 v53, 4, v52
    s_lshl_b32 s64, s86, 3
    v_mfma_f32_16x16x32_bf16 v[164:167], a[112:115], a[68:71], v[164:167]
    s_and_b32 s65, s87, 6
    s_add_u32 s64, s64, s65
    v_mfma_f32_16x16x32_bf16 v[128:131], v[232:235], a[232:235], v[128:131]
    s_waitcnt lgkmcnt(0)
    s_waitcnt vmcnt(22)
    v_mfma_f32_16x16x32_bf16 v[128:131], a[116:119], a[72:75], v[128:131]
    ds_read_b128 a[96:99], v14 offset:2048
    v_lshrrev_b32 v54, 3, v52
    v_mfma_f32_16x16x32_bf16 v[132:135], a[116:119], a[76:79], v[132:135]
    ds_read_b128 a[100:103], v14 offset:3072
    s_mul_i32 s64, s64, 40960
    v_and_b32 v54, 1, v54
    s_mul_i32 s65, s38, 10240
    v_mfma_f32_16x16x32_bf16 v[136:139], a[120:123], a[72:75], v[136:139]
    ds_read_b128 a[104:107], v14 offset:4096
    v_mfma_f32_16x16x32_bf16 v[132:135], v[232:235], a[236:239], v[132:135]
    v_lshlrev_b32 v54, 2, v54
    v_mfma_f32_16x16x32_bf16 v[140:143], a[120:123], a[76:79], v[140:143]
    ds_read_b128 a[108:111], v14 offset:5120
    s_add_u32 s64, s64, s65
    v_sub_u32 v54, v52, v54
    s_add_u32 s64, s64, 13631488
    v_mfma_f32_16x16x32_bf16 v[144:147], a[124:127], a[72:75], v[144:147]
    ds_read_b128 a[112:115], v14 offset:6144
    v_mfma_f32_16x16x32_bf16 v[136:139], v[236:239], a[232:235], v[136:139]
    s_add_u32 s48, s36, s64
    s_addc_u32 s49, s37, 0
    v_mfma_f32_16x16x32_bf16 v[148:151], a[124:127], a[76:79], v[148:151]
    s_mov_b32 s50, 51200
    buffer_load_dwordx4 v12, s[44:47], s72 offen offset:3072 sc1 lds
    v_mfma_f32_16x16x32_bf16 v[152:155], a[128:131], a[72:75], v[152:155]
    v_cmp_eq_u32 vcc, 0, v53
    v_mov_b32 v55, 64
    s_nop 0
    v_cndmask_b32 v54, v55, v54, vcc
    s_mov_b32 s51, 0x00020000
    v_mfma_f32_16x16x32_bf16 v[140:143], v[236:239], a[236:239], v[140:143]
    v_mfma_f32_16x16x32_bf16 v[156:159], a[128:131], a[76:79], v[156:159]
    v_mov_b32 v56, 0x3f80
    s_add_u32 m0, s3, 45056
    s_add_u32 s72, s72, 4096
    buffer_load_dwordx4 v12, s[44:47], s72 offen offset:0 sc1 lds
    v_mfma_f32_16x16x32_bf16 v[160:163], a[132:135], a[72:75], v[160:163]
    s_and_b32 s65, s87, 1
    v_mov_b32 v57, 0x3f800000
    s_mul_i32 s65, s65, 5120
    v_mfma_f32_16x16x32_bf16 v[144:147], v[232:235], a[240:243], v[144:147]
    v_mfma_f32_16x16x32_bf16 v[164:167], a[132:135], a[76:79], v[164:167]
    v_mov_b32 v58, 0
    v_and_b32 v50, 15, v1
    v_bfe_u32 v51, v1, 4, 1
    v_mfma_f32_16x16x32_bf16 v[148:151], v[232:235], a[244:247], v[148:151]
    s_waitcnt lgkmcnt(0)
    s_waitcnt vmcnt(22)
    v_mfma_f32_16x16x32_bf16 v[128:131], a[96:99], a[80:83], v[128:131]
    ds_read_b128 a[116:119], v14 offset:7168
    v_cmp_eq_u32 vcc, 0, v54
    s_nop 1
    v_cndmask_b32 v64, v58, v56, vcc
    v_mfma_f32_16x16x32_bf16 v[132:135], a[96:99], a[84:87], v[132:135]
    ds_read_b128 a[120:123], v14 offset:8192
    v_lshl_add_u32 v50, v51, 5, v50
    v_lshlrev_b32 v50, 4, v50
    v_cmp_eq_u32 vcc, 1, v54
    s_nop 1
    v_cndmask_b32 v64, v64, v57, vcc
    v_mfma_f32_16x16x32_bf16 v[136:139], a[100:103], a[80:83], v[136:139]
    ds_read_b128 a[124:127], v14 offset:9216
    v_lshrrev_b32 v51, 5, v1
    v_mfma_f32_16x16x32_bf16 v[152:155], v[236:239], a[240:243], v[152:155]
    v_mfma_f32_16x16x32_bf16 v[140:143], a[100:103], a[84:87], v[140:143]
    ds_read_b128 a[128:131], v14 offset:10240
    v_cmp_eq_u32 vcc, 2, v54
    s_nop 1
    v_cndmask_b32 v65, v58, v56, vcc
    v_mul_u32_u24 v51, 40960, v51
    v_cmp_eq_u32 vcc, 3, v54
    s_nop 1
    v_cndmask_b32 v65, v65, v57, vcc
    v_mfma_f32_16x16x32_bf16 v[144:147], a[104:107], a[80:83], v[144:147]
    ds_read_b128 a[132:135], v14 offset:11264
    v_add_u32 v50, v50, v51
    v_mfma_f32_16x16x32_bf16 v[156:159], v[236:239], a[244:247], v[156:159]
    v_add_u32 v50, s65, v50
    v_cmp_eq_u32 vcc, 4, v54
    s_nop 1
    v_cndmask_b32 v66, v58, v56, vcc
    v_mfma_f32_16x16x32_bf16 v[148:151], a[104:107], a[84:87], v[148:151]
    s_add_u32 s72, s75, 4
    s_cmp_ge_u32 s72, 5
    s_cselect_b32 s69, 5, 0
    s_sub_u32 s72, s72, s69
    s_mul_i32 s72, s72, 4
    s_add_u32 s72, s72, 54
    s_mul_i32 s72, s72, 5120
    s_add_u32 m0, s3, 61440
    s_add_u32 s72, s72, s3
    buffer_load_dwordx4 v12, s[44:47], s72 offen offset:0 sc1 lds
    v_mfma_f32_16x16x32_bf16 v[152:155], a[108:111], a[80:83], v[152:155]
    s_movk_i32 s68, 4096
    v_mfma_f32_16x16x32_bf16 v[160:163], v[232:235], a[248:251], v[160:163]
    v_cmp_eq_u32 vcc, 5, v54
    s_nop 1
    v_cndmask_b32 v66, v66, v57, vcc
    v_mfma_f32_16x16x32_bf16 v[156:159], a[108:111], a[84:87], v[156:159]
    buffer_load_dwordx4 v12, s[44:47], s72 offen offset:1024 sc1 lds
    v_mfma_f32_16x16x32_bf16 v[160:163], a[112:115], a[80:83], v[160:163]
    v_cmp_eq_u32 vcc, 6, v54
    s_nop 1
    v_cndmask_b32 v67, v58, v56, vcc
    v_mfma_f32_16x16x32_bf16 v[164:167], v[232:235], a[252:255], v[164:167]
    v_cmp_eq_u32 vcc, 7, v54
    s_nop 1
    v_cndmask_b32 v67, v67, v57, vcc
    v_mfma_f32_16x16x32_bf16 v[164:167], a[112:115], a[84:87], v[164:167]
    s_waitcnt vmcnt(6)
    v_cmp_le_u32 vcc, v31, v44
    s_nop 1
    s_cmp_eq_u64 vcc, -1
    s_cbranch_scc1 L_oc_12_ok
    s_cmp_lg_u32 s38, 0
    s_cbranch_scc1 L_oc_12_ok
    s_mov_b32 s69, 0
L_oc_12_spin:
    buffer_load_dword v44, v30, s[60:63], 0 offen sc1
    s_waitcnt vmcnt(0)
    v_cmp_le_u32 vcc, v31, v44
    s_nop 1
    s_cmp_eq_u64 vcc, -1
    s_cbranch_scc1 L_oc_12_ok
    s_sleep 2
    s_add_u32 s69, s69, 1
    s_cmp_lt_u32 s69, 0x4000
    s_cbranch_scc1 L_oc_12_spin
L_oc_12_ok:
    s_waitcnt lgkmcnt(0)
    v_mfma_f32_16x16x32_bf16 v[128:131], a[116:119], a[88:91], v[128:131]
    s_barrier
    ds_read_b128 a[96:99], v14 offset:12288
    v_mfma_f32_16x16x32_bf16 v[132:135], a[116:119], a[92:95], v[132:135]
    ds_read_b128 a[100:103], v14 offset:13312
    v_mfma_f32_16x16x32_bf16 v[136:139], a[120:123], a[88:91], v[136:139]
    ds_read_b128 a[104:107], v14 offset:14336
    v_mfma_f32_16x16x32_bf16 v[140:143], a[120:123], a[92:95], v[140:143]
    ds_read_b128 a[108:111], v14 offset:15360
    v_mfma_f32_16x16x32_bf16 v[144:147], a[124:127], a[88:91], v[144:147]
    ds_read_b128 a[112:115], v14 offset:16384
    s_add_u32 m0, s3, 61440
    v_mfma_f32_16x16x32_bf16 v[148:151], a[124:127], a[92:95], v[148:151]
    buffer_load_dwordx4 v12, s[44:47], s72 offen offset:2048 sc1 lds
    v_mfma_f32_16x16x32_bf16 v[152:155], a[128:131], a[88:91], v[152:155]
    v_mfma_f32_16x16x32_bf16 v[156:159], a[128:131], a[92:95], v[156:159]
    buffer_load_dwordx4 v12, s[44:47], s72 offen offset:3072 sc1 lds
    v_mfma_f32_16x16x32_bf16 v[160:163], a[132:135], a[88:91], v[160:163]
    v_mfma_f32_16x16x32_bf16 v[164:167], a[132:135], a[92:95], v[164:167]
    s_add_u32 s71, s75, 0
    s_cmp_ge_u32 s71, 5
    s_cselect_b32 s69, 5, 0
    s_sub_u32 s71, s71, s69
    s_mul_i32 s71, s71, 4
    s_add_u32 s71, s71, 54
    s_mul_i32 s71, s71, 1024
    buffer_load_dwordx4 a[0:3], v12, s[52:55], s71 offen offset:0 sc1
    buffer_load_dwordx4 a[4:7], v15, s[52:55], s71 offen offset:0 sc1
    buffer_load_dwordx4 a[8:11], v12, s[52:55], s71 offen offset:1024 sc1
    buffer_load_dwordx4 a[12:15], v15, s[52:55], s71 offen offset:1024 sc1
    buffer_load_dwordx4 a[16:19], v12, s[52:55], s71 offen offset:2048 sc1
    buffer_load_dwordx4 a[20:23], v15, s[52:55], s71 offen offset:2048 sc1
    buffer_load_dwordx4 a[24:27], v12, s[52:55], s71 offen offset:3072 sc1
    buffer_load_dwordx4 a[28:31], v15, s[52:55], s71 offen offset:3072 sc1
    s_add_u32 s70, s75, 1
    s_cmp_ge_u32 s70, 5
    s_cselect_b32 s69, 5, 0
    s_sub_u32 s70, s70, s69
    s_mul_i32 s70, s70, 4
    s_add_u32 s70, s70, 54
    s_mul_i32 s70, s70, 1024
    buffer_load_dwordx4 a[32:35], v12, s[52:55], s70 offen offset:0 sc1
    buffer_load_dwordx4 a[36:39], v15, s[52:55], s70 offen offset:0 sc1
    buffer_load_dwordx4 a[40:43], v12, s[52:55], s70 offen offset:1024 sc1
    buffer_load_dwordx4 a[44:47], v15, s[52:55], s70 offen offset:1024 sc1
    buffer_load_dwordx4 a[48:51], v12, s[52:55], s70 offen offset:2048 sc1
    buffer_load_dwordx4 a[52:55], v15, s[52:55], s70 offen offset:2048 sc1
    buffer_load_dwordx4 a[56:59], v12, s[52:55], s70 offen offset:3072 sc1
    buffer_load_dwordx4 a[60:63], v15, s[52:55], s70 offen offset:3072 sc1
    s_add_u32 s71, s75, 2
    s_cmp_ge_u32 s71, 5
    s_cselect_b32 s69, 5, 0
    s_sub_u32 s71, s71, s69
    s_mul_i32 s71, s71, 4
    s_add_u32 s71, s71, 54
    s_mul_i32 s71, s71, 1024
    buffer_load_dwordx4 a[64:67], v12, s[52:55], s71 offen offset:0 sc1
    buffer_load_dwordx4 a[68:71], v15, s[52:55], s71 offen offset:0 sc1
    buffer_load_dwordx4 a[72:75], v12, s[52:55], s71 offen offset:1024 sc1
    buffer_load_dwordx4 a[76:79], v15, s[52:55], s71 offen offset:1024 sc1
    buffer_load_dwordx4 a[80:83], v12, s[52:55], s71 offen offset:2048 sc1
    buffer_load_dwordx4 a[84:87], v15, s[52:55], s71 offen offset:2048 sc1
    buffer_load_dwordx4 a[88:91], v12, s[52:55], s71 offen offset:3072 sc1
    buffer_load_dwordx4 a[92:95], v15, s[52:55], s71 offen offset:3072 sc1
    s_waitcnt lgkmcnt(0)
    s_waitcnt vmcnt(22)
    v_mfma_f32_16x16x32_bf16 v[128:131], a[96:99], a[0:3], v[128:131]
    ds_read_b128 a[116:119], v14 offset:17408
    v_mfma_f32_16x16x32_bf16 v[132:135], a[96:99], a[4:7], v[132:135]
    ds_read_b128 a[120:123], v14 offset:18432
    v_mfma_f32_16x16x32_bf16 v[136:139], a[100:103], a[0:3], v[136:139]
    ds_read_b128 a[124:127], v14 offset:19456
    v_mfma_f32_16x16x32_bf16 v[140:143], a[100:103], a[4:7], v[140:143]
    ds_read_b128 a[128:131], v14 offset:20480
    v_mfma_f32_16x16x32_bf16 v[144:147], a[104:107], a[0:3], v[144:147]
    ds_read_b128 a[132:135], v14 offset:21504
    v_mfma_f32_16x16x32_bf16 v[148:151], a[104:107], a[4:7], v[148:151]
    s_add_u32 m0, s3, 65536
    s_add_u32 s72, s72, 4096
    buffer_load_dwordx4 v12, s[44:47], s72 offen offset:0 sc1 lds
    v_mfma_f32_16x16x32_bf16 v[152:155], a[108:111], a[0:3], v[152:155]
    v_mfma_f32_16x16x32_bf16 v[156:159], a[108:111], a[4:7], v[156:159]
    s_mov_b32 s72, 266240
    s_add_u32 s72, s72, s3
    s_cmp_lt_u32 s38, 2
    s_cselect_b32 s72, s72, 0x40000000
    s_add_u32 m0, s3, 81920
    s_nop 0
    buffer_load_dwordx4 v12, s[44:47], s72 offen offset:0 sc1 lds
    v_mfma_f32_16x16x32_bf16 v[160:163], a[112:115], a[0:3], v[160:163]
    v_mfma_f32_16x16x32_bf16 v[164:167], a[112:115], a[4:7], v[164:167]
    s_add_u32 s70, s75, 3
    s_cmp_ge_u32 s70, 5
    s_cselect_b32 s69, 5, 0
    s_sub_u32 s70, s70, s69
    s_mul_i32 s70, s70, 4
    s_add_u32 s70, s70, 54
    s_mul_i32 s70, s70, 1024
    buffer_load_dwordx4 a[0:3], v12, s[52:55], s70 offen offset:0 sc1
    buffer_load_dwordx4 a[4:7], v15, s[52:55], s70 offen offset:0 sc1
    s_waitcnt lgkmcnt(0)
    s_waitcnt vmcnt(24)
    v_mfma_f32_16x16x32_bf16 v[128:131], a[116:119], a[8:11], v[128:131]
    ds_read_b128 a[96:99], v14 offset:22528
    v_mfma_f32_16x16x32_bf16 v[132:135], a[116:119], a[12:15], v[132:135]
    ds_read_b128 a[100:103], v14 offset:23552
    v_mfma_f32_16x16x32_bf16 v[136:139], a[120:123], a[8:11], v[136:139]
    ds_read_b128 a[104:107], v14 offset:24576
    v_mfma_f32_16x16x32_bf16 v[140:143], a[120:123], a[12:15], v[140:143]
    ds_read_b128 a[108:111], v14 offset:25600
    v_mfma_f32_16x16x32_bf16 v[144:147], a[124:127], a[8:11], v[144:147]
    ds_read_b128 a[112:115], v14 offset:26624
    v_mfma_f32_16x16x32_bf16 v[148:151], a[124:127], a[12:15], v[148:151]
    buffer_load_dwordx4 v12, s[44:47], s72 offen offset:1024 sc1 lds
    v_mfma_f32_16x16x32_bf16 v[152:155], a[128:131], a[8:11], v[152:155]
    v_mfma_f32_16x16x32_bf16 v[156:159], a[128:131], a[12:15], v[156:159]
    buffer_load_dwordx4 v12, s[44:47], s72 offen offset:2048 sc1 lds
    v_mfma_f32_16x16x32_bf16 v[160:163], a[132:135], a[8:11], v[160:163]
    v_mfma_f32_16x16x32_bf16 v[164:167], a[132:135], a[12:15], v[164:167]
    buffer_load_dwordx4 a[8:11], v12, s[52:55], s70 offen offset:1024 sc1
    buffer_load_dwordx4 a[12:15], v15, s[52:55], s70 offen offset:1024 sc1
    s_waitcnt lgkmcnt(0)
    s_waitcnt vmcnt(26)
    v_mfma_f32_16x16x32_bf16 v[128:131], a[96:99], a[16:19], v[128:131]
    ds_read_b128 a[116:119], v14 offset:27648
    v_mfma_f32_16x16x32_bf16 v[132:135], a[96:99], a[20:23], v[132:135]
    ds_read_b128 a[120:123], v14 offset:28672
    v_mfma_f32_16x16x32_bf16 v[136:139], a[100:103], a[16:19], v[136:139]
    ds_read_b128 a[124:127], v14 offset:29696
    v_mfma_f32_16x16x32_bf16 v[140:143], a[100:103], a[20:23], v[140:143]
    ds_read_b128 a[128:131], v14 offset:30720
    v_mfma_f32_16x16x32_bf16 v[144:147], a[104:107], a[16:19], v[144:147]
    ds_read_b128 a[132:135], v14 offset:31744
    v_mfma_f32_16x16x32_bf16 v[148:151], a[104:107], a[20:23], v[148:151]
    buffer_load_dwordx4 v12, s[44:47], s72 offen offset:3072 sc1 lds
    v_mfma_f32_16x16x32_bf16 v[152:155], a[108:111], a[16:19], v[152:155]
    v_mfma_f32_16x16x32_bf16 v[156:159], a[108:111], a[20:23], v[156:159]
    s_add_u32 m0, s3, 86016
    s_add_u32 s72, s72, 4096
    buffer_load_dwordx4 v12, s[44:47], s72 offen offset:0 sc1 lds
    v_mfma_f32_16x16x32_bf16 v[160:163], a[112:115], a[16:19], v[160:163]
    v_mfma_f32_16x16x32_bf16 v[164:167], a[112:115], a[20:23], v[164:167]
    buffer_load_dwordx4 a[16:19], v12, s[52:55], s70 offen offset:2048 sc1
    buffer_load_dwordx4 a[20:23], v15, s[52:55], s70 offen offset:2048 sc1
    s_waitcnt lgkmcnt(0)
    s_waitcnt vmcnt(28)
    v_mfma_f32_16x16x32_bf16 v[128:131], a[116:119], a[24:27], v[128:131]
    s_barrier
    ds_read_b128 a[96:99], v12 offset:0
    v_mfma_f32_16x16x32_bf16 v[132:135], a[116:119], a[28:31], v[132:135]
    ds_read_b128 a[100:103], v12 offset:1024
    v_mfma_f32_16x16x32_bf16 v[136:139], a[120:123], a[24:27], v[136:139]
    ds_read_b128 a[104:107], v12 offset:2048
    v_mfma_f32_16x16x32_bf16 v[140:143], a[120:123], a[28:31], v[140:143]
    ds_read_b128 a[108:111], v12 offset:3072
    v_mfma_f32_16x16x32_bf16 v[144:147], a[124:127], a[24:27], v[144:147]
    ds_read_b128 a[112:115], v12 offset:4096
    v_mfma_f32_16x16x32_bf16 v[148:151], a[124:127], a[28:31], v[148:151]
    v_mfma_f32_16x16x32_bf16 v[152:155], a[128:131], a[24:27], v[152:155]
    v_mfma_f32_16x16x32_bf16 v[156:159], a[128:131], a[28:31], v[156:159]
    v_mfma_f32_16x16x32_bf16 v[160:163], a[132:135], a[24:27], v[160:163]
    v_mfma_f32_16x16x32_bf16 v[164:167], a[132:135], a[28:31], v[164:167]
    buffer_load_dwordx4 a[24:27], v12, s[52:55], s70 offen offset:3072 sc1
    buffer_load_dwordx4 a[28:31], v15, s[52:55], s70 offen offset:3072 sc1
    s_waitcnt lgkmcnt(0)
    s_waitcnt vmcnt(28)
    v_mfma_f32_16x16x32_bf16 v[128:131], a[96:99], a[32:35], v[128:131]
    ds_read_b128 a[116:119], v12 offset:5120
    v_mfma_f32_16x16x32_bf16 v[132:135], a[96:99], a[36:39], v[132:135]
    ds_read_b128 a[120:123], v12 offset:6144
    v_mfma_f32_16x16x32_bf16 v[136:139], a[100:103], a[32:35], v[136:139]
    ds_read_b128 a[124:127], v12 offset:7168
    v_mfma_f32_16x16x32_bf16 v[140:143], a[100:103], a[36:39], v[140:143]
    ds_read_b128 a[128:131], v12 offset:8192
    v_mfma_f32_16x16x32_bf16 v[144:147], a[104:107], a[32:35], v[144:147]
    ds_read_b128 a[132:135], v12 offset:9216
    v_mfma_f32_16x16x32_bf16 v[148:151], a[104:107], a[36:39], v[148:151]
    v_mfma_f32_16x16x32_bf16 v[152:155], a[108:111], a[32:35], v[152:155]
    v_mfma_f32_16x16x32_bf16 v[156:159], a[108:111], a[36:39], v[156:159]
    v_mfma_f32_16x16x32_bf16 v[160:163], a[112:115], a[32:35], v[160:163]
    v_mfma_f32_16x16x32_bf16 v[164:167], a[112:115], a[36:39], v[164:167]
    s_add_u32 s71, s75, 4
    s_cmp_ge_u32 s71, 5
    s_cselect_b32 s69, 5, 0
    s_sub_u32 s71, s71, s69
    s_mul_i32 s71, s71, 4
    s_add_u32 s71, s71, 54
    s_mul_i32 s71, s71, 1024
    buffer_load_dwordx4 a[32:35], v12, s[52:55], s71 offen offset:0 sc1
    buffer_load_dwordx4 a[36:39], v15, s[52:55], s71 offen offset:0 sc1
    s_waitcnt lgkmcnt(0)
    s_waitcnt vmcnt(28)
    v_mfma_f32_16x16x32_bf16 v[128:131], a[116:119], a[40:43], v[128:131]
    ds_read_b128 a[96:99], v12 offset:10240
    v_mfma_f32_16x16x32_bf16 v[132:135], a[116:119], a[44:47], v[132:135]
    ds_read_b128 a[100:103], v12 offset:11264
    v_mfma_f32_16x16x32_bf16 v[136:139], a[120:123], a[40:43], v[136:139]
    ds_read_b128 a[104:107], v12 offset:12288
    v_mfma_f32_16x16x32_bf16 v[140:143], a[120:123], a[44:47], v[140:143]
    ds_read_b128 a[108:111], v12 offset:13312
    v_mfma_f32_16x16x32_bf16 v[144:147], a[124:127], a[40:43], v[144:147]
    ds_read_b128 a[112:115], v12 offset:14336
    v_mfma_f32_16x16x32_bf16 v[148:151], a[124:127], a[44:47], v[148:151]
    v_mfma_f32_16x16x32_bf16 v[152:155], a[128:131], a[40:43], v[152:155]
    v_mfma_f32_16x16x32_bf16 v[156:159], a[128:131], a[44:47], v[156:159]
    v_mfma_f32_16x16x32_bf16 v[160:163], a[132:135], a[40:43], v[160:163]
    v_mfma_f32_16x16x32_bf16 v[164:167], a[132:135], a[44:47], v[164:167]
    buffer_load_dwordx4 a[40:43], v12, s[52:55], s71 offen offset:1024 sc1
    buffer_load_dwordx4 a[44:47], v15, s[52:55], s71 offen offset:1024 sc1
    s_waitcnt lgkmcnt(0)
    s_waitcnt vmcnt(28)
    v_mfma_f32_16x16x32_bf16 v[128:131], a[96:99], a[48:51], v[128:131]
    ds_read_b128 a[116:119], v12 offset:15360
    v_mfma_f32_16x16x32_bf16 v[132:135], a[96:99], a[52:55], v[132:135]
    ds_read_b128 a[120:123], v12 offset:16384
    v_mfma_f32_16x16x32_bf16 v[136:139], a[100:103], a[48:51], v[136:139]
    ds_read_b128 a[124:127], v12 offset:17408
    v_mfma_f32_16x16x32_bf16 v[140:143], a[100:103], a[52:55], v[140:143]
    ds_read_b128 a[128:131], v12 offset:18432
    v_mfma_f32_16x16x32_bf16 v[144:147], a[104:107], a[48:51], v[144:147]
    ds_read_b128 a[132:135], v12 offset:19456
    v_mfma_f32_16x16x32_bf16 v[148:151], a[104:107], a[52:55], v[148:151]
    v_mfma_f32_16x16x32_bf16 v[152:155], a[108:111], a[48:51], v[152:155]
    v_mfma_f32_16x16x32_bf16 v[156:159], a[108:111], a[52:55], v[156:159]
    v_mfma_f32_16x16x32_bf16 v[160:163], a[112:115], a[48:51], v[160:163]
    v_mfma_f32_16x16x32_bf16 v[164:167], a[112:115], a[52:55], v[164:167]
    buffer_load_dwordx4 a[48:51], v12, s[52:55], s71 offen offset:2048 sc1
    buffer_load_dwordx4 a[52:55], v15, s[52:55], s71 offen offset:2048 sc1
    s_waitcnt lgkmcnt(0)
    s_waitcnt vmcnt(28)
    v_mfma_f32_16x16x32_bf16 v[128:131], a[116:119], a[56:59], v[128:131]
    s_barrier
    ds_read_b128 a[96:99], v12 offset:20480
    v_mfma_f32_16x16x32_bf16 v[132:135], a[116:119], a[60:63], v[132:135]
    ds_read_b128 a[100:103], v12 offset:21504
    v_mfma_f32_16x16x32_bf16 v[136:139], a[120:123], a[56:59], v[136:139]
    ds_read_b128 a[104:107], v12 offset:22528
    v_mfma_f32_16x16x32_bf16 v[140:143], a[120:123], a[60:63], v[140:143]
    ds_read_b128 a[108:111], v12 offset:23552
    v_mfma_f32_16x16x32_bf16 v[144:147], a[124:127], a[56:59], v[144:147]
    ds_read_b128 a[112:115], v12 offset:24576
    v_mfma_f32_16x16x32_bf16 v[148:151], a[124:127], a[60:63], v[148:151]
    s_lshl_b32 s64, s86, 12
    s_add_u32 s64, s64, 256
    v_mfma_f32_16x16x32_bf16 v[152:155], a[128:131], a[56:59], v[152:155]
    v_min_u32 v47, 3, v1
    v_lshl_add_u32 v47, v47, 7, s64
    v_mfma_f32_16x16x32_bf16 v[156:159], a[128:131], a[60:63], v[156:159]
    v_mov_b32 v48, 8
    v_mfma_f32_16x16x32_bf16 v[160:163], a[132:135], a[56:59], v[160:163]
    buffer_load_dword v49, v47, s[60:63], s73 offen sc1
    v_mfma_f32_16x16x32_bf16 v[164:167], a[132:135], a[60:63], v[164:167]
    buffer_load_dwordx4 a[56:59], v12, s[52:55], s71 offen offset:3072 sc1
    buffer_load_dwordx4 a[60:63], v15, s[52:55], s71 offen offset:3072 sc1
    s_waitcnt lgkmcnt(0)
    s_waitcnt vmcnt(29)
    v_mfma_f32_16x16x32_bf16 v[128:131], a[96:99], a[64:67], v[128:131]
    ds_read_b128 a[116:119], v12 offset:25600
    v_mfma_f32_16x16x32_bf16 v[132:135], a[96:99], a[68:71], v[132:135]
    ds_read_b128 a[120:123], v12 offset:26624
    v_mfma_f32_16x16x32_bf16 v[136:139], a[100:103], a[64:67], v[136:139]
    ds_read_b128 a[124:127], v12 offset:27648
    v_mfma_f32_16x16x32_bf16 v[140:143], a[100:103], a[68:71], v[140:143]
    ds_read_b128 a[128:131], v12 offset:28672
    v_mfma_f32_16x16x32_bf16 v[144:147], a[104:107], a[64:67], v[144:147]
    ds_read_b128 a[132:135], v12 offset:29696
    v_mfma_f32_16x16x32_bf16 v[148:151], a[104:107], a[68:71], v[148:151]
    v_mfma_f32_16x16x32_bf16 v[152:155], a[108:111], a[64:67], v[152:155]
    v_mfma_f32_16x16x32_bf16 v[156:159], a[108:111], a[68:71], v[156:159]
    v_mfma_f32_16x16x32_bf16 v[160:163], a[112:115], a[64:67], v[160:163]
    v_mfma_f32_16x16x32_bf16 v[164:167], a[112:115], a[68:71], v[164:167]
    s_waitcnt lgkmcnt(0)
    s_waitcnt vmcnt(27)
    v_mfma_f32_16x16x32_bf16 v[128:131], a[116:119], a[72:75], v[128:131]
    ds_read_b128 a[96:99], v12 offset:30720
    v_mfma_f32_16x16x32_bf16 v[132:135], a[116:119], a[76:79], v[132:135]
    ds_read_b128 a[100:103], v12 offset:31744
    v_mfma_f32_16x16x32_bf16 v[136:139], a[120:123], a[72:75], v[136:139]
    ds_read_b128 a[104:107], v12 offset:32768
    v_mfma_f32_16x16x32_bf16 v[140:143], a[120:123], a[76:79], v[140:143]
    ds_read_b128 a[108:111], v12 offset:33792
    v_mfma_f32_16x16x32_bf16 v[144:147], a[124:127], a[72:75], v[144:147]
    ds_read_b128 a[112:115], v12 offset:34816
    v_mfma_f32_16x16x32_bf16 v[148:151], a[124:127], a[76:79], v[148:151]
    v_mfma_f32_16x16x32_bf16 v[152:155], a[128:131], a[72:75], v[152:155]
    v_mfma_f32_16x16x32_bf16 v[156:159], a[128:131], a[76:79], v[156:159]
    v_mfma_f32_16x16x32_bf16 v[160:163], a[132:135], a[72:75], v[160:163]
    v_mfma_f32_16x16x32_bf16 v[164:167], a[132:135], a[76:79], v[164:167]
    s_waitcnt lgkmcnt(0)
    s_waitcnt vmcnt(25)
    v_mfma_f32_16x16x32_bf16 v[128:131], a[96:99], a[80:83], v[128:131]
    ds_read_b128 a[116:119], v12 offset:35840
    v_mfma_f32_16x16x32_bf16 v[132:135], a[96:99], a[84:87], v[132:135]
    ds_read_b128 a[120:123], v12 offset:36864
    v_mfma_f32_16x16x32_bf16 v[136:139], a[100:103], a[80:83], v[136:139]
    ds_read_b128 a[124:127], v12 offset:37888
    v_mfma_f32_16x16x32_bf16 v[140:143], a[100:103], a[84:87], v[140:143]
    ds_read_b128 a[128:131], v12 offset:38912
    v_mfma_f32_16x16x32_bf16 v[144:147], a[104:107], a[80:83], v[144:147]
    ds_read_b128 a[132:135], v12 offset:39936
    v_mfma_f32_16x16x32_bf16 v[148:151], a[104:107], a[84:87], v[148:151]
    v_mfma_f32_16x16x32_bf16 v[152:155], a[108:111], a[80:83], v[152:155]
    v_mfma_f32_16x16x32_bf16 v[156:159], a[108:111], a[84:87], v[156:159]
    v_mfma_f32_16x16x32_bf16 v[160:163], a[112:115], a[80:83], v[160:163]
    v_mfma_f32_16x16x32_bf16 v[164:167], a[112:115], a[84:87], v[164:167]
    s_waitcnt vmcnt(2)
    v_cmp_le_u32 vcc, v48, v49
    s_nop 1
    s_cmp_eq_u64 vcc, -1
    s_cbranch_scc1 L_h2_13_ok
    s_cmp_lg_u32 s38, 0
    s_cbranch_scc1 L_h2_13_ok
    s_mov_b32 s69, 0
L_h2_13_spin:
    buffer_load_dword v49, v47, s[60:63], 0 offen sc1
    s_waitcnt vmcnt(0)
    v_cmp_le_u32 vcc, v48, v49
    s_nop 1
    s_cmp_eq_u64 vcc, -1
    s_cbranch_scc1 L_h2_13_ok
    s_sleep 2
    s_add_u32 s69, s69, 1
    s_cmp_lt_u32 s69, 0x4000
    s_cbranch_scc1 L_h2_13_spin
L_h2_13_ok:
    s_waitcnt lgkmcnt(0)
    v_mfma_f32_16x16x32_bf16 v[128:131], a[116:119], a[88:91], v[128:131]
    s_barrier
    ds_read_b128 a[96:99], v12 offset:40960
    v_mfma_f32_16x16x32_bf16 v[132:135], a[116:119], a[92:95], v[132:135]
    ds_read_b128 a[100:103], v12 offset:41984
    v_mfma_f32_16x16x32_bf16 v[136:139], a[120:123], a[88:91], v[136:139]
    ds_read_b128 a[104:107], v12 offset:43008
    v_mfma_f32_16x16x32_bf16 v[140:143], a[120:123], a[92:95], v[140:143]
    ds_read_b128 a[108:111], v12 offset:44032
    v_mfma_f32_16x16x32_bf16 v[144:147], a[124:127], a[88:91], v[144:147]
    ds_read_b128 a[112:115], v12 offset:45056
    v_mfma_f32_16x16x32_bf16 v[148:151], a[124:127], a[92:95], v[148:151]
    v_mfma_f32_16x16x32_bf16 v[152:155], a[128:131], a[88:91], v[152:155]
    v_mfma_f32_16x16x32_bf16 v[156:159], a[128:131], a[92:95], v[156:159]
    v_mfma_f32_16x16x32_bf16 v[160:163], a[132:135], a[88:91], v[160:163]
    v_mfma_f32_16x16x32_bf16 v[164:167], a[132:135], a[92:95], v[164:167]
    s_mov_b32 s70, 53248
    buffer_load_dwordx4 a[64:67], v12, s[52:55], s70 offen offset:0 sc1
    buffer_load_dwordx4 a[68:71], v15, s[52:55], s70 offen offset:0 sc1
    buffer_load_dwordx4 a[72:75], v12, s[52:55], s70 offen offset:1024 sc1
    buffer_load_dwordx4 a[76:79], v15, s[52:55], s70 offen offset:1024 sc1
    s_waitcnt lgkmcnt(0)
    v_mfma_f32_16x16x32_bf16 v[128:131], a[96:99], a[0:3], v[128:131]
    ds_read_b128 a[116:119], v12 offset:46080
    v_mfma_f32_16x16x32_bf16 v[132:135], a[96:99], a[4:7], v[132:135]
    ds_read_b128 a[120:123], v12 offset:47104
    v_mfma_f32_16x16x32_bf16 v[136:139], a[100:103], a[0:3], v[136:139]
    ds_read_b128 a[124:127], v12 offset:48128
    v_mfma_f32_16x16x32_bf16 v[140:143], a[100:103], a[4:7], v[140:143]
    ds_read_b128 a[128:131], v12 offset:49152
    v_mfma_f32_16x16x32_bf16 v[144:147], a[104:107], a[0:3], v[144:147]
    ds_read_b128 a[132:135], v12 offset:50176
    v_mfma_f32_16x16x32_bf16 v[148:151], a[104:107], a[4:7], v[148:151]
    v_mfma_f32_16x16x32_bf16 v[152:155], a[108:111], a[0:3], v[152:155]
    v_mfma_f32_16x16x32_bf16 v[156:159], a[108:111], a[4:7], v[156:159]
    v_mfma_f32_16x16x32_bf16 v[160:163], a[112:115], a[0:3], v[160:163]
    v_mfma_f32_16x16x32_bf16 v[164:167], a[112:115], a[4:7], v[164:167]
    s_waitcnt lgkmcnt(0)
    v_mfma_f32_16x16x32_bf16 v[128:131], a[116:119], a[8:11], v[128:131]
    ds_read_b128 a[96:99], v12 offset:51200
    v_mfma_f32_16x16x32_bf16 v[132:135], a[116:119], a[12:15], v[132:135]
    ds_read_b128 a[100:103], v12 offset:52224
    v_mfma_f32_16x16x32_bf16 v[136:139], a[120:123], a[8:11], v[136:139]
    ds_read_b128 a[104:107], v12 offset:53248
    v_mfma_f32_16x16x32_bf16 v[140:143], a[120:123], a[12:15], v[140:143]
    ds_read_b128 a[108:111], v12 offset:54272
    v_mfma_f32_16x16x32_bf16 v[144:147], a[124:127], a[8:11], v[144:147]
    ds_read_b128 a[112:115], v12 offset:55296
    v_mfma_f32_16x16x32_bf16 v[148:151], a[124:127], a[12:15], v[148:151]
    v_mfma_f32_16x16x32_bf16 v[152:155], a[128:131], a[8:11], v[152:155]
    v_mfma_f32_16x16x32_bf16 v[156:159], a[128:131], a[12:15], v[156:159]
    v_mfma_f32_16x16x32_bf16 v[160:163], a[132:135], a[8:11], v[160:163]
    v_mfma_f32_16x16x32_bf16 v[164:167], a[132:135], a[12:15], v[164:167]
    s_waitcnt lgkmcnt(0)
    v_mfma_f32_16x16x32_bf16 v[128:131], a[96:99], a[16:19], v[128:131]
    ds_read_b128 a[116:119], v12 offset:56320
    v_mfma_f32_16x16x32_bf16 v[132:135], a[96:99], a[20:23], v[132:135]
    ds_read_b128 a[120:123], v12 offset:57344
    s_lshl_b32 s64, s86, 12
    v_mfma_f32_16x16x32_bf16 v[136:139], a[100:103], a[16:19], v[136:139]
    ds_read_b128 a[124:127], v12 offset:58368
    s_and_b32 s65, s87, 6
    v_mfma_f32_16x16x32_bf16 v[140:143], a[100:103], a[20:23], v[140:143]
    ds_read_b128 a[128:131], v12 offset:59392
    s_lshl_b32 s65, s65, 7
    v_mfma_f32_16x16x32_bf16 v[144:147], a[104:107], a[16:19], v[144:147]
    ds_read_b128 a[132:135], v12 offset:60416
    s_add_u32 s64, s64, s65
    v_mfma_f32_16x16x32_bf16 v[148:151], a[104:107], a[20:23], v[148:151]
    s_add_u32 s64, s64, 1280
    v_and_b32 v30, 1, v1
    v_mfma_f32_16x16x32_bf16 v[152:155], a[108:111], a[16:19], v[152:155]
    v_lshl_add_u32 v30, v30, 7, s64
    v_mov_b32 v31, 4
    v_mfma_f32_16x16x32_bf16 v[156:159], a[108:111], a[20:23], v[156:159]
    buffer_load_dword v44, v30, s[60:63], s73 offen sc1
    v_mfma_f32_16x16x32_bf16 v[160:163], a[112:115], a[16:19], v[160:163]
    v_mfma_f32_16x16x32_bf16 v[164:167], a[112:115], a[20:23], v[164:167]
    s_waitcnt lgkmcnt(0)
    v_mfma_f32_16x16x32_bf16 v[128:131], a[116:119], a[24:27], v[128:131]
    s_barrier
    ds_read_b128 a[96:99], v12 offset:61440
    v_mfma_f32_16x16x32_bf16 v[132:135], a[116:119], a[28:31], v[132:135]
    ds_read_b128 a[100:103], v12 offset:62464
    v_mfma_f32_16x16x32_bf16 v[136:139], a[120:123], a[24:27], v[136:139]
    ds_read_b128 a[104:107], v12 offset:63488
    v_mfma_f32_16x16x32_bf16 v[140:143], a[120:123], a[28:31], v[140:143]
    ds_read_b128 a[108:111], v12 offset:64512
    v_mfma_f32_16x16x32_bf16 v[144:147], a[124:127], a[24:27], v[144:147]
    ds_read_b128 a[112:115], v13 offset:0
    v_mfma_f32_16x16x32_bf16 v[148:151], a[124:127], a[28:31], v[148:151]
    v_mfma_f32_16x16x32_bf16 v[152:155], a[128:131], a[24:27], v[152:155]
    v_mfma_f32_16x16x32_bf16 v[156:159], a[128:131], a[28:31], v[156:159]
    v_mfma_f32_16x16x32_bf16 v[160:163], a[132:135], a[24:27], v[160:163]
    v_mfma_f32_16x16x32_bf16 v[164:167], a[132:135], a[28:31], v[164:167]
    s_waitcnt lgkmcnt(0)
    v_mfma_f32_16x16x32_bf16 v[128:131], a[96:99], a[32:35], v[128:131]
    ds_read_b128 a[116:119], v13 offset:1024
    v_mfma_f32_16x16x32_bf16 v[132:135], a[96:99], a[36:39], v[132:135]
    ds_read_b128 a[120:123], v13 offset:2048
    v_mfma_f32_16x16x32_bf16 v[136:139], a[100:103], a[32:35], v[136:139]
    ds_read_b128 a[124:127], v13 offset:3072
    v_mfma_f32_16x16x32_bf16 v[140:143], a[100:103], a[36:39], v[140:143]
    ds_read_b128 a[128:131], v13 offset:4096
    v_mfma_f32_16x16x32_bf16 v[144:147], a[104:107], a[32:35], v[144:147]
    ds_read_b128 a[132:135], v13 offset:5120
    v_mfma_f32_16x16x32_bf16 v[148:151], a[104:107], a[36:39], v[148:151]
    v_mfma_f32_16x16x32_bf16 v[152:155], a[108:111], a[32:35], v[152:155]
    v_mfma_f32_16x16x32_bf16 v[156:159], a[108:111], a[36:39], v[156:159]
    v_mfma_f32_16x16x32_bf16 v[160:163], a[112:115], a[32:35], v[160:163]
    v_mfma_f32_16x16x32_bf16 v[164:167], a[112:115], a[36:39], v[164:167]
    s_waitcnt lgkmcnt(0)
    v_mfma_f32_16x16x32_bf16 v[128:131], a[116:119], a[40:43], v[128:131]
    ds_read_b128 a[96:99], v13 offset:6144
    v_mfma_f32_16x16x32_bf16 v[132:135], a[116:119], a[44:47], v[132:135]
    ds_read_b128 a[100:103], v13 offset:7168
    v_mfma_f32_16x16x32_bf16 v[136:139], a[120:123], a[40:43], v[136:139]
    ds_read_b128 a[104:107], v13 offset:8192
    v_mfma_f32_16x16x32_bf16 v[140:143], a[120:123], a[44:47], v[140:143]
    ds_read_b128 a[108:111], v13 offset:9216
    v_mfma_f32_16x16x32_bf16 v[144:147], a[124:127], a[40:43], v[144:147]
    ds_read_b128 a[112:115], v13 offset:10240
    v_mfma_f32_16x16x32_bf16 v[148:151], a[124:127], a[44:47], v[148:151]
    v_mfma_f32_16x16x32_bf16 v[152:155], a[128:131], a[40:43], v[152:155]
    v_mfma_f32_16x16x32_bf16 v[156:159], a[128:131], a[44:47], v[156:159]
    v_mfma_f32_16x16x32_bf16 v[160:163], a[132:135], a[40:43], v[160:163]
    v_mfma_f32_16x16x32_bf16 v[164:167], a[132:135], a[44:47], v[164:167]
    s_waitcnt lgkmcnt(0)
    v_mfma_f32_16x16x32_bf16 v[128:131], a[96:99], a[48:51], v[128:131]
    ds_read_b128 a[116:119], v13 offset:11264
    v_mfma_f32_16x16x32_bf16 v[132:135], a[96:99], a[52:55], v[132:135]
    ds_read_b128 a[120:123], v13 offset:12288
    v_mfma_f32_16x16x32_bf16 v[136:139], a[100:103], a[48:51], v[136:139]
    ds_read_b128 a[124:127], v13 offset:13312
    v_mfma_f32_16x16x32_bf16 v[140:143], a[100:103], a[52:55], v[140:143]
    ds_read_b128 a[128:131], v13 offset:14336
    v_mfma_f32_16x16x32_bf16 v[144:147], a[104:107], a[48:51], v[144:147]
    ds_read_b128 a[132:135], v13 offset:15360
    v_mfma_f32_16x16x32_bf16 v[148:151], a[104:107], a[52:55], v[148:151]
    v_mfma_f32_16x16x32_bf16 v[152:155], a[108:111], a[48:51], v[152:155]
    v_mfma_f32_16x16x32_bf16 v[156:159], a[108:111], a[52:55], v[156:159]
    v_mfma_f32_16x16x32_bf16 v[160:163], a[112:115], a[48:51], v[160:163]
    v_mfma_f32_16x16x32_bf16 v[164:167], a[112:115], a[52:55], v[164:167]
    s_waitcnt vmcnt(0)
    v_cmp_le_u32 vcc, v31, v44
    s_nop 1
    s_cmp_eq_u64 vcc, -1
    s_cbranch_scc1 L_pc_14_ok
    s_cmp_lg_u32 s38, 0
    s_cbranch_scc1 L_pc_14_ok
    s_mov_b32 s69, 0
L_pc_14_spin:
    buffer_load_dword v44, v30, s[60:63], 0 offen sc1
    s_waitcnt vmcnt(0)
    v_cmp_le_u32 vcc, v31, v44
    s_nop 1
    s_cmp_eq_u64 vcc, -1
    s_cbranch_scc1 L_pc_14_ok
    s_sleep 2
    s_add_u32 s69, s69, 1
    s_cmp_lt_u32 s69, 0x4000
    s_cbranch_scc1 L_pc_14_spin
L_pc_14_ok:
    s_waitcnt lgkmcnt(0)
    v_mfma_f32_16x16x32_bf16 v[128:131], a[116:119], a[56:59], v[128:131]
    s_barrier
    ds_read_b128 a[96:99], v13 offset:16384
    v_mfma_f32_16x16x32_bf16 v[132:135], a[116:119], a[60:63], v[132:135]
    ds_read_b128 a[100:103], v13 offset:17408
    v_mfma_f32_16x16x32_bf16 v[136:139], a[120:123], a[56:59], v[136:139]
    ds_read_b128 a[104:107], v13 offset:18432
    v_mfma_f32_16x16x32_bf16 v[140:143], a[120:123], a[60:63], v[140:143]
    ds_read_b128 a[108:111], v13 offset:19456
    buffer_load_dwordx4 v[168:171], v50, s[48:51], 0 offen offset:0 sc1
    v_mfma_f32_16x16x32_bf16 v[144:147], a[124:127], a[56:59], v[144:147]
    ds_read_b128 a[112:115], v13 offset:20480
    v_mfma_f32_16x16x32_bf16 v[148:151], a[124:127], a[60:63], v[148:151]
    buffer_load_dwordx4 v[172:175], v50, s[48:51], 0 offen offset:256 sc1
    v_mfma_f32_16x16x32_bf16 v[152:155], a[128:131], a[56:59], v[152:155]
    buffer_load_dwordx4 v[176:179], v50, s[48:51], 0 offen offset:1024 sc1
    v_mfma_f32_16x16x32_bf16 v[156:159], a[128:131], a[60:63], v[156:159]
    buffer_load_dwordx4 v[180:183], v50, s[48:51], 0 offen offset:1280 sc1
    v_mfma_f32_16x16x32_bf16 v[160:163], a[132:135], a[56:59], v[160:163]
    buffer_load_dwordx4 v[184:187], v50, s[48:51], 0 offen offset:2048 sc1
    v_mfma_f32_16x16x32_bf16 v[164:167], a[132:135], a[60:63], v[164:167]
    buffer_load_dwordx4 v[188:191], v50, s[48:51], 0 offen offset:2304 sc1
    buffer_load_dwordx4 v[192:195], v50, s[48:51], 0 offen offset:3072 sc1
    s_waitcnt lgkmcnt(0)
    v_mfma_f32_16x16x32_bf16 v[128:131], a[96:99], a[64:67], v[128:131]
    ds_read_b128 a[116:119], v13 offset:21504
    v_mfma_f32_16x16x32_bf16 v[132:135], a[96:99], a[68:71], v[132:135]
    ds_read_b128 a[120:123], v13 offset:22528
    buffer_load_dwordx4 v[196:199], v50, s[48:51], 0 offen offset:3328 sc1
    v_mfma_f32_16x16x32_bf16 v[136:139], a[100:103], a[64:67], v[136:139]
    ds_read_b128 a[124:127], v13 offset:23552
    buffer_load_dwordx4 v[200:203], v50, s[48:51], s68 offen offset:0 sc1
    v_mfma_f32_16x16x32_bf16 v[140:143], a[100:103], a[68:71], v[140:143]
    ds_read_b128 a[128:131], v13 offset:24576
    buffer_load_dwordx4 v[204:207], v50, s[48:51], s68 offen offset:256 sc1
    v_mfma_f32_16x16x32_bf16 v[144:147], a[104:107], a[64:67], v[144:147]
    ds_read_b128 a[132:135], v13 offset:25600
    v_mfma_f32_16x16x32_bf16 v[148:151], a[104:107], a[68:71], v[148:151]
    v_mfma_f32_16x16x32_bf16 v[152:155], a[108:111], a[64:67], v[152:155]
    v_mfma_f32_16x16x32_bf16 v[156:159], a[108:111], a[68:71], v[156:159]
    v_mfma_f32_16x16x32_bf16 v[160:163], a[112:115], a[64:67], v[160:163]
    v_mfma_f32_16x16x32_bf16 v[164:167], a[112:115], a[68:71], v[164:167]
    s_waitcnt lgkmcnt(0)
    v_mfma_f32_16x16x32_bf16 v[128:131], a[116:119], a[72:75], v[128:131]
    v_mfma_f32_16x16x32_bf16 v[132:135], a[116:119], a[76:79], v[132:135]
    v_mfma_f32_16x16x32_bf16 v[136:139], a[120:123], a[72:75], v[136:139]
    v_mfma_f32_16x16x32_bf16 v[140:143], a[120:123], a[76:79], v[140:143]
    v_mfma_f32_16x16x32_bf16 v[144:147], a[124:127], a[72:75], v[144:147]
    v_mfma_f32_16x16x32_bf16 v[148:151], a[124:127], a[76:79], v[148:151]
    v_mfma_f32_16x16x32_bf16 v[152:155], a[128:131], a[72:75], v[152:155]
    v_mfma_f32_16x16x32_bf16 v[156:159], a[128:131], a[76:79], v[156:159]
    v_mfma_f32_16x16x32_bf16 v[160:163], a[132:135], a[72:75], v[160:163]
    v_mfma_f32_16x16x32_bf16 v[164:167], a[132:135], a[76:79], v[164:167]
    s_waitcnt vmcnt(9)
    v_mfma_f32_16x16x32_bf16 v[128:131], v[64:67], v[168:171], v[128:131]
    s_waitcnt vmcnt(8)
    v_mfma_f32_16x16x32_bf16 v[132:135], v[64:67], v[172:175], v[132:135]
    s_waitcnt vmcnt(7)
    v_mfma_f32_16x16x32_bf16 v[136:139], v[64:67], v[176:179], v[136:139]
    s_nop 3
    v_cvt_pk_bf16_f32 v54, v128, v129
    v_cvt_pk_bf16_f32 v55, v130, v131
    buffer_store_dwordx2 v[54:55], v45, s[12:15], 0 offen offset:0
    s_waitcnt vmcnt(7)
    v_mfma_f32_16x16x32_bf16 v[140:143], v[64:67], v[180:183], v[140:143]
    v_cvt_pk_bf16_f32 v56, v132, v133
    v_cvt_pk_bf16_f32 v57, v134, v135
    buffer_store_dwordx2 v[56:57], v46, s[12:15], 0 offen offset:0
    s_waitcnt vmcnt(7)
    v_mfma_f32_16x16x32_bf16 v[144:147], v[64:67], v[184:187], v[144:147]
    v_cvt_pk_bf16_f32 v58, v136, v137
    v_cvt_pk_bf16_f32 v59, v138, v139
    buffer_store_dwordx2 v[58:59], v45, s[12:15], 0 offen offset:32
    s_waitcnt vmcnt(7)
    v_mfma_f32_16x16x32_bf16 v[148:151], v[64:67], v[188:191], v[148:151]
    v_cvt_pk_bf16_f32 v60, v140, v141
    v_cvt_pk_bf16_f32 v61, v142, v143
    buffer_store_dwordx2 v[60:61], v46, s[12:15], 0 offen offset:32
    s_waitcnt vmcnt(7)
    v_mfma_f32_16x16x32_bf16 v[152:155], v[64:67], v[192:195], v[152:155]
    v_cvt_pk_bf16_f32 v54, v144, v145
    v_cvt_pk_bf16_f32 v55, v146, v147
    buffer_store_dwordx2 v[54:55], v45, s[12:15], 0 offen offset:64
    s_waitcnt vmcnt(7)
    v_mfma_f32_16x16x32_bf16 v[156:159], v[64:67], v[196:199], v[156:159]
    v_cvt_pk_bf16_f32 v56, v148, v149
    v_cvt_pk_bf16_f32 v57, v150, v151
    buffer_store_dwordx2 v[56:57], v46, s[12:15], 0 offen offset:64
    s_waitcnt vmcnt(7)
    v_mfma_f32_16x16x32_bf16 v[160:163], v[64:67], v[200:203], v[160:163]
    v_cvt_pk_bf16_f32 v58, v152, v153
    v_cvt_pk_bf16_f32 v59, v154, v155
    buffer_store_dwordx2 v[58:59], v45, s[12:15], 0 offen offset:96
    s_waitcnt vmcnt(7)
    v_mfma_f32_16x16x32_bf16 v[164:167], v[64:67], v[204:207], v[164:167]
    v_cvt_pk_bf16_f32 v60, v156, v157
    v_cvt_pk_bf16_f32 v61, v158, v159
    buffer_store_dwordx2 v[60:61], v46, s[12:15], 0 offen offset:96
    v_cvt_pk_bf16_f32 v54, v160, v161
    v_cvt_pk_bf16_f32 v55, v162, v163
    buffer_store_dwordx2 v[54:55], v45, s[12:15], 0 offen offset:128
    s_nop 1
    v_cvt_pk_bf16_f32 v56, v164, v165
    v_cvt_pk_bf16_f32 v57, v166, v167
    buffer_store_dwordx2 v[56:57], v46, s[12:15], 0 offen offset:128
L_end:
    s_endpgm
L_zs:
    s_mul_i32 s41, s40, 17664
    s_add_u32 s41, s41, 25165824
    s_add_u32 s12, s36, s41
    s_addc_u32 s13, s37, 0
    s_mov_b32 s14, 17664
    s_mov_b32 s15, 0x00020000
    v_mov_b32 v40, 0
    v_mov_b32 v41, 0
    v_mov_b32 v42, 0
    v_mov_b32 v43, 0
    v_lshlrev_b32 v44, 4, v1
    v_add_u32 v44, s43, v44
    s_lshl_b32 s41, s38, 10
    s_add_u32 s41, s41, 16384
    v_lshl_add_u32 v45, v1, 4, s41
    s_nop 1
    buffer_store_dwordx4 v[40:43], v44, s[12:15], 0 offen offset:0 sc1
    buffer_store_dwordx4 v[40:43], v44, s[12:15], 0 offen offset:1024 sc1
    buffer_store_dwordx4 v[40:43], v44, s[12:15], 0 offen offset:2048 sc1
    buffer_store_dwordx4 v[40:43], v44, s[12:15], 0 offen offset:3072 sc1
    buffer_store_dwordx4 v[40:43], v45, s[12:15], 0 offen sc1
    s_branch L_zs_ret
L_zf_1:
    s_waitcnt vmcnt(8)
    s_barrier
    s_or_b32 s41, s39, s38
    s_cmp_eq_u32 s41, 0
    s_cselect_b32 s14, 64, 0
    s_add_u32 s12, s34, 0
    s_addc_u32 s13, s35, 0
    s_lshl_b32 s41, s40, 2
    v_mov_b32 v250, 1
    v_lshlrev_b32 v251, 6, v1
    buffer_store_dword v250, v251, s[12:15], s41 offen sc1
    s_branch L_zf_1_ret
L_zf_7:
    s_waitcnt vmcnt(8)
    s_barrier
    s_or_b32 s41, s39, s38
    s_cmp_eq_u32 s41, 0
    s_cselect_b32 s14, 64, 0
    s_add_u32 s12, s34, 0
    s_addc_u32 s13, s35, 0
    s_lshl_b32 s41, s40, 2
    v_mov_b32 v60, 1
    v_lshlrev_b32 v61, 6, v1
    buffer_store_dword v60, v61, s[12:15], s41 offen sc1
    s_branch L_zf_7_ret
L_code_end:
.section .rodata,"a"
.p2align 6
.amdhsa_kernel parallel_sum__linear_kernel_hedgehog__glu_gated_reglu__prompt_kernel
  .amdhsa_next_free_vgpr 512
  .amdhsa_next_free_sgpr 102
  .amdhsa_accum_offset 256
  .amdhsa_group_segment_fixed_size 0
  .amdhsa_kernarg_size 88
  .amdhsa_user_sgpr_count 2
  .amdhsa_user_sgpr_kernarg_segment_ptr 1
  .amdhsa_system_sgpr_workgroup_id_x 1
.end_amdhsa_kernel
```
